```python
import torch

def _softmax(x, axis=-1):
    return torch.softmax(x, dim=axis)
def _gelu(x):
    return torch.nn.functional.gelu(x, approximate="tanh")
def _silu(x):
    return torch.nn.functional.silu(x)
def _sigmoid(x):
    return torch.sigmoid(x)
def _layernorm(x, axis=-1, eps=1e-5):
    m = x.mean(dim=axis, keepdim=True)
    v = x.var(dim=axis, keepdim=True, unbiased=False)
    return (x - m) / torch.sqrt(v + eps)
def _scatter_add(tgt, idx, src, axis=0):
    return tgt.clone().index_add_(axis, idx, src)
def _segment_sum(src, seg, n):
    out = torch.zeros((n,) + src.shape[1:], dtype=src.dtype)
    return out.index_add_(0, seg, src)
def _pad(x, pw):
    flat = tuple(v for pair in reversed(pw) for v in pair)
    return torch.nn.functional.pad(x, flat)

kernel_name = 'sequential_preLN__mha_block__glu_gated_glu__prompt'

def setup_inputs():

    _w = (lambda a: (lambda t: t.to(torch.bfloat16) if t.is_floating_point() else t)(torch.as_tensor(a)))
    def _A_setup():
        B, S, D, H = 1, 2048, 512, 32
        return {
            "x": _w((lambda *s: torch.randn(*s, dtype=torch.bfloat16) * 0.05)(B, S, D)),
            "wqkv": _w((lambda *s: torch.randn(*s, dtype=torch.bfloat16) * 0.05)(D, 3 * D)),
            "wo": _w((lambda *s: torch.randn(*s, dtype=torch.bfloat16) * 0.05)(D, D)),
        }
    _A_in = _A_setup()

    def _B_setup():
        B, S, D, F = 1, 2048, 512, 1376
        return {
            "x": _w((lambda *s: torch.randn(*s, dtype=torch.bfloat16) * 0.05)(B, S, D)),
            "w_gate": _w((lambda *s: torch.randn(*s, dtype=torch.bfloat16) * 0.05)(D, F)),
            "w_up": _w((lambda *s: torch.randn(*s, dtype=torch.bfloat16) * 0.05)(D, F)),
            "w_down": _w((lambda *s: torch.randn(*s, dtype=torch.bfloat16) * 0.05)(F, D)),
        }
    _B_in = _B_setup()

    return {
        "A_x": _A_in["x"],
        "A_wqkv": _A_in["wqkv"],
        "A_wo": _A_in["wo"],
        "B_x": _B_in["x"],
        "B_w_gate": _B_in["w_gate"],
        "B_w_up": _B_in["w_up"],
        "B_w_down": _B_in["w_down"],
    }

def reference(A_x, A_wqkv, A_wo, B_x, B_w_gate, B_w_up, B_w_down):
    def _A_ref(x, wqkv, wo):
        B, S, D = x.shape
        H = 32
        Dh = D // H
        qkv = (lambda x, *d: x.permute(*d))((x @ wqkv).reshape(B, S, 3, H, Dh), 2, 0, 3, 1, 4)
        q, k, v = qkv[0], qkv[1], qkv[2]
        scores = torch.einsum("bhqd,bhkd->bhqk", q, k) * (Dh ** -0.5)
        p = _softmax(scores, axis=-1)
        o = torch.einsum("bhqk,bhkd->bhqd", p, v)
        return (lambda x, *d: x.permute(*d))(o, 0, 2, 1, 3).reshape(B, S, D) @ wo

    def _B_ref(x, w_gate, w_up, w_down):
        g = torch.einsum("bsd,df->bsf", x, w_gate)
        u = torch.einsum("bsd,df->bsf", x, w_up)
        h = _sigmoid(g) * u
        return torch.einsum("bsf,fd->bsd", h, w_down)

    x = A_x
    h = x + _A_ref(_layernorm(x, axis=-1), A_wqkv, A_wo)
    h2 = h + _B_ref(_layernorm(h, axis=-1), B_w_gate, B_w_up, B_w_down)
    return h2
```

```asm
; @launch grid=(256,1,1) block=(576,1,1) lds=163840
.amdgcn_target "amdgcn-amd-amdhsa--gfx950"
.text
.globl sequential_preLN__mha_block__glu_gated_glu__prompt_kernel
.p2align 8
.type sequential_preLN__mha_block__glu_gated_glu__prompt_kernel,@function
sequential_preLN__mha_block__glu_gated_glu__prompt_kernel:
    s_cmp_ge_u32 s2, 256
    s_cbranch_scc1 L_done
    s_load_dwordx16 s[64:79], s[0:1], 0
    s_load_dwordx2 s[8:9], s[0:1], 72
    v_and_b32 v1, 63, v0
    v_lshrrev_b32 v7, 6, v0
    v_lshlrev_b32 v2, 4, v1
    v_readfirstlane_b32 s24, v7
    s_and_b32 s30, s2, 7
    s_lshl_b32 s30, s30, 2
    s_bfe_u32 s31, s2, 0x20003
    s_add_u32 s28, s30, s31
    s_lshr_b32 s27, s2, 5
    s_and_b32 s29, s24, 3
    s_cmp_eq_u32 s24, 8
    s_cbranch_scc1 L_p1_aux
    s_cmp_ge_u32 s24, 4
    s_cbranch_scc0 L_p1_compute
    v_lshrrev_b32 v8, 3, v1
    v_and_b32 v9, 7, v1
    v_lshrrev_b32 v10, 1, v8
    v_xor_b32 v10, v10, v9
    v_lshlrev_b32 v10, 4, v10
    v_lshl_add_u32 v4, v8, 10, v10
    v_xor_b32 v5, 64, v4
    v_add_u32 v5, 7168, v5
    s_lshl_b32 s34, s28, 16
    s_lshl_b32 s30, s29, 14
    s_add_u32 s34, s34, s30
    s_lshl_b32 s36, s29, 11
    s_and_b32 s44, s2, 7
    s_lshl_b32 s44, s44, 2
    s_lshr_b32 s45, s2, 6
    s_add_u32 s44, s44, s45
    s_lshl_b32 s44, s44, 16
    s_add_u32 s44, s44, s30
    s_bfe_u32 s45, s2, 0x30003
    s_lshl_b32 s45, s45, 7
    s_add_u32 s44, s44, s45
    v_lshrrev_b32 v10, 2, v1
    v_and_b32 v10, 4, v10
    v_xor_b32 v10, v10, v9
    v_lshlrev_b32 v10, 4, v10
    v_mul_u32_u24 v11, 3072, v8
    s_mul_i32 s30, s29, 24576
    s_lshl_b32 s31, s27, 7
    s_add_u32 s30, s30, s31
    v_add3_u32 v3, v11, v10, s30
    s_mul_i32 s32, s29, 3072
    s_waitcnt lgkmcnt(0)
    s_mov_b32 s20, s64
    s_mov_b32 s21, s65
    s_mov_b32 s22, 0x00200000
    s_mov_b32 s23, 0x00020000
    s_mov_b32 s16, s66
    s_mov_b32 s17, s67
    s_mov_b32 s18, 0x00180000
    s_mov_b32 s19, 0x00020000
    s_add_u32 m0, s36, 0
    s_add_u32 s43, s34, 0
    buffer_load_dwordx4 v4, s[20:23], s43 offen lds
    buffer_load_dwordx4 v5, s[20:23], s43 offen offset:1024 lds
    s_add_u32 m0, s32, 65536
    s_mov_b32 s42, 0
    buffer_load_dwordx4 v3, s[16:19], s42 offen offset:0 lds
    buffer_load_dwordx4 v3, s[16:19], s42 offen offset:1024 lds
    buffer_load_dwordx4 v3, s[16:19], s42 offen offset:2048 lds
    s_lshr_b32 s30, s2, 3
    s_lshl_b32 s30, s30, 2
    s_add_u32 s30, s30, s29
    s_lshl_b32 s30, s30, 10
    s_add_u32 s50, s66, s30
    s_addc_u32 s51, s67, 0
    s_load_dword s52, s[50:51], 384
    s_load_dword s52, s[50:51], 448
    s_load_dword s52, s[50:51], 131456
    s_load_dword s52, s[50:51], 131520
    s_load_dword s52, s[50:51], 262528
    s_load_dword s52, s[50:51], 262592
    s_load_dword s52, s[50:51], 393600
    s_load_dword s52, s[50:51], 393664
    s_load_dword s52, s[50:51], 524672
    s_load_dword s52, s[50:51], 524736
    s_load_dword s52, s[50:51], 655744
    s_load_dword s52, s[50:51], 655808
    s_load_dword s52, s[50:51], 786816
    s_load_dword s52, s[50:51], 786880
    s_add_u32 m0, s32, 77824
    s_mov_b32 s42, 98304
    buffer_load_dwordx4 v3, s[16:19], s42 offen offset:0 lds
    buffer_load_dwordx4 v3, s[16:19], s42 offen offset:1024 lds
    buffer_load_dwordx4 v3, s[16:19], s42 offen offset:2048 lds
    s_add_u32 m0, s36, 8192
    s_add_u32 s43, s34, 128
    buffer_load_dwordx4 v4, s[20:23], s43 offen lds
    buffer_load_dwordx4 v5, s[20:23], s43 offen offset:1024 lds
    s_add_u32 m0, s32, 90112
    s_mov_b32 s42, 196608
    buffer_load_dwordx4 v3, s[16:19], s42 offen offset:0 lds
    buffer_load_dwordx4 v3, s[16:19], s42 offen offset:1024 lds
    buffer_load_dwordx4 v3, s[16:19], s42 offen offset:2048 lds
    s_add_u32 s12, s8, 0x00000000
    s_addc_u32 s13, s9, 0
    s_mov_b32 s14, 0x02000000
    s_mov_b32 s15, 0x00020000
    s_mov_b32 s41, 0x3f803f80
    v_lshrrev_b32 v8, 2, v1
    v_and_b32 v9, 3, v1
    v_lshlrev_b32 v10, 7, v8
    v_lshl_add_u32 v10, v9, 4, v10
    v_bfe_u32 v11, v1, 3, 1
    v_lshl_add_u32 v10, v11, 6, v10
    v_add_u32 v6, s36, v10
    v_xor_b32 v7, 64, v6
    s_lshl_b32 s30, s29, 4
    v_add_u32 v8, s30, v8
    v_lshlrev_b32 v21, 2, v8
    v_add_u32 v21, 155136, v21
    v_and_b32 v10, 31, v8
    v_lshl_add_u32 v10, v9, 5, v10
    v_lshrrev_b32 v11, 5, v8
    v_lshl_add_u32 v10, v11, 6, v10
    v_lshlrev_b32 v20, 4, v10
    v_add_u32 v20, 153088, v20
    v_mov_b32 v22, 0
    v_mov_b32 v23, 0
    s_waitcnt vmcnt(8)
    s_barrier
    s_load_dword s52, s[50:51], 917888
    s_load_dword s52, s[50:51], 917952
    s_add_u32 s50, s50, 1048576
    s_addc_u32 s51, s51, 0
    s_load_dword s52, s[50:51], 384
    s_load_dword s52, s[50:51], 448
    s_load_dword s52, s[50:51], 131456
    s_load_dword s52, s[50:51], 131520
    s_load_dword s52, s[50:51], 262528
    s_load_dword s52, s[50:51], 262592
    s_load_dword s52, s[50:51], 393600
    s_load_dword s52, s[50:51], 393664
    s_add_u32 m0, s32, 102400
    s_mov_b32 s42, 294912
    buffer_load_dwordx4 v3, s[16:19], s42 offen offset:0 lds
    buffer_load_dwordx4 v3, s[16:19], s42 offen offset:1024 lds
    buffer_load_dwordx4 v3, s[16:19], s42 offen offset:2048 lds
    s_add_u32 m0, s36, 16384
    s_add_u32 s43, s34, 256
    buffer_load_dwordx4 v4, s[20:23], s43 offen lds
    buffer_load_dwordx4 v5, s[20:23], s43 offen offset:1024 lds
    s_add_u32 m0, s32, 114688
    s_mov_b32 s42, 393216
    buffer_load_dwordx4 v3, s[16:19], s42 offen offset:0 lds
    buffer_load_dwordx4 v3, s[16:19], s42 offen offset:1024 lds
    buffer_load_dwordx4 v3, s[16:19], s42 offen offset:2048 lds
    s_waitcnt vmcnt(13)
    s_barrier
    s_add_u32 m0, s32, 126976
    s_mov_b32 s42, 491520
    buffer_load_dwordx4 v3, s[16:19], s42 offen offset:0 lds
    buffer_load_dwordx4 v3, s[16:19], s42 offen offset:1024 lds
    buffer_load_dwordx4 v3, s[16:19], s42 offen offset:2048 lds
    s_waitcnt vmcnt(8)
    s_barrier
    s_add_u32 m0, s36, 24576
    s_add_u32 s43, s34, 384
    buffer_load_dwordx4 v4, s[20:23], s43 offen lds
    buffer_load_dwordx4 v5, s[20:23], s43 offen offset:1024 lds
    s_add_u32 m0, s32, 139264
    s_mov_b32 s42, 589824
    buffer_load_dwordx4 v3, s[16:19], s42 offen offset:0 lds
    buffer_load_dwordx4 v3, s[16:19], s42 offen offset:1024 lds
    buffer_load_dwordx4 v3, s[16:19], s42 offen offset:2048 lds
    s_add_u32 m0, s32, 65536
    s_mov_b32 s42, 688128
    buffer_load_dwordx4 v3, s[16:19], s42 offen offset:0 lds
    buffer_load_dwordx4 v3, s[16:19], s42 offen offset:1024 lds
    buffer_load_dwordx4 v3, s[16:19], s42 offen offset:2048 lds
    s_waitcnt vmcnt(8)
    s_barrier
    ds_read_b128 v[32:35], v6 offset:0
    ds_read_b128 v[36:39], v7 offset:0
    ds_read_b128 v[40:43], v6 offset:8192
    ds_read_b128 v[44:47], v7 offset:8192
    s_add_u32 m0, s36, 32768
    s_add_u32 s43, s34, 512
    buffer_load_dwordx4 v4, s[20:23], s43 offen lds
    buffer_load_dwordx4 v5, s[20:23], s43 offen offset:1024 lds
    s_add_u32 m0, s32, 77824
    s_mov_b32 s42, 786432
    buffer_load_dwordx4 v3, s[16:19], s42 offen offset:0 lds
    buffer_load_dwordx4 v3, s[16:19], s42 offen offset:1024 lds
    buffer_load_dwordx4 v3, s[16:19], s42 offen offset:2048 lds
    s_add_u32 m0, s32, 90112
    s_mov_b32 s42, 884736
    buffer_load_dwordx4 v3, s[16:19], s42 offen offset:0 lds
    buffer_load_dwordx4 v3, s[16:19], s42 offen offset:1024 lds
    buffer_load_dwordx4 v3, s[16:19], s42 offen offset:2048 lds
    s_waitcnt lgkmcnt(0)
    v_dot2_f32_bf16 v22, v32, s41, v22
    v_dot2_f32_bf16 v23, v32, v32, v23
    v_dot2_f32_bf16 v22, v33, s41, v22
    v_dot2_f32_bf16 v23, v33, v33, v23
    v_dot2_f32_bf16 v22, v34, s41, v22
    v_dot2_f32_bf16 v23, v34, v34, v23
    v_dot2_f32_bf16 v22, v35, s41, v22
    v_dot2_f32_bf16 v23, v35, v35, v23
    v_dot2_f32_bf16 v22, v36, s41, v22
    v_dot2_f32_bf16 v23, v36, v36, v23
    v_dot2_f32_bf16 v22, v37, s41, v22
    v_dot2_f32_bf16 v23, v37, v37, v23
    v_dot2_f32_bf16 v22, v38, s41, v22
    v_dot2_f32_bf16 v23, v38, v38, v23
    v_dot2_f32_bf16 v22, v39, s41, v22
    v_dot2_f32_bf16 v23, v39, v39, v23
    v_dot2_f32_bf16 v22, v40, s41, v22
    v_dot2_f32_bf16 v23, v40, v40, v23
    v_dot2_f32_bf16 v22, v41, s41, v22
    v_dot2_f32_bf16 v23, v41, v41, v23
    v_dot2_f32_bf16 v22, v42, s41, v22
    v_dot2_f32_bf16 v23, v42, v42, v23
    v_dot2_f32_bf16 v22, v43, s41, v22
    v_dot2_f32_bf16 v23, v43, v43, v23
    v_dot2_f32_bf16 v22, v44, s41, v22
    v_dot2_f32_bf16 v23, v44, v44, v23
    v_dot2_f32_bf16 v22, v45, s41, v22
    v_dot2_f32_bf16 v23, v45, v45, v23
    v_dot2_f32_bf16 v22, v46, s41, v22
    v_dot2_f32_bf16 v23, v46, v46, v23
    v_dot2_f32_bf16 v22, v47, s41, v22
    v_dot2_f32_bf16 v23, v47, v47, v23
    s_waitcnt vmcnt(8)
    s_barrier
    ds_read_b128 v[32:35], v6 offset:16384
    ds_read_b128 v[36:39], v7 offset:16384
    ds_read_b128 v[40:43], v6 offset:24576
    ds_read_b128 v[44:47], v7 offset:24576
    s_add_u32 m0, s36, 40960
    s_add_u32 s43, s34, 640
    buffer_load_dwordx4 v4, s[20:23], s43 offen lds
    buffer_load_dwordx4 v5, s[20:23], s43 offen offset:1024 lds
    s_add_u32 m0, s32, 102400
    s_mov_b32 s42, 983040
    buffer_load_dwordx4 v3, s[16:19], s42 offen offset:0 lds
    buffer_load_dwordx4 v3, s[16:19], s42 offen offset:1024 lds
    buffer_load_dwordx4 v3, s[16:19], s42 offen offset:2048 lds
    s_add_u32 m0, s32, 114688
    s_mov_b32 s42, 1081344
    buffer_load_dwordx4 v3, s[16:19], s42 offen offset:0 lds
    buffer_load_dwordx4 v3, s[16:19], s42 offen offset:1024 lds
    buffer_load_dwordx4 v3, s[16:19], s42 offen offset:2048 lds
    s_waitcnt lgkmcnt(0)
    v_dot2_f32_bf16 v22, v32, s41, v22
    v_dot2_f32_bf16 v23, v32, v32, v23
    v_dot2_f32_bf16 v22, v33, s41, v22
    v_dot2_f32_bf16 v23, v33, v33, v23
    v_dot2_f32_bf16 v22, v34, s41, v22
    v_dot2_f32_bf16 v23, v34, v34, v23
    v_dot2_f32_bf16 v22, v35, s41, v22
    v_dot2_f32_bf16 v23, v35, v35, v23
    v_dot2_f32_bf16 v22, v36, s41, v22
    v_dot2_f32_bf16 v23, v36, v36, v23
    v_dot2_f32_bf16 v22, v37, s41, v22
    v_dot2_f32_bf16 v23, v37, v37, v23
    v_dot2_f32_bf16 v22, v38, s41, v22
    v_dot2_f32_bf16 v23, v38, v38, v23
    v_dot2_f32_bf16 v22, v39, s41, v22
    v_dot2_f32_bf16 v23, v39, v39, v23
    v_dot2_f32_bf16 v22, v40, s41, v22
    v_dot2_f32_bf16 v23, v40, v40, v23
    v_dot2_f32_bf16 v22, v41, s41, v22
    v_dot2_f32_bf16 v23, v41, v41, v23
    v_dot2_f32_bf16 v22, v42, s41, v22
    v_dot2_f32_bf16 v23, v42, v42, v23
    v_dot2_f32_bf16 v22, v43, s41, v22
    v_dot2_f32_bf16 v23, v43, v43, v23
    v_dot2_f32_bf16 v22, v44, s41, v22
    v_dot2_f32_bf16 v23, v44, v44, v23
    v_dot2_f32_bf16 v22, v45, s41, v22
    v_dot2_f32_bf16 v23, v45, v45, v23
    v_dot2_f32_bf16 v22, v46, s41, v22
    v_dot2_f32_bf16 v23, v46, v46, v23
    v_dot2_f32_bf16 v22, v47, s41, v22
    v_dot2_f32_bf16 v23, v47, v47, v23
    s_waitcnt vmcnt(8)
    s_barrier
    ds_read_b128 v[32:35], v6 offset:32768
    ds_read_b128 v[36:39], v7 offset:32768
    s_add_u32 m0, s36, 49152
    s_add_u32 s43, s34, 768
    buffer_load_dwordx4 v4, s[20:23], s43 offen lds
    buffer_load_dwordx4 v5, s[20:23], s43 offen offset:1024 lds
    s_add_u32 m0, s32, 126976
    s_mov_b32 s42, 1179648
    buffer_load_dwordx4 v3, s[16:19], s42 offen offset:0 lds
    buffer_load_dwordx4 v3, s[16:19], s42 offen offset:1024 lds
    buffer_load_dwordx4 v3, s[16:19], s42 offen offset:2048 lds
    s_add_u32 m0, s32, 139264
    s_mov_b32 s42, 1277952
    buffer_load_dwordx4 v3, s[16:19], s42 offen offset:0 lds
    buffer_load_dwordx4 v3, s[16:19], s42 offen offset:1024 lds
    buffer_load_dwordx4 v3, s[16:19], s42 offen offset:2048 lds
    s_waitcnt lgkmcnt(0)
    v_dot2_f32_bf16 v22, v32, s41, v22
    v_dot2_f32_bf16 v23, v32, v32, v23
    v_dot2_f32_bf16 v22, v33, s41, v22
    v_dot2_f32_bf16 v23, v33, v33, v23
    v_dot2_f32_bf16 v22, v34, s41, v22
    v_dot2_f32_bf16 v23, v34, v34, v23
    v_dot2_f32_bf16 v22, v35, s41, v22
    v_dot2_f32_bf16 v23, v35, v35, v23
    v_dot2_f32_bf16 v22, v36, s41, v22
    v_dot2_f32_bf16 v23, v36, v36, v23
    v_dot2_f32_bf16 v22, v37, s41, v22
    v_dot2_f32_bf16 v23, v37, v37, v23
    v_dot2_f32_bf16 v22, v38, s41, v22
    v_dot2_f32_bf16 v23, v38, v38, v23
    v_dot2_f32_bf16 v22, v39, s41, v22
    v_dot2_f32_bf16 v23, v39, v39, v23
    s_waitcnt vmcnt(8)
    s_barrier
    ds_read_b128 v[32:35], v6 offset:40960
    ds_read_b128 v[36:39], v7 offset:40960
    s_add_u32 m0, s36, 57344
    s_add_u32 s43, s34, 896
    buffer_load_dwordx4 v4, s[20:23], s43 offen lds
    buffer_load_dwordx4 v5, s[20:23], s43 offen offset:1024 lds
    s_add_u32 m0, s32, 65536
    s_mov_b32 s42, 1376256
    buffer_load_dwordx4 v3, s[16:19], s42 offen offset:0 lds
    buffer_load_dwordx4 v3, s[16:19], s42 offen offset:1024 lds
    buffer_load_dwordx4 v3, s[16:19], s42 offen offset:2048 lds
    s_add_u32 m0, s32, 77824
    s_mov_b32 s42, 1474560
    buffer_load_dwordx4 v3, s[16:19], s42 offen offset:0 lds
    buffer_load_dwordx4 v3, s[16:19], s42 offen offset:1024 lds
    buffer_load_dwordx4 v3, s[16:19], s42 offen offset:2048 lds
    s_add_u32 m0, s36, 155648
    s_nop 0
    buffer_load_dwordx4 v4, s[20:23], s44 offen lds
    buffer_load_dwordx4 v5, s[20:23], s44 offen offset:1024 lds
    s_waitcnt lgkmcnt(0)
    v_dot2_f32_bf16 v22, v32, s41, v22
    v_dot2_f32_bf16 v23, v32, v32, v23
    v_dot2_f32_bf16 v22, v33, s41, v22
    v_dot2_f32_bf16 v23, v33, v33, v23
    v_dot2_f32_bf16 v22, v34, s41, v22
    v_dot2_f32_bf16 v23, v34, v34, v23
    v_dot2_f32_bf16 v22, v35, s41, v22
    v_dot2_f32_bf16 v23, v35, v35, v23
    v_dot2_f32_bf16 v22, v36, s41, v22
    v_dot2_f32_bf16 v23, v36, v36, v23
    v_dot2_f32_bf16 v22, v37, s41, v22
    v_dot2_f32_bf16 v23, v37, v37, v23
    v_dot2_f32_bf16 v22, v38, s41, v22
    v_dot2_f32_bf16 v23, v38, v38, v23
    v_dot2_f32_bf16 v22, v39, s41, v22
    v_dot2_f32_bf16 v23, v39, v39, v23
    s_lshl_b32 s30, s28, 1
    s_and_b32 s31, s29, 1
    s_add_u32 s30, s30, s31
    s_mul_i32 s30, s30, 126976
    s_lshl_b32 s31, s27, 13
    s_lshl_b32 s43, s27, 12
    s_add_u32 s43, s43, 65536
    s_cmp_ge_u32 s29, 2
    s_cselect_b32 s31, s43, s31
    s_mul_i32 s43, s27, -768
    s_add_u32 s43, s43, 28672
    v_lshlrev_b32 v30, 7, v1
    s_cmp_ge_u32 s29, 2
    s_cbranch_scc0 L_p1_tkv
    s_mov_b32 exec_lo, 0
    v_add_u32 v30, s43, v30
    s_mov_b32 exec_lo, -1
    s_mov_b32 exec_hi, 0x3ffffff
L_p1_tkv:
    s_add_u32 s30, s30, s31
    buffer_load_dword v31, v30, s[12:15], s30 offen
    s_mov_b64 exec, -1
    s_waitcnt vmcnt(11)
    s_barrier
    ds_read_b128 v[32:35], v6 offset:49152
    ds_read_b128 v[36:39], v7 offset:49152
    s_waitcnt lgkmcnt(0)
    v_dot2_f32_bf16 v22, v32, s41, v22
    v_dot2_f32_bf16 v23, v32, v32, v23
    v_dot2_f32_bf16 v22, v33, s41, v22
    v_dot2_f32_bf16 v23, v33, v33, v23
    v_dot2_f32_bf16 v22, v34, s41, v22
    v_dot2_f32_bf16 v23, v34, v34, v23
    v_dot2_f32_bf16 v22, v35, s41, v22
    v_dot2_f32_bf16 v23, v35, v35, v23
    v_dot2_f32_bf16 v22, v36, s41, v22
    v_dot2_f32_bf16 v23, v36, v36, v23
    v_dot2_f32_bf16 v22, v37, s41, v22
    v_dot2_f32_bf16 v23, v37, v37, v23
    v_dot2_f32_bf16 v22, v38, s41, v22
    v_dot2_f32_bf16 v23, v38, v38, v23
    v_dot2_f32_bf16 v22, v39, s41, v22
    v_dot2_f32_bf16 v23, v39, v39, v23
    s_waitcnt vmcnt(3)
    s_barrier
    ds_read_b128 v[32:35], v6 offset:57344
    ds_read_b128 v[36:39], v7 offset:57344
    s_waitcnt lgkmcnt(0)
    v_dot2_f32_bf16 v22, v32, s41, v22
    v_dot2_f32_bf16 v23, v32, v32, v23
    v_dot2_f32_bf16 v22, v33, s41, v22
    v_dot2_f32_bf16 v23, v33, v33, v23
    v_dot2_f32_bf16 v22, v34, s41, v22
    v_dot2_f32_bf16 v23, v34, v34, v23
    v_dot2_f32_bf16 v22, v35, s41, v22
    v_dot2_f32_bf16 v23, v35, v35, v23
    v_dot2_f32_bf16 v22, v36, s41, v22
    v_dot2_f32_bf16 v23, v36, v36, v23
    v_dot2_f32_bf16 v22, v37, s41, v22
    v_dot2_f32_bf16 v23, v37, v37, v23
    v_dot2_f32_bf16 v22, v38, s41, v22
    v_dot2_f32_bf16 v23, v38, v38, v23
    v_dot2_f32_bf16 v22, v39, s41, v22
    v_dot2_f32_bf16 v23, v39, v39, v23
    s_nop 2
    v_add_f32_dpp v22, v22, v22 quad_perm:[1,0,3,2] row_mask:0xf bank_mask:0xf
    v_add_f32_dpp v23, v23, v23 quad_perm:[1,0,3,2] row_mask:0xf bank_mask:0xf
    s_nop 0
    v_add_f32_dpp v22, v22, v22 quad_perm:[2,3,0,1] row_mask:0xf bank_mask:0xf
    v_add_f32_dpp v23, v23, v23 quad_perm:[2,3,0,1] row_mask:0xf bank_mask:0xf
    s_nop 0
    v_mul_f32 v24, 0xbb000000, v22
    v_mul_f32 v23, 0x3b000000, v23
    v_fma_f32 v23, -v24, v24, v23
    v_max_f32 v23, 0, v23
    v_add_f32 v23, 0x3727c5ac, v23
    v_rsq_f32 v25, v23
    v_cvt_pk_bf16_f32 v32, v24, v24
    v_lshlrev_b32 v9, 16, v32
    v_sub_f32 v8, v24, v9
    v_cvt_pk_bf16_f32 v33, v8, 0
    v_mov_b32 v34, 0
    v_mov_b32 v35, 0
    s_mov_b32 exec_lo, 0x33333333
    s_mov_b32 exec_hi, 0x33333333
    ds_write_b128 v20, v[32:35]
    ds_write_b32 v21, v25
    s_mov_b64 exec, -1
    v_mov_b32 v8, 155392
    ds_read_b64 v[10:11], v8
    s_waitcnt lgkmcnt(0)
    v_readfirstlane_b32 s54, v10
    v_readfirstlane_b32 s53, v11
    s_barrier
    s_waitcnt vmcnt(0) lgkmcnt(0)
    s_lshr_b32 s25, s2, 3
    s_and_b32 s26, s2, 7
    s_lshr_b32 s27, s24, 2
    s_and_b32 s28, s24, 3
    v_and_b32 v144, 27, v1
    v_cmp_eq_u32 vcc, 16, v144
    v_mov_b32 v144, 0x3f803f80
    v_mov_b32 v5, 0xdddd
    v_cndmask_b32 v32, 0, v144, vcc
    v_cndmask_b32 v33, 0, v144, vcc
    v_cndmask_b32 v34, 0, v144, vcc
    v_cndmask_b32 v35, 0, v144, vcc
    v_cndmask_b32 v36, 0, v144, vcc
    v_cndmask_b32 v37, 0, v144, vcc
    v_cndmask_b32 v38, 0, v144, vcc
    v_cndmask_b32 v39, 0, v144, vcc
    v_cndmask_b32 v40, 0, v144, vcc
    v_cndmask_b32 v41, 0, v144, vcc
    v_cndmask_b32 v42, 0, v144, vcc
    v_cndmask_b32 v43, 0, v144, vcc
    v_cndmask_b32 v44, 0, v144, vcc
    v_cndmask_b32 v45, 0, v144, vcc
    v_cndmask_b32 v46, 0, v144, vcc
    v_cndmask_b32 v47, 0, v144, vcc
    v_cndmask_b32 v48, 0, v144, vcc
    v_cndmask_b32 v49, 0, v144, vcc
    v_cndmask_b32 v50, 0, v144, vcc
    v_cndmask_b32 v51, 0, v144, vcc
    v_cndmask_b32 v52, 0, v144, vcc
    v_cndmask_b32 v53, 0, v144, vcc
    v_cndmask_b32 v54, 0, v144, vcc
    v_cndmask_b32 v55, 0, v144, vcc
    v_cndmask_b32 v56, 0, v144, vcc
    v_cndmask_b32 v57, 0, v144, vcc
    v_cndmask_b32 v58, 0, v144, vcc
    v_cndmask_b32 v59, 0, v144, vcc
    v_cndmask_b32 v60, 0, v144, vcc
    v_cndmask_b32 v61, 0, v144, vcc
    v_cndmask_b32 v62, 0, v144, vcc
    v_cndmask_b32 v63, 0, v144, vcc
    s_mov_b32 s34, 0x0000ffff
    s_mov_b32 s35, 0x0000ffff
    s_lshl_b32 s30, s27, 16
    v_add_u32 v3, s30, v2
    v_lshrrev_b32 v144, 5, v1
    v_and_b32 v145, 15, v1
    v_lshlrev_b32 v145, 4, v145
    v_lshl_add_u32 v144, v144, 8, v145
    v_add_u32 v4, s30, v144
    s_mul_i32 s30, s24, 3072
    s_add_u32 s30, s30, 131072
    v_add_u32 v6, s30, v2
    s_xor_b32 s31, s24, 4
    s_mul_i32 s30, s31, 3072
    s_add_u32 s30, s30, 131072
    v_add_u32 v7, s30, v2
    s_lshl_b32 s30, s28, 1
    s_add_u32 s30, s30, s27
    s_lshl_b32 s30, s30, 10
    s_add_u32 s30, s30, 131072
    v_add_u32 v146, s30, v2
    v_xor_b32 v147, 1024, v146
    s_lshl_b32 s30, s27, 4
    s_add_u32 s30, s30, 142340
    v_mov_b32 v150, s30
    v_mov_b32 v151, 1
    v_mov_b32 v96, 0
    v_mov_b32 v97, 0
    v_mov_b32 v98, 0
    v_mov_b32 v99, 0
    v_mov_b32 v100, 0
    v_mov_b32 v101, 0
    v_mov_b32 v102, 0
    v_mov_b32 v103, 0
    v_mov_b32 v104, 0
    v_mov_b32 v105, 0
    v_mov_b32 v106, 0
    v_mov_b32 v107, 0
    v_mov_b32 v108, 0
    v_mov_b32 v109, 0
    v_mov_b32 v110, 0
    v_mov_b32 v111, 0
    v_mov_b32 v112, 0
    v_mov_b32 v113, 0
    v_mov_b32 v114, 0
    v_mov_b32 v115, 0
    v_mov_b32 v116, 0
    v_mov_b32 v117, 0
    v_mov_b32 v118, 0
    v_mov_b32 v119, 0
    v_mov_b32 v120, 0
    v_mov_b32 v121, 0
    v_mov_b32 v122, 0
    v_mov_b32 v123, 0
    v_mov_b32 v124, 0
    v_mov_b32 v125, 0
    v_mov_b32 v126, 0
    v_mov_b32 v127, 0
    s_lshl_b32 s57, s26, 2
    s_add_u32 s57, s57, s28
    s_lshl_b32 s55, s57, 8
    s_lshl_b32 s31, s25, 1
    s_add_u32 s31, s31, s27
    s_lshl_b32 s31, s31, 2
    s_add_u32 s55, s55, s31
    s_add_u32 s55, s55, 11534336
    s_lshl_b32 s57, s57, 1
    s_add_u32 s57, s57, s27
    s_mul_i32 s57, s57, 126976
    s_lshl_b32 s31, s25, 10
    s_add_u32 s57, s57, s31
    s_add_u32 s57, s57, 65536
    s_lshl_b32 s40, s26, 9
    s_lshr_b32 s30, s25, 1
    s_lshl_b32 s30, s30, 5
    s_add_u32 s40, s40, s30
    s_add_u32 s40, s40, 11558912
    s_lshl_b32 s36, s26, 2
    s_add_u32 s36, s36, s28
    s_mul_i32 s36, s36, 253952
    s_lshl_b32 s30, s25, 10
    s_add_u32 s37, s36, s30
    s_add_u32 s36, s37, s30
    s_add_u32 s37, s37, 65536
    s_add_u32 s42, s36, 124928
    s_add_u32 s43, s37, 125952
    s_lshr_b32 s38, s28, 1
    s_lshl_b32 s38, s38, 16
    s_and_b32 s30, s28, 1
    s_lshl_b32 s30, s30, 12
    s_add_u32 s38, s38, s30
    s_lshl_b32 s39, s28, 11
    s_add_u32 s39, s39, 131072
    v_lshlrev_b32 v148, 2, v1
    s_mov_b32 s59, 0x40000
    s_mov_b64 exec, 0xff
L_poll_l1:
    buffer_load_dword v149, v148, s[12:15], s40 offen sc1
    s_sub_u32 s59, s59, 1
    s_waitcnt vmcnt(0)
    v_cmp_ne_u32 vcc, s53, v149
    s_cmp_eq_u32 s59, 0
    s_cbranch_scc1 L_poll_l1_x
    s_cbranch_vccnz L_poll_l1
L_poll_l1_x:
    s_mov_b64 exec, -1
    s_mov_b32 m0, s39
    s_nop 0
    buffer_load_dwordx4 v2, s[12:15], s37 offen offset:0 sc1 lds
    buffer_load_dwordx4 v2, s[12:15], s43 offen offset:1024 sc1 lds
    s_mov_b32 m0, s38
    s_nop 0
    buffer_load_dwordx4 v2, s[12:15], s36 offen offset:0 sc1 lds
    buffer_load_dwordx4 v2, s[12:15], s36 offen offset:1024 sc1 lds
    buffer_load_dwordx4 v2, s[12:15], s42 offen offset:2048 sc1 lds
    buffer_load_dwordx4 v2, s[12:15], s42 offen offset:3072 sc1 lds
    s_waitcnt vmcnt(0) lgkmcnt(0)
    s_branch L_p2_b0
L_p1_aux:
    s_setprio 3
    v_lshlrev_b32 v30, 7, v1
    s_lshr_b32 s30, s2, 3
    s_lshl_b32 s30, s30, 11
    v_add_u32 v30, s30, v30
    s_mov_b64 exec, 0xffff
    s_getpc_b64 s[44:45]
L_pc_p1:
    s_add_u32 s44, s44, sequential_preLN__mha_block__glu_gated_glu__prompt_kernel-L_pc_p1
    s_addc_u32 s45, s45, (sequential_preLN__mha_block__glu_gated_glu__prompt_kernel-L_pc_p1)>>32
    v_min_u32 v30, L_code_end-sequential_preLN__mha_block__glu_gated_glu__prompt_kernel-4, v30
    global_load_dword v31, v30, s[44:45]
    s_mov_b64 exec, -1
    s_getreg_b32 s56, hwreg(HW_REG_XCC_ID, 0, 4)
    s_and_b32 s57, s2, 7
    s_lshl_b32 s57, s57, 8
    s_add_u32 s57, s57, 11554816
    s_lshr_b32 s58, s2, 3
    s_lshl_b32 s58, s58, 2
    v_mov_b32 v6, 11563008
    s_waitcnt lgkmcnt(0)
    s_add_u32 s12, s8, 0x00000000
    s_addc_u32 s13, s9, 0
    s_mov_b32 s14, 0x02000000
    s_mov_b32 s15, 0x00020000
    buffer_load_dword v7, v6, s[12:15], 0 offen
    v_mov_b32 v6, s58
    s_barrier
    s_barrier
    s_waitcnt vmcnt(0) lgkmcnt(0)
    v_readfirstlane_b32 s53, v7
    s_nop 3
    s_mul_i32 s53, s53, 1664525
    s_add_u32 s53, s53, 1013904223
    s_lshl_b32 s58, s53, 4
    s_or_b32 s56, s56, s58
    v_mov_b32 v7, s56
    s_mov_b64 exec, 1
    buffer_store_dword v7, v6, s[12:15], s57 offen sc1
    s_mov_b32 exec_lo, -1
    s_mov_b32 exec_hi, 0
    v_lshlrev_b32 v6, 2, v1
    s_barrier
    s_barrier
    s_barrier
    s_barrier
    buffer_load_dword v7, v6, s[12:15], s57 offen sc1
    s_barrier
    s_mov_b32 s59, 0x40000
    s_waitcnt vmcnt(0)
    s_branch L_xt_chk
L_xt_poll:
    buffer_load_dword v7, v6, s[12:15], s57 offen sc1
    s_sub_u32 s59, s59, 1
    s_waitcnt vmcnt(0)
L_xt_chk:
    v_xor_b32 v8, s56, v7
    v_cmp_lt_u32 vcc, 15, v8
    s_cmp_eq_u32 s59, 0
    s_cbranch_scc1 L_xt_done
    s_cbranch_vccnz L_xt_poll
L_xt_done:
    v_cmp_ne_u32 vcc, 0, v8
    s_nop 1
    s_cmp_eq_u64 vcc, 0
    s_cselect_b32 s54, 1, 0
    v_mov_b32 v6, 155392
    v_mov_b32 v8, s54
    v_mov_b32 v9, s53
    ds_write_b64 v6, v[8:9]
    s_waitcnt lgkmcnt(0)
    s_mov_b64 exec, -1
    s_barrier
    s_barrier
    s_barrier
    v_mov_b32 v22, 142340
    v_mov_b32 v23, 0
    ds_write_b32 v22, v23 offset:0
    ds_write_b32 v22, v23 offset:4
    ds_write_b32 v22, v23 offset:8
    ds_write_b32 v22, v23 offset:32
    ds_write_b32 v22, v23 offset:16
    ds_write_b32 v22, v23 offset:20
    ds_write_b32 v22, v23 offset:24
    ds_write_b32 v22, v23 offset:48
    s_lshr_b32 s25, s2, 3
    s_mul_i32 s33, s25, 135424
    s_add_u32 s33, s33, 12582912
    s_lshr_b32 s61, s25, 1
    s_lshl_b32 s61, s61, 10
    s_add_u32 s61, s61, 11567104
    v_lshrrev_b32 v6, 3, v1
    v_lshlrev_b32 v6, 7, v6
    v_and_b32 v7, 7, v1
    v_lshl_add_u32 v6, v7, 2, v6
    s_mov_b64 s[62:63], 0
    s_mov_b32 s59, 0x40000
    s_waitcnt lgkmcnt(0)
    s_barrier
    s_add_u32 s36, s2, 1
    s_and_b32 s36, s36, 7
    s_lshl_b32 s36, s36, 3
    s_bitcmp1_b64 s[62:63], s36
    s_cbranch_scc1 L_g1_have1
L_g1_poll1:
    buffer_load_dword v7, v6, s[12:15], s61 offen sc1
    s_sub_u32 s59, s59, 1
    s_waitcnt vmcnt(0)
    v_cmp_eq_u32 vcc, s53, v7
    s_cmp_eq_u32 s59, 0
    s_cselect_b64 s[62:63], -1, vcc
    s_cselect_b32 s59, 1, s59
    s_lshr_b64 s[34:35], s[62:63], 1
    s_and_b64 s[62:63], s[62:63], s[34:35]
    s_lshr_b64 s[34:35], s[62:63], 2
    s_and_b64 s[62:63], s[62:63], s[34:35]
    s_lshr_b64 s[34:35], s[62:63], 4
    s_and_b64 s[62:63], s[62:63], s[34:35]
    s_bitcmp1_b64 s[62:63], s36
    s_cbranch_scc0 L_g1_poll1
L_g1_have1:
    s_lshl_b32 s36, s36, 11
    s_add_u32 s36, s36, s33
    s_mov_b32 m0, 8192
    s_add_u32 s37, s36, 0
    buffer_load_dwordx4 v2, s[12:15], s37 offen offset:0 sc1 lds
    buffer_load_dwordx4 v2, s[12:15], s37 offen offset:1024 sc1 lds
    buffer_load_dwordx4 v2, s[12:15], s37 offen offset:2048 sc1 lds
    buffer_load_dwordx4 v2, s[12:15], s37 offen offset:3072 sc1 lds
    s_mov_b32 m0, 12288
    s_add_u32 s37, s36, 4096
    buffer_load_dwordx4 v2, s[12:15], s37 offen offset:0 sc1 lds
    buffer_load_dwordx4 v2, s[12:15], s37 offen offset:1024 sc1 lds
    buffer_load_dwordx4 v2, s[12:15], s37 offen offset:2048 sc1 lds
    buffer_load_dwordx4 v2, s[12:15], s37 offen offset:3072 sc1 lds
    s_add_u32 s36, s2, 1
    s_and_b32 s36, s36, 7
    s_lshl_b32 s36, s36, 3
    s_lshl_b32 s36, s36, 11
    s_add_u32 s36, s36, s33
    s_mov_b32 m0, 73728
    s_add_u32 s37, s36, 8192
    buffer_load_dwordx4 v2, s[12:15], s37 offen offset:0 sc1 lds
    buffer_load_dwordx4 v2, s[12:15], s37 offen offset:1024 sc1 lds
    buffer_load_dwordx4 v2, s[12:15], s37 offen offset:2048 sc1 lds
    buffer_load_dwordx4 v2, s[12:15], s37 offen offset:3072 sc1 lds
    s_mov_b32 m0, 77824
    s_add_u32 s37, s36, 12288
    buffer_load_dwordx4 v2, s[12:15], s37 offen offset:0 sc1 lds
    buffer_load_dwordx4 v2, s[12:15], s37 offen offset:1024 sc1 lds
    buffer_load_dwordx4 v2, s[12:15], s37 offen offset:2048 sc1 lds
    buffer_load_dwordx4 v2, s[12:15], s37 offen offset:3072 sc1 lds
    s_add_u32 s36, s2, 2
    s_and_b32 s36, s36, 7
    s_lshl_b32 s36, s36, 3
    s_bitcmp1_b64 s[62:63], s36
    s_cbranch_scc1 L_g1_have2
L_g1_poll2:
    buffer_load_dword v7, v6, s[12:15], s61 offen sc1
    s_sub_u32 s59, s59, 1
    s_waitcnt vmcnt(0)
    v_mov_b32 v23, 1
    ds_write_b32 v22, v23 offset:0
    v_mov_b32 v23, 1
    ds_write_b32 v22, v23 offset:16
    v_cmp_eq_u32 vcc, s53, v7
    s_cmp_eq_u32 s59, 0
    s_cselect_b64 s[62:63], -1, vcc
    s_cselect_b32 s59, 1, s59
    s_lshr_b64 s[34:35], s[62:63], 1
    s_and_b64 s[62:63], s[62:63], s[34:35]
    s_lshr_b64 s[34:35], s[62:63], 2
    s_and_b64 s[62:63], s[62:63], s[34:35]
    s_lshr_b64 s[34:35], s[62:63], 4
    s_and_b64 s[62:63], s[62:63], s[34:35]
    s_bitcmp1_b64 s[62:63], s36
    s_cbranch_scc0 L_g1_poll2
L_g1_have2:
    s_lshl_b32 s36, s36, 11
    s_add_u32 s36, s36, s33
    s_mov_b32 m0, 16384
    s_add_u32 s37, s36, 0
    buffer_load_dwordx4 v2, s[12:15], s37 offen offset:0 sc1 lds
    buffer_load_dwordx4 v2, s[12:15], s37 offen offset:1024 sc1 lds
    buffer_load_dwordx4 v2, s[12:15], s37 offen offset:2048 sc1 lds
    buffer_load_dwordx4 v2, s[12:15], s37 offen offset:3072 sc1 lds
    s_mov_b32 m0, 20480
    s_add_u32 s37, s36, 4096
    buffer_load_dwordx4 v2, s[12:15], s37 offen offset:0 sc1 lds
    buffer_load_dwordx4 v2, s[12:15], s37 offen offset:1024 sc1 lds
    buffer_load_dwordx4 v2, s[12:15], s37 offen offset:2048 sc1 lds
    buffer_load_dwordx4 v2, s[12:15], s37 offen offset:3072 sc1 lds
    s_waitcnt vmcnt(16)
    v_mov_b32 v23, 1
    ds_write_b32 v22, v23 offset:0
    s_add_u32 s36, s2, 2
    s_and_b32 s36, s36, 7
    s_lshl_b32 s36, s36, 3
    s_lshl_b32 s36, s36, 11
    s_add_u32 s36, s36, s33
    s_mov_b32 m0, 81920
    s_add_u32 s37, s36, 8192
    buffer_load_dwordx4 v2, s[12:15], s37 offen offset:0 sc1 lds
    buffer_load_dwordx4 v2, s[12:15], s37 offen offset:1024 sc1 lds
    buffer_load_dwordx4 v2, s[12:15], s37 offen offset:2048 sc1 lds
    buffer_load_dwordx4 v2, s[12:15], s37 offen offset:3072 sc1 lds
    s_mov_b32 m0, 86016
    s_add_u32 s37, s36, 12288
    buffer_load_dwordx4 v2, s[12:15], s37 offen offset:0 sc1 lds
    buffer_load_dwordx4 v2, s[12:15], s37 offen offset:1024 sc1 lds
    buffer_load_dwordx4 v2, s[12:15], s37 offen offset:2048 sc1 lds
    buffer_load_dwordx4 v2, s[12:15], s37 offen offset:3072 sc1 lds
    s_waitcnt vmcnt(16)
    v_mov_b32 v23, 1
    ds_write_b32 v22, v23 offset:16
    s_add_u32 s36, s2, 3
    s_and_b32 s36, s36, 7
    s_lshl_b32 s36, s36, 3
    s_bitcmp1_b64 s[62:63], s36
    s_cbranch_scc1 L_g1_have3
L_g1_poll3:
    buffer_load_dword v7, v6, s[12:15], s61 offen sc1
    s_sub_u32 s59, s59, 1
    s_waitcnt vmcnt(0)
    v_mov_b32 v23, 2
    ds_write_b32 v22, v23 offset:0
    v_mov_b32 v23, 2
    ds_write_b32 v22, v23 offset:16
    v_cmp_eq_u32 vcc, s53, v7
    s_cmp_eq_u32 s59, 0
    s_cselect_b64 s[62:63], -1, vcc
    s_cselect_b32 s59, 1, s59
    s_lshr_b64 s[34:35], s[62:63], 1
    s_and_b64 s[62:63], s[62:63], s[34:35]
    s_lshr_b64 s[34:35], s[62:63], 2
    s_and_b64 s[62:63], s[62:63], s[34:35]
    s_lshr_b64 s[34:35], s[62:63], 4
    s_and_b64 s[62:63], s[62:63], s[34:35]
    s_bitcmp1_b64 s[62:63], s36
    s_cbranch_scc0 L_g1_poll3
L_g1_have3:
    s_lshl_b32 s36, s36, 11
    s_add_u32 s36, s36, s33
    s_mov_b32 m0, 24576
    s_add_u32 s37, s36, 0
    buffer_load_dwordx4 v2, s[12:15], s37 offen offset:0 sc1 lds
    buffer_load_dwordx4 v2, s[12:15], s37 offen offset:1024 sc1 lds
    buffer_load_dwordx4 v2, s[12:15], s37 offen offset:2048 sc1 lds
    buffer_load_dwordx4 v2, s[12:15], s37 offen offset:3072 sc1 lds
    s_mov_b32 m0, 28672
    s_add_u32 s37, s36, 4096
    buffer_load_dwordx4 v2, s[12:15], s37 offen offset:0 sc1 lds
    buffer_load_dwordx4 v2, s[12:15], s37 offen offset:1024 sc1 lds
    buffer_load_dwordx4 v2, s[12:15], s37 offen offset:2048 sc1 lds
    buffer_load_dwordx4 v2, s[12:15], s37 offen offset:3072 sc1 lds
    s_waitcnt vmcnt(16)
    v_mov_b32 v23, 2
    ds_write_b32 v22, v23 offset:0
    s_add_u32 s36, s2, 3
    s_and_b32 s36, s36, 7
    s_lshl_b32 s36, s36, 3
    s_lshl_b32 s36, s36, 11
    s_add_u32 s36, s36, s33
    s_mov_b32 m0, 90112
    s_add_u32 s37, s36, 8192
    buffer_load_dwordx4 v2, s[12:15], s37 offen offset:0 sc1 lds
    buffer_load_dwordx4 v2, s[12:15], s37 offen offset:1024 sc1 lds
    buffer_load_dwordx4 v2, s[12:15], s37 offen offset:2048 sc1 lds
    buffer_load_dwordx4 v2, s[12:15], s37 offen offset:3072 sc1 lds
    s_mov_b32 m0, 94208
    s_add_u32 s37, s36, 12288
    buffer_load_dwordx4 v2, s[12:15], s37 offen offset:0 sc1 lds
    buffer_load_dwordx4 v2, s[12:15], s37 offen offset:1024 sc1 lds
    buffer_load_dwordx4 v2, s[12:15], s37 offen offset:2048 sc1 lds
    buffer_load_dwordx4 v2, s[12:15], s37 offen offset:3072 sc1 lds
    s_waitcnt vmcnt(16)
    v_mov_b32 v23, 2
    ds_write_b32 v22, v23 offset:16
    s_add_u32 s36, s2, 4
    s_and_b32 s36, s36, 7
    s_lshl_b32 s36, s36, 3
    s_bitcmp1_b64 s[62:63], s36
    s_cbranch_scc1 L_g1_have4
L_g1_poll4:
    buffer_load_dword v7, v6, s[12:15], s61 offen sc1
    s_sub_u32 s59, s59, 1
    s_waitcnt vmcnt(0)
    v_mov_b32 v23, 3
    ds_write_b32 v22, v23 offset:0
    v_mov_b32 v23, 3
    ds_write_b32 v22, v23 offset:16
    v_cmp_eq_u32 vcc, s53, v7
    s_cmp_eq_u32 s59, 0
    s_cselect_b64 s[62:63], -1, vcc
    s_cselect_b32 s59, 1, s59
    s_lshr_b64 s[34:35], s[62:63], 1
    s_and_b64 s[62:63], s[62:63], s[34:35]
    s_lshr_b64 s[34:35], s[62:63], 2
    s_and_b64 s[62:63], s[62:63], s[34:35]
    s_lshr_b64 s[34:35], s[62:63], 4
    s_and_b64 s[62:63], s[62:63], s[34:35]
    s_bitcmp1_b64 s[62:63], s36
    s_cbranch_scc0 L_g1_poll4
L_g1_have4:
    s_lshl_b32 s36, s36, 11
    s_add_u32 s36, s36, s33
    s_mov_b32 m0, 32768
    s_add_u32 s37, s36, 0
    buffer_load_dwordx4 v2, s[12:15], s37 offen offset:0 sc1 lds
    buffer_load_dwordx4 v2, s[12:15], s37 offen offset:1024 sc1 lds
    buffer_load_dwordx4 v2, s[12:15], s37 offen offset:2048 sc1 lds
    buffer_load_dwordx4 v2, s[12:15], s37 offen offset:3072 sc1 lds
    s_mov_b32 m0, 36864
    s_add_u32 s37, s36, 4096
    buffer_load_dwordx4 v2, s[12:15], s37 offen offset:0 sc1 lds
    buffer_load_dwordx4 v2, s[12:15], s37 offen offset:1024 sc1 lds
    buffer_load_dwordx4 v2, s[12:15], s37 offen offset:2048 sc1 lds
    buffer_load_dwordx4 v2, s[12:15], s37 offen offset:3072 sc1 lds
    s_waitcnt vmcnt(16)
    v_mov_b32 v23, 3
    ds_write_b32 v22, v23 offset:0
    s_add_u32 s36, s2, 4
    s_and_b32 s36, s36, 7
    s_lshl_b32 s36, s36, 3
    s_lshl_b32 s36, s36, 11
    s_add_u32 s36, s36, s33
    s_mov_b32 m0, 98304
    s_add_u32 s37, s36, 8192
    buffer_load_dwordx4 v2, s[12:15], s37 offen offset:0 sc1 lds
    buffer_load_dwordx4 v2, s[12:15], s37 offen offset:1024 sc1 lds
    buffer_load_dwordx4 v2, s[12:15], s37 offen offset:2048 sc1 lds
    buffer_load_dwordx4 v2, s[12:15], s37 offen offset:3072 sc1 lds
    s_mov_b32 m0, 102400
    s_add_u32 s37, s36, 12288
    buffer_load_dwordx4 v2, s[12:15], s37 offen offset:0 sc1 lds
    buffer_load_dwordx4 v2, s[12:15], s37 offen offset:1024 sc1 lds
    buffer_load_dwordx4 v2, s[12:15], s37 offen offset:2048 sc1 lds
    buffer_load_dwordx4 v2, s[12:15], s37 offen offset:3072 sc1 lds
    s_waitcnt vmcnt(16)
    v_mov_b32 v23, 3
    ds_write_b32 v22, v23 offset:16
    s_add_u32 s36, s2, 5
    s_and_b32 s36, s36, 7
    s_lshl_b32 s36, s36, 3
    s_bitcmp1_b64 s[62:63], s36
    s_cbranch_scc1 L_g1_have5
L_g1_poll5:
    buffer_load_dword v7, v6, s[12:15], s61 offen sc1
    s_sub_u32 s59, s59, 1
    s_waitcnt vmcnt(0)
    v_mov_b32 v23, 4
    ds_write_b32 v22, v23 offset:0
    v_mov_b32 v23, 4
    ds_write_b32 v22, v23 offset:16
    v_cmp_eq_u32 vcc, s53, v7
    s_cmp_eq_u32 s59, 0
    s_cselect_b64 s[62:63], -1, vcc
    s_cselect_b32 s59, 1, s59
    s_lshr_b64 s[34:35], s[62:63], 1
    s_and_b64 s[62:63], s[62:63], s[34:35]
    s_lshr_b64 s[34:35], s[62:63], 2
    s_and_b64 s[62:63], s[62:63], s[34:35]
    s_lshr_b64 s[34:35], s[62:63], 4
    s_and_b64 s[62:63], s[62:63], s[34:35]
    s_bitcmp1_b64 s[62:63], s36
    s_cbranch_scc0 L_g1_poll5
L_g1_have5:
    s_lshl_b32 s36, s36, 11
    s_add_u32 s36, s36, s33
    s_mov_b32 m0, 40960
    s_add_u32 s37, s36, 0
    buffer_load_dwordx4 v2, s[12:15], s37 offen offset:0 sc1 lds
    buffer_load_dwordx4 v2, s[12:15], s37 offen offset:1024 sc1 lds
    buffer_load_dwordx4 v2, s[12:15], s37 offen offset:2048 sc1 lds
    buffer_load_dwordx4 v2, s[12:15], s37 offen offset:3072 sc1 lds
    s_mov_b32 m0, 45056
    s_add_u32 s37, s36, 4096
    buffer_load_dwordx4 v2, s[12:15], s37 offen offset:0 sc1 lds
    buffer_load_dwordx4 v2, s[12:15], s37 offen offset:1024 sc1 lds
    buffer_load_dwordx4 v2, s[12:15], s37 offen offset:2048 sc1 lds
    buffer_load_dwordx4 v2, s[12:15], s37 offen offset:3072 sc1 lds
    s_waitcnt vmcnt(16)
    v_mov_b32 v23, 4
    ds_write_b32 v22, v23 offset:0
    s_add_u32 s36, s2, 5
    s_and_b32 s36, s36, 7
    s_lshl_b32 s36, s36, 3
    s_lshl_b32 s36, s36, 11
    s_add_u32 s36, s36, s33
    s_mov_b32 m0, 106496
    s_add_u32 s37, s36, 8192
    buffer_load_dwordx4 v2, s[12:15], s37 offen offset:0 sc1 lds
    buffer_load_dwordx4 v2, s[12:15], s37 offen offset:1024 sc1 lds
    buffer_load_dwordx4 v2, s[12:15], s37 offen offset:2048 sc1 lds
    buffer_load_dwordx4 v2, s[12:15], s37 offen offset:3072 sc1 lds
    s_mov_b32 m0, 110592
    s_add_u32 s37, s36, 12288
    buffer_load_dwordx4 v2, s[12:15], s37 offen offset:0 sc1 lds
    buffer_load_dwordx4 v2, s[12:15], s37 offen offset:1024 sc1 lds
    buffer_load_dwordx4 v2, s[12:15], s37 offen offset:2048 sc1 lds
    buffer_load_dwordx4 v2, s[12:15], s37 offen offset:3072 sc1 lds
    s_waitcnt vmcnt(16)
    v_mov_b32 v23, 4
    ds_write_b32 v22, v23 offset:16
    s_add_u32 s36, s2, 6
    s_and_b32 s36, s36, 7
    s_lshl_b32 s36, s36, 3
    s_bitcmp1_b64 s[62:63], s36
    s_cbranch_scc1 L_g1_have6
L_g1_poll6:
    buffer_load_dword v7, v6, s[12:15], s61 offen sc1
    s_sub_u32 s59, s59, 1
    s_waitcnt vmcnt(0)
    v_mov_b32 v23, 5
    ds_write_b32 v22, v23 offset:0
    v_mov_b32 v23, 5
    ds_write_b32 v22, v23 offset:16
    v_cmp_eq_u32 vcc, s53, v7
    s_cmp_eq_u32 s59, 0
    s_cselect_b64 s[62:63], -1, vcc
    s_cselect_b32 s59, 1, s59
    s_lshr_b64 s[34:35], s[62:63], 1
    s_and_b64 s[62:63], s[62:63], s[34:35]
    s_lshr_b64 s[34:35], s[62:63], 2
    s_and_b64 s[62:63], s[62:63], s[34:35]
    s_lshr_b64 s[34:35], s[62:63], 4
    s_and_b64 s[62:63], s[62:63], s[34:35]
    s_bitcmp1_b64 s[62:63], s36
    s_cbranch_scc0 L_g1_poll6
L_g1_have6:
    s_lshl_b32 s36, s36, 11
    s_add_u32 s36, s36, s33
    s_mov_b32 m0, 49152
    s_add_u32 s37, s36, 0
    buffer_load_dwordx4 v2, s[12:15], s37 offen offset:0 sc1 lds
    buffer_load_dwordx4 v2, s[12:15], s37 offen offset:1024 sc1 lds
    buffer_load_dwordx4 v2, s[12:15], s37 offen offset:2048 sc1 lds
    buffer_load_dwordx4 v2, s[12:15], s37 offen offset:3072 sc1 lds
    s_mov_b32 m0, 53248
    s_add_u32 s37, s36, 4096
    buffer_load_dwordx4 v2, s[12:15], s37 offen offset:0 sc1 lds
    buffer_load_dwordx4 v2, s[12:15], s37 offen offset:1024 sc1 lds
    buffer_load_dwordx4 v2, s[12:15], s37 offen offset:2048 sc1 lds
    buffer_load_dwordx4 v2, s[12:15], s37 offen offset:3072 sc1 lds
    s_waitcnt vmcnt(16)
    v_mov_b32 v23, 5
    ds_write_b32 v22, v23 offset:0
    s_add_u32 s36, s2, 6
    s_and_b32 s36, s36, 7
    s_lshl_b32 s36, s36, 3
    s_lshl_b32 s36, s36, 11
    s_add_u32 s36, s36, s33
    s_mov_b32 m0, 114688
    s_add_u32 s37, s36, 8192
    buffer_load_dwordx4 v2, s[12:15], s37 offen offset:0 sc1 lds
    buffer_load_dwordx4 v2, s[12:15], s37 offen offset:1024 sc1 lds
    buffer_load_dwordx4 v2, s[12:15], s37 offen offset:2048 sc1 lds
    buffer_load_dwordx4 v2, s[12:15], s37 offen offset:3072 sc1 lds
    s_mov_b32 m0, 118784
    s_add_u32 s37, s36, 12288
    buffer_load_dwordx4 v2, s[12:15], s37 offen offset:0 sc1 lds
    buffer_load_dwordx4 v2, s[12:15], s37 offen offset:1024 sc1 lds
    buffer_load_dwordx4 v2, s[12:15], s37 offen offset:2048 sc1 lds
    buffer_load_dwordx4 v2, s[12:15], s37 offen offset:3072 sc1 lds
    s_waitcnt vmcnt(16)
    v_mov_b32 v23, 5
    ds_write_b32 v22, v23 offset:16
    s_add_u32 s36, s2, 7
    s_and_b32 s36, s36, 7
    s_lshl_b32 s36, s36, 3
    s_bitcmp1_b64 s[62:63], s36
    s_cbranch_scc1 L_g1_have7
L_g1_poll7:
    buffer_load_dword v7, v6, s[12:15], s61 offen sc1
    s_sub_u32 s59, s59, 1
    s_waitcnt vmcnt(0)
    v_mov_b32 v23, 6
    ds_write_b32 v22, v23 offset:0
    v_mov_b32 v23, 6
    ds_write_b32 v22, v23 offset:16
    v_cmp_eq_u32 vcc, s53, v7
    s_cmp_eq_u32 s59, 0
    s_cselect_b64 s[62:63], -1, vcc
    s_cselect_b32 s59, 1, s59
    s_lshr_b64 s[34:35], s[62:63], 1
    s_and_b64 s[62:63], s[62:63], s[34:35]
    s_lshr_b64 s[34:35], s[62:63], 2
    s_and_b64 s[62:63], s[62:63], s[34:35]
    s_lshr_b64 s[34:35], s[62:63], 4
    s_and_b64 s[62:63], s[62:63], s[34:35]
    s_bitcmp1_b64 s[62:63], s36
    s_cbranch_scc0 L_g1_poll7
L_g1_have7:
    s_lshl_b32 s36, s36, 11
    s_add_u32 s36, s36, s33
    s_mov_b32 m0, 57344
    s_add_u32 s37, s36, 0
    buffer_load_dwordx4 v2, s[12:15], s37 offen offset:0 sc1 lds
    buffer_load_dwordx4 v2, s[12:15], s37 offen offset:1024 sc1 lds
    buffer_load_dwordx4 v2, s[12:15], s37 offen offset:2048 sc1 lds
    buffer_load_dwordx4 v2, s[12:15], s37 offen offset:3072 sc1 lds
    s_mov_b32 m0, 61440
    s_add_u32 s37, s36, 4096
    buffer_load_dwordx4 v2, s[12:15], s37 offen offset:0 sc1 lds
    buffer_load_dwordx4 v2, s[12:15], s37 offen offset:1024 sc1 lds
    buffer_load_dwordx4 v2, s[12:15], s37 offen offset:2048 sc1 lds
    buffer_load_dwordx4 v2, s[12:15], s37 offen offset:3072 sc1 lds
    s_waitcnt vmcnt(16)
    v_mov_b32 v23, 6
    ds_write_b32 v22, v23 offset:0
    s_add_u32 s36, s2, 7
    s_and_b32 s36, s36, 7
    s_lshl_b32 s36, s36, 3
    s_lshl_b32 s36, s36, 11
    s_add_u32 s36, s36, s33
    s_mov_b32 m0, 122880
    s_add_u32 s37, s36, 8192
    buffer_load_dwordx4 v2, s[12:15], s37 offen offset:0 sc1 lds
    buffer_load_dwordx4 v2, s[12:15], s37 offen offset:1024 sc1 lds
    buffer_load_dwordx4 v2, s[12:15], s37 offen offset:2048 sc1 lds
    buffer_load_dwordx4 v2, s[12:15], s37 offen offset:3072 sc1 lds
    s_mov_b32 m0, 126976
    s_add_u32 s37, s36, 12288
    buffer_load_dwordx4 v2, s[12:15], s37 offen offset:0 sc1 lds
    buffer_load_dwordx4 v2, s[12:15], s37 offen offset:1024 sc1 lds
    buffer_load_dwordx4 v2, s[12:15], s37 offen offset:2048 sc1 lds
    buffer_load_dwordx4 v2, s[12:15], s37 offen offset:3072 sc1 lds
    s_waitcnt vmcnt(16)
    v_mov_b32 v23, 6
    ds_write_b32 v22, v23 offset:16
    s_add_u32 s36, s2, 8
    s_and_b32 s36, s36, 7
    s_lshl_b32 s36, s36, 3
    s_bitcmp1_b64 s[62:63], s36
    s_cbranch_scc1 L_g1_have8
L_g1_poll8:
    buffer_load_dword v7, v6, s[12:15], s61 offen sc1
    s_sub_u32 s59, s59, 1
    s_waitcnt vmcnt(0)
    v_mov_b32 v23, 7
    ds_write_b32 v22, v23 offset:0
    v_mov_b32 v23, 7
    ds_write_b32 v22, v23 offset:16
    v_cmp_eq_u32 vcc, s53, v7
    s_cmp_eq_u32 s59, 0
    s_cselect_b64 s[62:63], -1, vcc
    s_cselect_b32 s59, 1, s59
    s_lshr_b64 s[34:35], s[62:63], 1
    s_and_b64 s[62:63], s[62:63], s[34:35]
    s_lshr_b64 s[34:35], s[62:63], 2
    s_and_b64 s[62:63], s[62:63], s[34:35]
    s_lshr_b64 s[34:35], s[62:63], 4
    s_and_b64 s[62:63], s[62:63], s[34:35]
    s_bitcmp1_b64 s[62:63], s36
    s_cbranch_scc0 L_g1_poll8
L_g1_have8:
    s_mov_b32 s16, s68
    s_mov_b32 s17, s69
    s_mov_b32 s18, 0x00080000
    s_mov_b32 s19, 0x00020000
    s_mov_b32 s20, s72
    s_mov_b32 s21, s73
    s_mov_b32 s22, 0x00158000
    s_mov_b32 s23, 0x00020000
    s_mov_b32 s48, s74
    s_mov_b32 s49, s75
    s_mov_b32 s50, 0x00158000
    s_mov_b32 s51, 0x00020000
    s_and_b32 s30, s2, 7
    s_lshl_b32 s31, s30, 18
    s_add_u32 s4, s64, s31
    s_addc_u32 s5, s65, 0
    s_mov_b32 s44, s4
    s_mov_b32 s45, s5
    s_mov_b32 s46, 0x00040000
    s_mov_b32 s47, 0x00020000
    s_mul_i32 s30, s30, 176128
    s_add_u32 s10, s76, s30
    s_addc_u32 s11, s77, 0
    s_mov_b32 s40, s10
    s_mov_b32 s41, s11
    s_mov_b32 s42, 0x0002b000
    s_mov_b32 s43, 0x00020000
    s_lshr_b32 s30, s2, 3
    v_lshlrev_b32 v3, 7, v1
    v_lshrrev_b32 v8, 3, v1
    v_and_b32 v9, 7, v1
    v_lshrrev_b32 v10, 2, v1
    v_and_b32 v10, 4, v10
    v_xor_b32 v10, v10, v9
    v_lshlrev_b32 v10, 4, v10
    v_lshl_add_u32 v10, v8, 10, v10
    v_add_u32 v25, 7168, v10
    v_add_u32 v26, 14336, v10
    v_add_u32 v27, 21504, v10
    v_lshrrev_b32 v11, 1, v8
    v_xor_b32 v11, v11, v9
    v_lshlrev_b32 v11, 4, v11
    v_lshl_add_u32 v11, v8, 10, v11
    v_xor_b32 v12, 64, v11
    v_and_b32 v13, 2, v1
    v_lshlrev_b32 v13, 5, v13
    v_sub_u32 v13, 32, v13
    s_lshr_b32 s61, s2, 4
    s_mul_i32 s61, s61, 192
    v_add_u32 v14, 0, v1
    v_mul_u32_u24 v14, 171, v14
    v_lshrrev_b32 v14, 11, v14
    v_mul_u32_u24 v14, 2560, v14
    v_add3_u32 v16, v2, v14, s61
    v_add_u32 v19, v16, v13
    v_add_u32 v14, 64, v1
    v_mul_u32_u24 v14, 171, v14
    v_lshrrev_b32 v14, 11, v14
    v_mul_u32_u24 v14, 2560, v14
    v_add3_u32 v17, v2, v14, s61
    v_add_u32 v20, v17, v13
    v_add_u32 v14, 128, v1
    v_mul_u32_u24 v14, 171, v14
    v_lshrrev_b32 v14, 11, v14
    v_mul_u32_u24 v14, 2560, v14
    v_add3_u32 v18, v2, v14, s61
    v_add_u32 v21, v18, v13
    s_bfe_u32 s60, s2, 0x30003
    s_lshl_b32 s60, s60, 7
    s_waitcnt vmcnt(8)
    v_mov_b32 v23, 7
    ds_write_b32 v22, v23 offset:0
    s_waitcnt vmcnt(0)
    v_mov_b32 v23, 7
    ds_write_b32 v22, v23 offset:16
    s_mul_i32 s31, s2, 5504
    v_add_u32 v4, s31, v3
    s_mov_b32 exec_lo, 0xffffffff
    s_mov_b32 exec_hi, 0x000007ff
    buffer_load_dword v5, v4, s[20:23], 0 offen
    buffer_load_dword v5, v4, s[48:51], 0 offen
    s_mov_b64 exec, -1
    s_mul_i32 s31, s30, 16384
    v_add_u32 v4, s31, v3
    buffer_load_dword v5, v4, s[16:19], 0 offen
    v_add_u32 v4, 0x2000, v4
    buffer_load_dword v5, v4, s[16:19], 0 offen
    s_mul_i32 s31, s30, 8192
    v_add_u32 v4, s31, v3
    buffer_load_dword v5, v4, s[40:43], 0 offen
L_skip_gu:
    s_lshl_b32 s31, s30, 11
    v_add_u32 v4, s31, v3
    s_mov_b64 exec, 0xffff
    s_getpc_b64 s[38:39]
L_pc_p2:
    s_add_u32 s38, s38, L_p2_tail-L_pc_p2
    s_addc_u32 s39, s39, (L_p2_tail-L_pc_p2)>>32
    v_min_u32 v4, L_code_end-L_p2_tail-4, v4
    global_load_dword v5, v4, s[38:39]
    s_mov_b64 exec, -1
    s_mov_b32 s58, 0x100000
L_prog1:
    ds_read_b32 v24, v22 offset:8
    s_sub_u32 s58, s58, 1
    s_waitcnt lgkmcnt(0)
    v_readfirstlane_b32 s37, v24
    s_cmp_eq_u32 s58, 0
    s_cbranch_scc1 L_prog1_x
    s_cmp_ge_u32 s37, 4
    s_cbranch_scc1 L_prog1_x
    s_sleep 3
    s_branch L_prog1
L_prog1_x:
    s_mov_b32 s58, 0x100000
L_prog2:
    ds_read_b32 v24, v22 offset:24
    s_sub_u32 s58, s58, 1
    s_waitcnt lgkmcnt(0)
    v_readfirstlane_b32 s37, v24
    s_cmp_eq_u32 s58, 0
    s_cbranch_scc1 L_prog2_x
    s_cmp_ge_u32 s37, 4
    s_cbranch_scc1 L_prog2_x
    s_sleep 3
    s_branch L_prog2
L_prog2_x:
    s_mov_b32 m0, 0
    s_add_u32 s36, s60, 0
    buffer_load_dwordx4 v10, s[16:19], s36 offen offset:0 lds
    buffer_load_dwordx4 v25, s[16:19], s36 offen offset:1024 lds
    buffer_load_dwordx4 v26, s[16:19], s36 offen offset:2048 lds
    buffer_load_dwordx4 v27, s[16:19], s36 offen offset:3072 lds
    s_mov_b32 m0, 4096
    s_add_u32 s36, s60, 32768
    buffer_load_dwordx4 v10, s[16:19], s36 offen offset:0 lds
    buffer_load_dwordx4 v25, s[16:19], s36 offen offset:1024 lds
    buffer_load_dwordx4 v26, s[16:19], s36 offen offset:2048 lds
    buffer_load_dwordx4 v27, s[16:19], s36 offen offset:3072 lds
    s_mov_b32 m0, 8192
    s_add_u32 s36, s60, 65536
    buffer_load_dwordx4 v10, s[16:19], s36 offen offset:0 lds
    buffer_load_dwordx4 v25, s[16:19], s36 offen offset:1024 lds
    buffer_load_dwordx4 v26, s[16:19], s36 offen offset:2048 lds
    buffer_load_dwordx4 v27, s[16:19], s36 offen offset:3072 lds
    s_mov_b32 m0, 12288
    s_add_u32 s36, s60, 98304
    buffer_load_dwordx4 v10, s[16:19], s36 offen offset:0 lds
    buffer_load_dwordx4 v25, s[16:19], s36 offen offset:1024 lds
    buffer_load_dwordx4 v26, s[16:19], s36 offen offset:2048 lds
    buffer_load_dwordx4 v27, s[16:19], s36 offen offset:3072 lds
    s_waitcnt vmcnt(40)
    s_mov_b32 m0, 16384
    s_add_u32 s36, s60, 131072
    buffer_load_dwordx4 v10, s[16:19], s36 offen offset:0 lds
    buffer_load_dwordx4 v25, s[16:19], s36 offen offset:1024 lds
    buffer_load_dwordx4 v26, s[16:19], s36 offen offset:2048 lds
    buffer_load_dwordx4 v27, s[16:19], s36 offen offset:3072 lds
    s_mov_b32 m0, 20480
    s_add_u32 s36, s60, 163840
    buffer_load_dwordx4 v10, s[16:19], s36 offen offset:0 lds
    buffer_load_dwordx4 v25, s[16:19], s36 offen offset:1024 lds
    buffer_load_dwordx4 v26, s[16:19], s36 offen offset:2048 lds
    buffer_load_dwordx4 v27, s[16:19], s36 offen offset:3072 lds
    s_mov_b32 m0, 24576
    s_add_u32 s36, s60, 196608
    buffer_load_dwordx4 v10, s[16:19], s36 offen offset:0 lds
    buffer_load_dwordx4 v25, s[16:19], s36 offen offset:1024 lds
    buffer_load_dwordx4 v26, s[16:19], s36 offen offset:2048 lds
    buffer_load_dwordx4 v27, s[16:19], s36 offen offset:3072 lds
    s_mov_b32 m0, 28672
    s_add_u32 s36, s60, 229376
    buffer_load_dwordx4 v10, s[16:19], s36 offen offset:0 lds
    buffer_load_dwordx4 v25, s[16:19], s36 offen offset:1024 lds
    buffer_load_dwordx4 v26, s[16:19], s36 offen offset:2048 lds
    buffer_load_dwordx4 v27, s[16:19], s36 offen offset:3072 lds
    s_waitcnt vmcnt(40)
    s_mov_b32 m0, 65536
    s_add_u32 s36, s60, 262144
    buffer_load_dwordx4 v10, s[16:19], s36 offen offset:0 lds
    buffer_load_dwordx4 v25, s[16:19], s36 offen offset:1024 lds
    buffer_load_dwordx4 v26, s[16:19], s36 offen offset:2048 lds
    buffer_load_dwordx4 v27, s[16:19], s36 offen offset:3072 lds
    s_mov_b32 m0, 69632
    s_add_u32 s36, s60, 294912
    buffer_load_dwordx4 v10, s[16:19], s36 offen offset:0 lds
    buffer_load_dwordx4 v25, s[16:19], s36 offen offset:1024 lds
    buffer_load_dwordx4 v26, s[16:19], s36 offen offset:2048 lds
    buffer_load_dwordx4 v27, s[16:19], s36 offen offset:3072 lds
    s_mov_b32 m0, 73728
    s_add_u32 s36, s60, 327680
    buffer_load_dwordx4 v10, s[16:19], s36 offen offset:0 lds
    buffer_load_dwordx4 v25, s[16:19], s36 offen offset:1024 lds
    buffer_load_dwordx4 v26, s[16:19], s36 offen offset:2048 lds
    buffer_load_dwordx4 v27, s[16:19], s36 offen offset:3072 lds
    s_mov_b32 m0, 77824
    s_add_u32 s36, s60, 360448
    buffer_load_dwordx4 v10, s[16:19], s36 offen offset:0 lds
    buffer_load_dwordx4 v25, s[16:19], s36 offen offset:1024 lds
    buffer_load_dwordx4 v26, s[16:19], s36 offen offset:2048 lds
    buffer_load_dwordx4 v27, s[16:19], s36 offen offset:3072 lds
    s_waitcnt vmcnt(40)
    s_mov_b32 m0, 81920
    s_add_u32 s36, s60, 393216
    buffer_load_dwordx4 v10, s[16:19], s36 offen offset:0 lds
    buffer_load_dwordx4 v25, s[16:19], s36 offen offset:1024 lds
    buffer_load_dwordx4 v26, s[16:19], s36 offen offset:2048 lds
    buffer_load_dwordx4 v27, s[16:19], s36 offen offset:3072 lds
    s_mov_b32 m0, 86016
    s_add_u32 s36, s60, 425984
    buffer_load_dwordx4 v10, s[16:19], s36 offen offset:0 lds
    buffer_load_dwordx4 v25, s[16:19], s36 offen offset:1024 lds
    buffer_load_dwordx4 v26, s[16:19], s36 offen offset:2048 lds
    buffer_load_dwordx4 v27, s[16:19], s36 offen offset:3072 lds
    s_mov_b32 m0, 90112
    s_add_u32 s36, s60, 458752
    buffer_load_dwordx4 v10, s[16:19], s36 offen offset:0 lds
    buffer_load_dwordx4 v25, s[16:19], s36 offen offset:1024 lds
    buffer_load_dwordx4 v26, s[16:19], s36 offen offset:2048 lds
    buffer_load_dwordx4 v27, s[16:19], s36 offen offset:3072 lds
    s_mov_b32 m0, 94208
    s_add_u32 s36, s60, 491520
    buffer_load_dwordx4 v10, s[16:19], s36 offen offset:0 lds
    buffer_load_dwordx4 v25, s[16:19], s36 offen offset:1024 lds
    buffer_load_dwordx4 v26, s[16:19], s36 offen offset:2048 lds
    buffer_load_dwordx4 v27, s[16:19], s36 offen offset:3072 lds
    s_waitcnt vmcnt(40)
    ds_read_b32 v24, v22 offset:48
    s_waitcnt lgkmcnt(0)
    v_readfirstlane_b32 s37, v24
    s_nop 0
    s_cmp_ge_u32 s37, 4
    s_cbranch_scc1 L_skip_rt
    s_and_b32 s36, s2, 7
    s_lshl_b32 s36, s36, 3
    s_lshr_b32 s31, s30, 2
    s_add_u32 s36, s36, s31
    s_mul_i32 s36, s36, 126976
    s_and_b32 s31, s30, 3
    s_lshl_b32 s31, s31, 13
    s_add_u32 s36, s36, s31
    s_add_u32 s37, s36, 65536
    buffer_load_dword v5, v3, s[12:15], s37 offen
    buffer_load_dword v5, v3, s[12:15], s36 offen
L_skip_rt:
    s_cmp_ge_u32 s2, 240
    s_cbranch_scc1 L_pre_end
    s_mov_b32 s58, 0x100000
L_prog3:
    ds_read_b32 v24, v22 offset:32
    s_sub_u32 s58, s58, 1
    s_waitcnt lgkmcnt(0)
    v_readfirstlane_b32 s37, v24
    s_cmp_eq_u32 s58, 0
    s_cbranch_scc1 L_prog3_x
    s_cmp_ge_u32 s37, 4
    s_cbranch_scc1 L_prog3_x
    s_sleep 3
    s_branch L_prog3
L_prog3_x:
    s_mov_b32 s58, 0x100000
L_prog4:
    ds_read_b32 v24, v22 offset:48
    s_sub_u32 s58, s58, 1
    s_waitcnt lgkmcnt(0)
    v_readfirstlane_b32 s37, v24
    s_cmp_eq_u32 s58, 0
    s_cbranch_scc1 L_prog4_x
    s_cmp_ge_u32 s37, 4
    s_cbranch_scc1 L_prog4_x
    s_sleep 3
    s_branch L_prog4
L_prog4_x:
    s_mov_b32 m0, 32768
    s_mov_b32 s36, 0
    buffer_load_dwordx4 v16, s[20:23], s36 offen offset:0 lds
    buffer_load_dwordx4 v17, s[20:23], s36 offen offset:1024 lds
    buffer_load_dwordx4 v18, s[20:23], s36 offen offset:2048 lds
    s_mov_b32 m0, 35840
    s_mov_b32 s36, 0
    buffer_load_dwordx4 v19, s[48:51], s36 offen offset:0 lds
    buffer_load_dwordx4 v20, s[48:51], s36 offen offset:1024 lds
    buffer_load_dwordx4 v21, s[48:51], s36 offen offset:2048 lds
    s_mov_b32 m0, 38912
    s_mov_b32 s36, 44032
    buffer_load_dwordx4 v16, s[20:23], s36 offen offset:0 lds
    buffer_load_dwordx4 v17, s[20:23], s36 offen offset:1024 lds
    buffer_load_dwordx4 v18, s[20:23], s36 offen offset:2048 lds
    s_mov_b32 m0, 41984
    s_mov_b32 s36, 44032
    buffer_load_dwordx4 v19, s[48:51], s36 offen offset:0 lds
    buffer_load_dwordx4 v20, s[48:51], s36 offen offset:1024 lds
    buffer_load_dwordx4 v21, s[48:51], s36 offen offset:2048 lds
    s_waitcnt vmcnt(40)
    s_mov_b32 m0, 45056
    s_mov_b32 s36, 88064
    buffer_load_dwordx4 v16, s[20:23], s36 offen offset:0 lds
    buffer_load_dwordx4 v17, s[20:23], s36 offen offset:1024 lds
    buffer_load_dwordx4 v18, s[20:23], s36 offen offset:2048 lds
    s_mov_b32 m0, 48128
    s_mov_b32 s36, 88064
    buffer_load_dwordx4 v19, s[48:51], s36 offen offset:0 lds
    buffer_load_dwordx4 v20, s[48:51], s36 offen offset:1024 lds
    buffer_load_dwordx4 v21, s[48:51], s36 offen offset:2048 lds
    s_mov_b32 m0, 51200
    s_mov_b32 s36, 132096
    buffer_load_dwordx4 v16, s[20:23], s36 offen offset:0 lds
    buffer_load_dwordx4 v17, s[20:23], s36 offen offset:1024 lds
    buffer_load_dwordx4 v18, s[20:23], s36 offen offset:2048 lds
    s_mov_b32 m0, 54272
    s_mov_b32 s36, 132096
    buffer_load_dwordx4 v19, s[48:51], s36 offen offset:0 lds
    buffer_load_dwordx4 v20, s[48:51], s36 offen offset:1024 lds
    buffer_load_dwordx4 v21, s[48:51], s36 offen offset:2048 lds
    s_waitcnt vmcnt(40)
    s_mov_b32 m0, 98304
    s_mov_b32 s36, 176128
    buffer_load_dwordx4 v16, s[20:23], s36 offen offset:0 lds
    buffer_load_dwordx4 v17, s[20:23], s36 offen offset:1024 lds
    buffer_load_dwordx4 v18, s[20:23], s36 offen offset:2048 lds
    s_mov_b32 m0, 101376
    s_mov_b32 s36, 176128
    buffer_load_dwordx4 v19, s[48:51], s36 offen offset:0 lds
    buffer_load_dwordx4 v20, s[48:51], s36 offen offset:1024 lds
    buffer_load_dwordx4 v21, s[48:51], s36 offen offset:2048 lds
    s_mov_b32 m0, 104448
    s_mov_b32 s36, 220160
    buffer_load_dwordx4 v16, s[20:23], s36 offen offset:0 lds
    buffer_load_dwordx4 v17, s[20:23], s36 offen offset:1024 lds
    buffer_load_dwordx4 v18, s[20:23], s36 offen offset:2048 lds
    s_mov_b32 m0, 107520
    s_mov_b32 s36, 220160
    buffer_load_dwordx4 v19, s[48:51], s36 offen offset:0 lds
    buffer_load_dwordx4 v20, s[48:51], s36 offen offset:1024 lds
    buffer_load_dwordx4 v21, s[48:51], s36 offen offset:2048 lds
    s_waitcnt vmcnt(40)
    s_mov_b32 m0, 110592
    s_mov_b32 s36, 264192
    buffer_load_dwordx4 v16, s[20:23], s36 offen offset:0 lds
    buffer_load_dwordx4 v17, s[20:23], s36 offen offset:1024 lds
    buffer_load_dwordx4 v18, s[20:23], s36 offen offset:2048 lds
    s_mov_b32 m0, 113664
    s_mov_b32 s36, 264192
    buffer_load_dwordx4 v19, s[48:51], s36 offen offset:0 lds
    buffer_load_dwordx4 v20, s[48:51], s36 offen offset:1024 lds
    buffer_load_dwordx4 v21, s[48:51], s36 offen offset:2048 lds
    s_mov_b32 m0, 116736
    s_mov_b32 s36, 308224
    buffer_load_dwordx4 v16, s[20:23], s36 offen offset:0 lds
    buffer_load_dwordx4 v17, s[20:23], s36 offen offset:1024 lds
    buffer_load_dwordx4 v18, s[20:23], s36 offen offset:2048 lds
    s_mov_b32 m0, 119808
    s_mov_b32 s36, 308224
    buffer_load_dwordx4 v19, s[48:51], s36 offen offset:0 lds
    buffer_load_dwordx4 v20, s[48:51], s36 offen offset:1024 lds
    buffer_load_dwordx4 v21, s[48:51], s36 offen offset:2048 lds
    s_waitcnt vmcnt(40)
L_pre_end:
    s_waitcnt vmcnt(0)
    s_endpgm
L_p1_odd:
    s_waitcnt lgkmcnt(4)
    v_mfma_f32_32x32x16_bf16 v[104:119], v[40:43], v[32:35], 0
    ds_read_b128 v[36:39], v4 offset:0
    ds_read_b64_tr_b16 v[52:53], v23 offset:6144
    ds_read_b64_tr_b16 v[54:55], v23 offset:6656
    s_waitcnt lgkmcnt(5)
    v_mfma_f32_32x32x16_bf16 v[120:135], v[44:47], v[32:35], 0
    ds_read_b64_tr_b16 v[56:57], v23 offset:7168
    ds_read_b64_tr_b16 v[58:59], v23 offset:7680
    s_waitcnt lgkmcnt(5)
    v_mfma_f32_32x32x16_bf16 v[136:151], v[32:35], v[48:51], 0
    ds_read_b64_tr_b16 v[60:61], v23 offset:8192
    ds_read_b64_tr_b16 v[62:63], v23 offset:8704
    s_waitcnt lgkmcnt(0)
    s_barrier
    v_mfma_f32_16x16x32_bf16 v[64:67], v[52:55], v[76:79], v[64:67]
    v_mfma_f32_32x32x16_bf16 v[104:119], v[52:55], v[36:39], v[104:119]
    ds_read_b128 v[32:35], v5 offset:0
    ds_read_b64_tr_b16 v[40:41], v23 offset:12288
    ds_read_b64_tr_b16 v[42:43], v23 offset:12800
    v_mfma_f32_16x16x32_bf16 v[68:71], v[56:59], v[76:79], v[68:71]
    v_mfma_f32_32x32x16_bf16 v[120:135], v[56:59], v[36:39], v[120:135]
    ds_read_b64_tr_b16 v[44:45], v23 offset:13312
    ds_read_b64_tr_b16 v[46:47], v23 offset:13824
    v_mfma_f32_16x16x32_bf16 v[72:75], v[60:63], v[76:79], v[72:75]
    v_mfma_f32_32x32x16_bf16 v[136:151], v[36:39], v[60:63], v[136:151]
    ds_read_b64_tr_b16 v[48:49], v23 offset:14336
    ds_read_b64_tr_b16 v[50:51], v23 offset:14848
    s_waitcnt lgkmcnt(4)
    v_mfma_f32_32x32x16_bf16 v[104:119], v[40:43], v[32:35], v[104:119]
    ds_read_b128 v[36:39], v6 offset:0
    ds_read_b64_tr_b16 v[52:53], v23 offset:18432
    ds_read_b64_tr_b16 v[54:55], v23 offset:18944
    s_waitcnt lgkmcnt(5)
    v_mfma_f32_32x32x16_bf16 v[120:135], v[44:47], v[32:35], v[120:135]
    ds_read_b64_tr_b16 v[56:57], v23 offset:19456
    ds_read_b64_tr_b16 v[58:59], v23 offset:19968
    s_waitcnt lgkmcnt(5)
    v_mfma_f32_32x32x16_bf16 v[136:151], v[32:35], v[48:51], v[136:151]
    ds_read_b64_tr_b16 v[60:61], v23 offset:20480
    ds_read_b64_tr_b16 v[62:63], v23 offset:20992
    s_waitcnt lgkmcnt(0)
    s_barrier
    v_mfma_f32_16x16x32_bf16 v[64:67], v[52:55], v[76:79], v[64:67]
    v_mfma_f32_32x32x16_bf16 v[104:119], v[52:55], v[36:39], v[104:119]
    ds_read_b128 v[32:35], v3 offset:8192
    ds_read_b64_tr_b16 v[40:41], v23 offset:24576
    ds_read_b64_tr_b16 v[42:43], v23 offset:25088
    v_mfma_f32_16x16x32_bf16 v[68:71], v[56:59], v[76:79], v[68:71]
    v_mfma_f32_32x32x16_bf16 v[120:135], v[56:59], v[36:39], v[120:135]
    ds_read_b64_tr_b16 v[44:45], v23 offset:25600
    ds_read_b64_tr_b16 v[46:47], v23 offset:26112
    v_mfma_f32_16x16x32_bf16 v[72:75], v[60:63], v[76:79], v[72:75]
    v_mfma_f32_32x32x16_bf16 v[136:151], v[36:39], v[60:63], v[136:151]
    ds_read_b64_tr_b16 v[48:49], v23 offset:26624
    ds_read_b64_tr_b16 v[50:51], v23 offset:27136
    s_waitcnt lgkmcnt(4)
    v_mfma_f32_32x32x16_bf16 v[104:119], v[40:43], v[32:35], v[104:119]
    ds_read_b128 v[36:39], v4 offset:8192
    ds_read_b64_tr_b16 v[52:53], v23 offset:30720
    ds_read_b64_tr_b16 v[54:55], v23 offset:31232
    s_waitcnt lgkmcnt(5)
    v_mfma_f32_32x32x16_bf16 v[120:135], v[44:47], v[32:35], v[120:135]
    ds_read_b64_tr_b16 v[56:57], v23 offset:31744
    ds_read_b64_tr_b16 v[58:59], v23 offset:32256
    s_waitcnt lgkmcnt(5)
    v_mfma_f32_32x32x16_bf16 v[136:151], v[32:35], v[48:51], v[136:151]
    ds_read_b64_tr_b16 v[60:61], v23 offset:32768
    ds_read_b64_tr_b16 v[62:63], v23 offset:33280
    s_waitcnt lgkmcnt(4)
    v_mfma_f32_16x16x32_bf16 v[64:67], v[52:55], v[76:79], v[64:67]
    v_mfma_f32_32x32x16_bf16 v[104:119], v[52:55], v[36:39], v[104:119]
    ds_read_b128 v[32:35], v5 offset:8192
    ds_read_b64_tr_b16 v[40:41], v23 offset:36864
    ds_read_b64_tr_b16 v[42:43], v23 offset:37376
    s_waitcnt lgkmcnt(5)
    v_mfma_f32_16x16x32_bf16 v[68:71], v[56:59], v[76:79], v[68:71]
    v_mfma_f32_32x32x16_bf16 v[120:135], v[56:59], v[36:39], v[120:135]
    ds_read_b64_tr_b16 v[44:45], v23 offset:37888
    ds_read_b64_tr_b16 v[46:47], v23 offset:38400
    s_waitcnt lgkmcnt(5)
    v_mfma_f32_16x16x32_bf16 v[72:75], v[60:63], v[76:79], v[72:75]
    v_mfma_f32_32x32x16_bf16 v[136:151], v[36:39], v[60:63], v[136:151]
    ds_read_b64_tr_b16 v[48:49], v23 offset:38912
    ds_read_b64_tr_b16 v[50:51], v23 offset:39424
    s_waitcnt lgkmcnt(4)
    v_mfma_f32_32x32x16_bf16 v[104:119], v[40:43], v[32:35], v[104:119]
    ds_read_b128 v[36:39], v6 offset:8192
    ds_read_b64_tr_b16 v[52:53], v23 offset:43008
    ds_read_b64_tr_b16 v[54:55], v23 offset:43520
    s_waitcnt lgkmcnt(5)
    v_mfma_f32_32x32x16_bf16 v[120:135], v[44:47], v[32:35], v[120:135]
    ds_read_b64_tr_b16 v[56:57], v23 offset:44032
    ds_read_b64_tr_b16 v[58:59], v23 offset:44544
    s_waitcnt lgkmcnt(5)
    v_mfma_f32_32x32x16_bf16 v[136:151], v[32:35], v[48:51], v[136:151]
    ds_read_b64_tr_b16 v[60:61], v23 offset:45056
    ds_read_b64_tr_b16 v[62:63], v23 offset:45568
    s_waitcnt lgkmcnt(0)
    s_barrier
    v_mfma_f32_16x16x32_bf16 v[64:67], v[52:55], v[76:79], v[64:67]
    v_mfma_f32_32x32x16_bf16 v[104:119], v[52:55], v[36:39], v[104:119]
    ds_read_b128 v[32:35], v3 offset:16384
    ds_read_b64_tr_b16 v[40:41], v23 offset:49152
    ds_read_b64_tr_b16 v[42:43], v23 offset:49664
    v_mfma_f32_16x16x32_bf16 v[68:71], v[56:59], v[76:79], v[68:71]
    v_mfma_f32_32x32x16_bf16 v[120:135], v[56:59], v[36:39], v[120:135]
    ds_read_b64_tr_b16 v[44:45], v23 offset:50176
    ds_read_b64_tr_b16 v[46:47], v23 offset:50688
    v_mfma_f32_16x16x32_bf16 v[72:75], v[60:63], v[76:79], v[72:75]
    v_mfma_f32_32x32x16_bf16 v[136:151], v[36:39], v[60:63], v[136:151]
    ds_read_b64_tr_b16 v[48:49], v23 offset:51200
    ds_read_b64_tr_b16 v[50:51], v23 offset:51712
    s_waitcnt lgkmcnt(4)
    v_mfma_f32_32x32x16_bf16 v[104:119], v[40:43], v[32:35], v[104:119]
    ds_read_b128 v[36:39], v4 offset:16384
    ds_read_b64_tr_b16 v[52:53], v23 offset:55296
    ds_read_b64_tr_b16 v[54:55], v23 offset:55808
    s_waitcnt lgkmcnt(5)
    v_mfma_f32_32x32x16_bf16 v[120:135], v[44:47], v[32:35], v[120:135]
    ds_read_b64_tr_b16 v[56:57], v23 offset:56320
    ds_read_b64_tr_b16 v[58:59], v23 offset:56832
    s_waitcnt lgkmcnt(5)
    v_mfma_f32_32x32x16_bf16 v[136:151], v[32:35], v[48:51], v[136:151]
    ds_read_b64_tr_b16 v[60:61], v23 offset:57344
    ds_read_b64_tr_b16 v[62:63], v23 offset:57856
    s_waitcnt lgkmcnt(4)
    v_mfma_f32_16x16x32_bf16 v[64:67], v[52:55], v[76:79], v[64:67]
    v_mfma_f32_32x32x16_bf16 v[104:119], v[52:55], v[36:39], v[104:119]
    ds_read_b128 v[32:35], v5 offset:16384
    ds_read_b64_tr_b16 v[40:41], v23 offset:61440
    ds_read_b64_tr_b16 v[42:43], v23 offset:61952
    s_waitcnt lgkmcnt(5)
    v_mfma_f32_16x16x32_bf16 v[68:71], v[56:59], v[76:79], v[68:71]
    v_mfma_f32_32x32x16_bf16 v[120:135], v[56:59], v[36:39], v[120:135]
    ds_read_b64_tr_b16 v[44:45], v23 offset:62464
    ds_read_b64_tr_b16 v[46:47], v23 offset:62976
    s_waitcnt lgkmcnt(5)
    v_mfma_f32_16x16x32_bf16 v[72:75], v[60:63], v[76:79], v[72:75]
    v_mfma_f32_32x32x16_bf16 v[136:151], v[36:39], v[60:63], v[136:151]
    ds_read_b64_tr_b16 v[48:49], v23 offset:63488
    ds_read_b64_tr_b16 v[50:51], v23 offset:64000
    s_waitcnt lgkmcnt(4)
    v_mfma_f32_32x32x16_bf16 v[104:119], v[40:43], v[32:35], v[104:119]
    ds_read_b128 v[36:39], v6 offset:16384
    ds_read_b64_tr_b16 v[52:53], v24 offset:2048
    ds_read_b64_tr_b16 v[54:55], v24 offset:2560
    s_waitcnt lgkmcnt(5)
    v_mfma_f32_32x32x16_bf16 v[120:135], v[44:47], v[32:35], v[120:135]
    ds_read_b64_tr_b16 v[56:57], v24 offset:3072
    ds_read_b64_tr_b16 v[58:59], v24 offset:3584
    s_waitcnt lgkmcnt(5)
    v_mfma_f32_32x32x16_bf16 v[136:151], v[32:35], v[48:51], v[136:151]
    ds_read_b64_tr_b16 v[60:61], v24 offset:4096
    ds_read_b64_tr_b16 v[62:63], v24 offset:4608
    s_waitcnt lgkmcnt(0)
    s_barrier
    v_mfma_f32_16x16x32_bf16 v[64:67], v[52:55], v[76:79], v[64:67]
    v_mfma_f32_32x32x16_bf16 v[104:119], v[52:55], v[36:39], v[104:119]
    ds_read_b128 v[32:35], v3 offset:24576
    ds_read_b64_tr_b16 v[40:41], v24 offset:8192
    ds_read_b64_tr_b16 v[42:43], v24 offset:8704
    v_mfma_f32_16x16x32_bf16 v[68:71], v[56:59], v[76:79], v[68:71]
    v_mfma_f32_32x32x16_bf16 v[120:135], v[56:59], v[36:39], v[120:135]
    ds_read_b64_tr_b16 v[44:45], v24 offset:9216
    ds_read_b64_tr_b16 v[46:47], v24 offset:9728
    v_mfma_f32_16x16x32_bf16 v[72:75], v[60:63], v[76:79], v[72:75]
    v_mfma_f32_32x32x16_bf16 v[136:151], v[36:39], v[60:63], v[136:151]
    ds_read_b64_tr_b16 v[48:49], v24 offset:10240
    ds_read_b64_tr_b16 v[50:51], v24 offset:10752
    s_waitcnt lgkmcnt(4)
    v_mfma_f32_32x32x16_bf16 v[104:119], v[40:43], v[32:35], v[104:119]
    ds_read_b128 v[36:39], v4 offset:24576
    ds_read_b64_tr_b16 v[52:53], v24 offset:14336
    ds_read_b64_tr_b16 v[54:55], v24 offset:14848
    s_waitcnt lgkmcnt(5)
    v_mfma_f32_32x32x16_bf16 v[120:135], v[44:47], v[32:35], v[120:135]
    ds_read_b64_tr_b16 v[56:57], v24 offset:15360
    ds_read_b64_tr_b16 v[58:59], v24 offset:15872
    s_waitcnt lgkmcnt(5)
    v_mfma_f32_32x32x16_bf16 v[136:151], v[32:35], v[48:51], v[136:151]
    ds_read_b64_tr_b16 v[60:61], v24 offset:16384
    ds_read_b64_tr_b16 v[62:63], v24 offset:16896
    s_waitcnt lgkmcnt(4)
    v_mfma_f32_16x16x32_bf16 v[64:67], v[52:55], v[76:79], v[64:67]
    v_mfma_f32_32x32x16_bf16 v[104:119], v[52:55], v[36:39], v[104:119]
    ds_read_b128 v[32:35], v5 offset:24576
    ds_read_b64_tr_b16 v[40:41], v23 offset:0
    ds_read_b64_tr_b16 v[42:43], v23 offset:512
    s_waitcnt lgkmcnt(5)
    v_mfma_f32_16x16x32_bf16 v[68:71], v[56:59], v[76:79], v[68:71]
    v_mfma_f32_32x32x16_bf16 v[120:135], v[56:59], v[36:39], v[120:135]
    ds_read_b64_tr_b16 v[44:45], v23 offset:1024
    ds_read_b64_tr_b16 v[46:47], v23 offset:1536
    s_waitcnt lgkmcnt(5)
    v_mfma_f32_16x16x32_bf16 v[72:75], v[60:63], v[76:79], v[72:75]
    v_mfma_f32_32x32x16_bf16 v[136:151], v[36:39], v[60:63], v[136:151]
    ds_read_b64_tr_b16 v[48:49], v23 offset:2048
    ds_read_b64_tr_b16 v[50:51], v23 offset:2560
    s_waitcnt lgkmcnt(4)
    v_mfma_f32_32x32x16_bf16 v[104:119], v[40:43], v[32:35], v[104:119]
    ds_read_b128 v[36:39], v6 offset:24576
    ds_read_b64_tr_b16 v[52:53], v23 offset:6144
    ds_read_b64_tr_b16 v[54:55], v23 offset:6656
    s_waitcnt lgkmcnt(5)
    v_mfma_f32_32x32x16_bf16 v[120:135], v[44:47], v[32:35], v[120:135]
    ds_read_b64_tr_b16 v[56:57], v23 offset:7168
    ds_read_b64_tr_b16 v[58:59], v23 offset:7680
    s_waitcnt lgkmcnt(5)
    v_mfma_f32_32x32x16_bf16 v[136:151], v[32:35], v[48:51], v[136:151]
    ds_read_b64_tr_b16 v[60:61], v23 offset:8192
    ds_read_b64_tr_b16 v[62:63], v23 offset:8704
    s_waitcnt lgkmcnt(0)
    s_barrier
    v_mfma_f32_16x16x32_bf16 v[64:67], v[52:55], v[76:79], v[64:67]
    v_mfma_f32_32x32x16_bf16 v[104:119], v[52:55], v[36:39], v[104:119]
    ds_read_b128 v[32:35], v3 offset:32768
    ds_read_b64_tr_b16 v[40:41], v23 offset:12288
    ds_read_b64_tr_b16 v[42:43], v23 offset:12800
    v_mfma_f32_16x16x32_bf16 v[68:71], v[56:59], v[76:79], v[68:71]
    v_mfma_f32_32x32x16_bf16 v[120:135], v[56:59], v[36:39], v[120:135]
    ds_read_b64_tr_b16 v[44:45], v23 offset:13312
    ds_read_b64_tr_b16 v[46:47], v23 offset:13824
    v_mfma_f32_16x16x32_bf16 v[72:75], v[60:63], v[76:79], v[72:75]
    v_mfma_f32_32x32x16_bf16 v[136:151], v[36:39], v[60:63], v[136:151]
    ds_read_b64_tr_b16 v[48:49], v23 offset:14336
    ds_read_b64_tr_b16 v[50:51], v23 offset:14848
    s_waitcnt lgkmcnt(4)
    v_mfma_f32_32x32x16_bf16 v[104:119], v[40:43], v[32:35], v[104:119]
    ds_read_b128 v[36:39], v4 offset:32768
    ds_read_b64_tr_b16 v[52:53], v23 offset:18432
    ds_read_b64_tr_b16 v[54:55], v23 offset:18944
    s_waitcnt lgkmcnt(5)
    v_mfma_f32_32x32x16_bf16 v[120:135], v[44:47], v[32:35], v[120:135]
    ds_read_b64_tr_b16 v[56:57], v23 offset:19456
    ds_read_b64_tr_b16 v[58:59], v23 offset:19968
    s_waitcnt lgkmcnt(5)
    v_mfma_f32_32x32x16_bf16 v[136:151], v[32:35], v[48:51], v[136:151]
    ds_read_b64_tr_b16 v[60:61], v23 offset:20480
    ds_read_b64_tr_b16 v[62:63], v23 offset:20992
    s_waitcnt lgkmcnt(4)
    v_mfma_f32_16x16x32_bf16 v[64:67], v[52:55], v[76:79], v[64:67]
    v_mfma_f32_32x32x16_bf16 v[104:119], v[52:55], v[36:39], v[104:119]
    ds_read_b128 v[32:35], v5 offset:32768
    ds_read_b64_tr_b16 v[40:41], v23 offset:24576
    ds_read_b64_tr_b16 v[42:43], v23 offset:25088
    s_waitcnt lgkmcnt(5)
    v_mfma_f32_16x16x32_bf16 v[68:71], v[56:59], v[76:79], v[68:71]
    v_mfma_f32_32x32x16_bf16 v[120:135], v[56:59], v[36:39], v[120:135]
    ds_read_b64_tr_b16 v[44:45], v23 offset:25600
    ds_read_b64_tr_b16 v[46:47], v23 offset:26112
    s_waitcnt lgkmcnt(5)
    v_mfma_f32_16x16x32_bf16 v[72:75], v[60:63], v[76:79], v[72:75]
    v_mfma_f32_32x32x16_bf16 v[136:151], v[36:39], v[60:63], v[136:151]
    ds_read_b64_tr_b16 v[48:49], v23 offset:26624
    ds_read_b64_tr_b16 v[50:51], v23 offset:27136
    s_waitcnt lgkmcnt(4)
    v_mfma_f32_32x32x16_bf16 v[104:119], v[40:43], v[32:35], v[104:119]
    ds_read_b128 v[36:39], v6 offset:32768
    ds_read_b64_tr_b16 v[52:53], v23 offset:30720
    ds_read_b64_tr_b16 v[54:55], v23 offset:31232
    s_waitcnt lgkmcnt(5)
    v_mfma_f32_32x32x16_bf16 v[120:135], v[44:47], v[32:35], v[120:135]
    ds_read_b64_tr_b16 v[56:57], v23 offset:31744
    ds_read_b64_tr_b16 v[58:59], v23 offset:32256
    s_waitcnt lgkmcnt(5)
    v_mfma_f32_32x32x16_bf16 v[136:151], v[32:35], v[48:51], v[136:151]
    ds_read_b64_tr_b16 v[60:61], v23 offset:32768
    ds_read_b64_tr_b16 v[62:63], v23 offset:33280
    s_waitcnt lgkmcnt(0)
    s_barrier
    v_mfma_f32_16x16x32_bf16 v[64:67], v[52:55], v[76:79], v[64:67]
    v_mfma_f32_32x32x16_bf16 v[104:119], v[52:55], v[36:39], v[104:119]
    ds_read_b128 v[32:35], v3 offset:40960
    ds_read_b64_tr_b16 v[40:41], v23 offset:36864
    ds_read_b64_tr_b16 v[42:43], v23 offset:37376
    v_mfma_f32_16x16x32_bf16 v[68:71], v[56:59], v[76:79], v[68:71]
    v_mfma_f32_32x32x16_bf16 v[120:135], v[56:59], v[36:39], v[120:135]
    ds_read_b64_tr_b16 v[44:45], v23 offset:37888
    ds_read_b64_tr_b16 v[46:47], v23 offset:38400
    v_mfma_f32_16x16x32_bf16 v[72:75], v[60:63], v[76:79], v[72:75]
    v_mfma_f32_32x32x16_bf16 v[136:151], v[36:39], v[60:63], v[136:151]
    ds_read_b64_tr_b16 v[48:49], v23 offset:38912
    ds_read_b64_tr_b16 v[50:51], v23 offset:39424
    s_waitcnt lgkmcnt(4)
    v_mfma_f32_32x32x16_bf16 v[104:119], v[40:43], v[32:35], v[104:119]
    ds_read_b128 v[36:39], v4 offset:40960
    ds_read_b64_tr_b16 v[52:53], v23 offset:43008
    ds_read_b64_tr_b16 v[54:55], v23 offset:43520
    s_waitcnt lgkmcnt(5)
    v_mfma_f32_32x32x16_bf16 v[120:135], v[44:47], v[32:35], v[120:135]
    ds_read_b64_tr_b16 v[56:57], v23 offset:44032
    ds_read_b64_tr_b16 v[58:59], v23 offset:44544
    s_waitcnt lgkmcnt(5)
    v_mfma_f32_32x32x16_bf16 v[136:151], v[32:35], v[48:51], v[136:151]
    ds_read_b64_tr_b16 v[60:61], v23 offset:45056
    ds_read_b64_tr_b16 v[62:63], v23 offset:45568
    s_waitcnt lgkmcnt(4)
    v_mfma_f32_16x16x32_bf16 v[64:67], v[52:55], v[76:79], v[64:67]
    v_mfma_f32_32x32x16_bf16 v[104:119], v[52:55], v[36:39], v[104:119]
    ds_read_b128 v[32:35], v5 offset:40960
    ds_read_b64_tr_b16 v[40:41], v23 offset:49152
    ds_read_b64_tr_b16 v[42:43], v23 offset:49664
    s_waitcnt lgkmcnt(5)
    v_mfma_f32_16x16x32_bf16 v[68:71], v[56:59], v[76:79], v[68:71]
    v_mfma_f32_32x32x16_bf16 v[120:135], v[56:59], v[36:39], v[120:135]
    ds_read_b64_tr_b16 v[44:45], v23 offset:50176
    ds_read_b64_tr_b16 v[46:47], v23 offset:50688
    s_waitcnt lgkmcnt(5)
    v_mfma_f32_16x16x32_bf16 v[72:75], v[60:63], v[76:79], v[72:75]
    v_mfma_f32_32x32x16_bf16 v[136:151], v[36:39], v[60:63], v[136:151]
    ds_read_b64_tr_b16 v[48:49], v23 offset:51200
    ds_read_b64_tr_b16 v[50:51], v23 offset:51712
    s_waitcnt lgkmcnt(4)
    v_mfma_f32_32x32x16_bf16 v[104:119], v[40:43], v[32:35], v[104:119]
    ds_read_b128 v[36:39], v6 offset:40960
    ds_read_b64_tr_b16 v[52:53], v23 offset:55296
    ds_read_b64_tr_b16 v[54:55], v23 offset:55808
    s_waitcnt lgkmcnt(5)
    v_mfma_f32_32x32x16_bf16 v[120:135], v[44:47], v[32:35], v[120:135]
    ds_read_b64_tr_b16 v[56:57], v23 offset:56320
    ds_read_b64_tr_b16 v[58:59], v23 offset:56832
    s_waitcnt lgkmcnt(5)
    v_mfma_f32_32x32x16_bf16 v[136:151], v[32:35], v[48:51], v[136:151]
    ds_read_b64_tr_b16 v[60:61], v23 offset:57344
    ds_read_b64_tr_b16 v[62:63], v23 offset:57856
    s_waitcnt lgkmcnt(0)
    s_barrier
    v_mfma_f32_16x16x32_bf16 v[64:67], v[52:55], v[76:79], v[64:67]
    v_mfma_f32_32x32x16_bf16 v[104:119], v[52:55], v[36:39], v[104:119]
    ds_read_b128 v[32:35], v3 offset:49152
    ds_read_b64_tr_b16 v[40:41], v23 offset:61440
    ds_read_b64_tr_b16 v[42:43], v23 offset:61952
    v_mfma_f32_16x16x32_bf16 v[68:71], v[56:59], v[76:79], v[68:71]
    v_mfma_f32_32x32x16_bf16 v[120:135], v[56:59], v[36:39], v[120:135]
    ds_read_b64_tr_b16 v[44:45], v23 offset:62464
    ds_read_b64_tr_b16 v[46:47], v23 offset:62976
    v_mfma_f32_16x16x32_bf16 v[72:75], v[60:63], v[76:79], v[72:75]
    v_mfma_f32_32x32x16_bf16 v[136:151], v[36:39], v[60:63], v[136:151]
    ds_read_b64_tr_b16 v[48:49], v23 offset:63488
    ds_read_b64_tr_b16 v[50:51], v23 offset:64000
    s_waitcnt lgkmcnt(4)
    v_mfma_f32_32x32x16_bf16 v[104:119], v[40:43], v[32:35], v[104:119]
    ds_read_b128 v[36:39], v4 offset:49152
    ds_read_b64_tr_b16 v[52:53], v24 offset:2048
    ds_read_b64_tr_b16 v[54:55], v24 offset:2560
    s_waitcnt lgkmcnt(5)
    v_mfma_f32_32x32x16_bf16 v[120:135], v[44:47], v[32:35], v[120:135]
    ds_read_b64_tr_b16 v[56:57], v24 offset:3072
    ds_read_b64_tr_b16 v[58:59], v24 offset:3584
    s_waitcnt lgkmcnt(5)
    v_mfma_f32_32x32x16_bf16 v[136:151], v[32:35], v[48:51], v[136:151]
    ds_read_b64_tr_b16 v[60:61], v24 offset:4096
    ds_read_b64_tr_b16 v[62:63], v24 offset:4608
    s_waitcnt lgkmcnt(4)
    v_mfma_f32_16x16x32_bf16 v[64:67], v[52:55], v[76:79], v[64:67]
    v_mfma_f32_32x32x16_bf16 v[104:119], v[52:55], v[36:39], v[104:119]
    ds_read_b128 v[32:35], v5 offset:49152
    ds_read_b64_tr_b16 v[40:41], v24 offset:8192
    ds_read_b64_tr_b16 v[42:43], v24 offset:8704
    s_waitcnt lgkmcnt(5)
    v_mfma_f32_16x16x32_bf16 v[68:71], v[56:59], v[76:79], v[68:71]
    v_mfma_f32_32x32x16_bf16 v[120:135], v[56:59], v[36:39], v[120:135]
    ds_read_b64_tr_b16 v[44:45], v24 offset:9216
    ds_read_b64_tr_b16 v[46:47], v24 offset:9728
    s_waitcnt lgkmcnt(5)
    v_mfma_f32_16x16x32_bf16 v[72:75], v[60:63], v[76:79], v[72:75]
    v_mfma_f32_32x32x16_bf16 v[136:151], v[36:39], v[60:63], v[136:151]
    ds_read_b64_tr_b16 v[48:49], v24 offset:10240
    ds_read_b64_tr_b16 v[50:51], v24 offset:10752
    s_waitcnt lgkmcnt(4)
    v_mfma_f32_32x32x16_bf16 v[104:119], v[40:43], v[32:35], v[104:119]
    ds_read_b128 v[36:39], v6 offset:49152
    ds_read_b64_tr_b16 v[52:53], v24 offset:14336
    ds_read_b64_tr_b16 v[54:55], v24 offset:14848
    s_waitcnt lgkmcnt(5)
    v_mfma_f32_32x32x16_bf16 v[120:135], v[44:47], v[32:35], v[120:135]
    ds_read_b64_tr_b16 v[56:57], v24 offset:15360
    ds_read_b64_tr_b16 v[58:59], v24 offset:15872
    s_waitcnt lgkmcnt(5)
    v_mfma_f32_32x32x16_bf16 v[136:151], v[32:35], v[48:51], v[136:151]
    ds_read_b64_tr_b16 v[60:61], v24 offset:16384
    ds_read_b64_tr_b16 v[62:63], v24 offset:16896
    s_waitcnt lgkmcnt(0)
    s_barrier
    v_mfma_f32_16x16x32_bf16 v[64:67], v[52:55], v[76:79], v[64:67]
    v_mfma_f32_32x32x16_bf16 v[104:119], v[52:55], v[36:39], v[104:119]
    ds_read_b128 v[32:35], v3 offset:57344
    ds_read_b64_tr_b16 v[40:41], v23 offset:0
    ds_read_b64_tr_b16 v[42:43], v23 offset:512
    v_mfma_f32_16x16x32_bf16 v[68:71], v[56:59], v[76:79], v[68:71]
    v_mfma_f32_32x32x16_bf16 v[120:135], v[56:59], v[36:39], v[120:135]
    ds_read_b64_tr_b16 v[44:45], v23 offset:1024
    ds_read_b64_tr_b16 v[46:47], v23 offset:1536
    v_mfma_f32_16x16x32_bf16 v[72:75], v[60:63], v[76:79], v[72:75]
    v_mfma_f32_32x32x16_bf16 v[136:151], v[36:39], v[60:63], v[136:151]
    ds_read_b64_tr_b16 v[48:49], v23 offset:2048
    ds_read_b64_tr_b16 v[50:51], v23 offset:2560
    ds_read_b64 v[102:103], v30
    s_waitcnt lgkmcnt(5)
    v_mfma_f32_32x32x16_bf16 v[104:119], v[40:43], v[32:35], v[104:119]
    ds_read_b128 v[36:39], v4 offset:57344
    ds_read_b64_tr_b16 v[52:53], v23 offset:6144
    ds_read_b64_tr_b16 v[54:55], v23 offset:6656
    s_waitcnt lgkmcnt(6)
    v_mfma_f32_32x32x16_bf16 v[120:135], v[44:47], v[32:35], v[120:135]
    ds_read_b64_tr_b16 v[56:57], v23 offset:7168
    ds_read_b64_tr_b16 v[58:59], v23 offset:7680
    s_waitcnt lgkmcnt(6)
    v_mfma_f32_32x32x16_bf16 v[136:151], v[32:35], v[48:51], v[136:151]
    ds_read_b64_tr_b16 v[60:61], v23 offset:8192
    ds_read_b64_tr_b16 v[62:63], v23 offset:8704
    s_waitcnt lgkmcnt(4)
    v_mfma_f32_16x16x32_bf16 v[64:67], v[52:55], v[76:79], v[64:67]
    v_mfma_f32_32x32x16_bf16 v[104:119], v[52:55], v[36:39], v[104:119]
    ds_read_b128 v[32:35], v5 offset:57344
    ds_read_b64_tr_b16 v[40:41], v23 offset:12288
    ds_read_b64_tr_b16 v[42:43], v23 offset:12800
    s_waitcnt lgkmcnt(5)
    v_mfma_f32_16x16x32_bf16 v[68:71], v[56:59], v[76:79], v[68:71]
    v_mfma_f32_32x32x16_bf16 v[120:135], v[56:59], v[36:39], v[120:135]
    ds_read_b64_tr_b16 v[44:45], v23 offset:13312
    ds_read_b64_tr_b16 v[46:47], v23 offset:13824
    s_waitcnt lgkmcnt(5)
    v_mfma_f32_16x16x32_bf16 v[72:75], v[60:63], v[76:79], v[72:75]
    v_mfma_f32_32x32x16_bf16 v[136:151], v[36:39], v[60:63], v[136:151]
    ds_read_b64_tr_b16 v[48:49], v23 offset:14336
    ds_read_b64_tr_b16 v[50:51], v23 offset:14848
    s_waitcnt lgkmcnt(4)
    v_mfma_f32_32x32x16_bf16 v[104:119], v[40:43], v[32:35], v[104:119]
    ds_read_b128 v[36:39], v6 offset:57344
    ds_read_b64_tr_b16 v[52:53], v23 offset:18432
    ds_read_b64_tr_b16 v[54:55], v23 offset:18944
    s_waitcnt lgkmcnt(5)
    v_mfma_f32_32x32x16_bf16 v[120:135], v[44:47], v[32:35], v[120:135]
    ds_read_b64_tr_b16 v[56:57], v23 offset:19456
    ds_read_b64_tr_b16 v[58:59], v23 offset:19968
    s_waitcnt lgkmcnt(5)
    v_mfma_f32_32x32x16_bf16 v[136:151], v[32:35], v[48:51], v[136:151]
    ds_read_b64_tr_b16 v[60:61], v23 offset:20480
    ds_read_b64_tr_b16 v[62:63], v23 offset:20992
    s_waitcnt lgkmcnt(0)
    v_mfma_f32_16x16x32_bf16 v[64:67], v[52:55], v[76:79], v[64:67]
    v_mfma_f32_16x16x32_bf16 v[68:71], v[56:59], v[76:79], v[68:71]
    v_mfma_f32_16x16x32_bf16 v[72:75], v[60:63], v[76:79], v[72:75]
    s_branch L_p1_join
L_p1_compute:
    s_lshr_b32 s25, s29, 1
    s_and_b32 s26, s29, 1
    v_and_b32 v8, 31, v1
    v_lshrrev_b32 v9, 5, v1
    v_bfe_u32 v10, v1, 1, 3
    v_xor_b32 v10, v10, v9
    v_lshlrev_b32 v10, 4, v10
    v_lshl_add_u32 v10, v8, 7, v10
    s_lshl_b32 s30, s25, 12
    v_add_u32 v3, s30, v10
    v_xor_b32 v4, 32, v3
    v_xor_b32 v5, 64, v3
    v_xor_b32 v6, 96, v3
    v_mul_u32_u24 v10, 3072, v9
    v_bfe_u32 v11, v1, 2, 2
    v_lshl_add_u32 v10, v11, 7, v10
    v_lshrrev_b32 v11, 1, v11
    v_xor_b32 v11, s26, v11
    v_lshl_add_u32 v10, v11, 6, v10
    v_bfe_u32 v12, v1, 4, 1
    v_lshl_add_u32 v10, v12, 5, v10
    v_and_b32 v11, 3, v1
    v_lshl_add_u32 v22, v11, 3, v10
    v_add_u32 v23, 0x00010000, v22
    v_add_u32 v24, 0x00020000, v22
    v_xor_b32 v10, v12, v1
    v_and_b32 v10, 1, v10
    v_cmp_eq_u32 vcc, 0, v10
    v_mov_b32 v10, 0x3f803f80
    s_nop 0
    v_cndmask_b32 v76, 0, v10, vcc
    v_cndmask_b32 v77, 0, v10, vcc
    v_cndmask_b32 v78, 0, v10, vcc
    v_cndmask_b32 v79, 0, v10, vcc
    s_lshl_b32 s30, s26, 1
    s_add_u32 s31, s30, s25
    s_mul_i32 s31, s31, 384
    s_add_u32 s31, s31, 151552
    v_and_b32 v10, 1, v1
    v_lshlrev_b32 v10, 6, v10
    v_and_b32 v11, 48, v1
    v_add3_u32 v25, v10, v11, s31
    s_mul_i32 s30, s30, 384
    s_add_u32 s30, s30, 151552
    v_mul_u32_u24 v10, 384, v9
    v_lshl_add_u32 v10, v8, 2, v10
    v_add_u32 v26, s30, v10
    s_lshl_b32 s30, s29, 9
    s_add_u32 s30, s30, 153088
    v_lshl_add_u32 v27, v1, 3, s30
    v_xor_b32 v31, 512, v27
    s_lshl_b32 s30, s29, 7
    s_add_u32 s30, s30, 155136
    v_lshl_add_u32 v28, v8, 2, s30
    v_lshl_add_u32 v29, v9, 4, s30
    s_lshl_b32 s30, s25, 10
    s_add_u32 s30, s30, 153088
    v_add_u32 v27, s30, v2
    s_lshl_b32 s30, s25, 7
    s_add_u32 s30, s30, 155136
    v_lshl_add_u32 v28, v8, 2, s30
    v_lshl_add_u32 v29, v9, 4, s30
    s_mov_b32 s41, 0x3f803f80
    v_mov_b32 v152, 0
    v_mov_b32 v153, 0
    v_and_b32 v10, 0x33, v1
    v_bfe_u32 v11, v1, 2, 1
    v_lshl_or_b32 v10, v11, 3, v10
    v_bfe_u32 v11, v1, 3, 1
    v_lshl_or_b32 v10, v11, 2, v10
    v_lshlrev_b32 v20, 4, v10
    v_lshlrev_b32 v10, 11, v12
    v_lshl_add_u32 v10, v9, 8, v10
    v_and_b32 v11, 15, v1
    v_lshl_add_u32 v21, v11, 4, v10
    s_lshl_b32 s30, s27, 2
    s_lshl_b32 s31, s26, 1
    s_add_u32 s30, s30, s31
    s_lshl_b32 s31, s28, 1
    s_add_u32 s31, s31, s25
    s_mul_i32 s60, s31, 126976
    s_lshl_b32 s46, s30, 10
    s_add_u32 s46, s46, s60
    s_add_u32 s46, s46, 65536
    s_add_u32 s47, s46, 1024
    s_lshl_b32 s37, s30, 11
    s_add_u32 s60, s60, s37
    s_lshl_b32 s37, s31, 11
    s_mul_i32 s36, s30, 135424
    s_add_u32 s36, s36, s37
    s_add_u32 s36, s36, 12582912
    s_add_u32 s37, s36, 135424
    v_mul_u32_u24 v156, 133376, v12
    v_add_u32 v156, v156, v21
    v_mov_b32 v64, 0
    v_mov_b32 v65, 0
    v_mov_b32 v66, 0
    v_mov_b32 v67, 0
    v_mov_b32 v68, 0
    v_mov_b32 v69, 0
    v_mov_b32 v70, 0
    v_mov_b32 v71, 0
    v_mov_b32 v72, 0
    v_mov_b32 v73, 0
    v_mov_b32 v74, 0
    v_mov_b32 v75, 0
    s_waitcnt lgkmcnt(0)
    s_add_u32 s12, s8, 0x00000000
    s_addc_u32 s13, s9, 0
    s_mov_b32 s14, 0x02000000
    s_mov_b32 s15, 0x00020000
    s_lshl_b32 s30, s27, 1
    s_add_u32 s30, s30, s26
    s_and_b32 s31, s28, 3
    s_lshl_b32 s31, s31, 1
    s_add_u32 s31, s31, s25
    s_lshl_b32 s31, s31, 2
    s_and_b32 s38, s2, 7
    s_lshl_b32 s48, s38, 9
    s_lshl_b32 s39, s30, 5
    s_add_u32 s48, s48, s39
    s_add_u32 s48, s48, s31
    s_add_u32 s48, s48, 11558912
    s_lshl_b32 s49, s30, 10
    s_lshl_b32 s39, s38, 7
    s_add_u32 s49, s49, s39
    s_add_u32 s49, s49, s31
    s_add_u32 s49, s49, 11567104
    s_mov_b32 s38, s60
    s_add_u32 s39, s60, 2048
    v_mov_b32 v30, 155392
    s_barrier
    ds_read_b128 v[32:35], v3 offset:0
    ds_read_b64_tr_b16 v[40:41], v23 offset:0
    ds_read_b64_tr_b16 v[42:43], v23 offset:512
    ds_read_b64_tr_b16 v[44:45], v23 offset:1024
    ds_read_b64_tr_b16 v[46:47], v23 offset:1536
    ds_read_b64_tr_b16 v[48:49], v23 offset:2048
    ds_read_b64_tr_b16 v[50:51], v23 offset:2560
    s_cmp_lg_u32 s25, s26
    s_cbranch_scc1 L_p1_odd
    s_waitcnt lgkmcnt(4)
    v_mfma_f32_16x16x32_bf16 v[64:67], v[40:43], v[76:79], v[64:67]
    v_mfma_f32_32x32x16_bf16 v[104:119], v[40:43], v[32:35], 0
    ds_read_b128 v[36:39], v4 offset:0
    ds_read_b64_tr_b16 v[52:53], v23 offset:6144
    ds_read_b64_tr_b16 v[54:55], v23 offset:6656
    s_waitcnt lgkmcnt(5)
    v_mfma_f32_16x16x32_bf16 v[68:71], v[44:47], v[76:79], v[68:71]
    v_mfma_f32_32x32x16_bf16 v[120:135], v[44:47], v[32:35], 0
    ds_read_b64_tr_b16 v[56:57], v23 offset:7168
    ds_read_b64_tr_b16 v[58:59], v23 offset:7680
    s_waitcnt lgkmcnt(5)
    v_mfma_f32_16x16x32_bf16 v[72:75], v[48:51], v[76:79], v[72:75]
    v_mfma_f32_32x32x16_bf16 v[136:151], v[32:35], v[48:51], 0
    ds_read_b64_tr_b16 v[60:61], v23 offset:8192
    ds_read_b64_tr_b16 v[62:63], v23 offset:8704
    s_waitcnt lgkmcnt(0)
    s_barrier
    v_mfma_f32_32x32x16_bf16 v[104:119], v[52:55], v[36:39], v[104:119]
    ds_read_b128 v[32:35], v5 offset:0
    ds_read_b64_tr_b16 v[40:41], v23 offset:12288
    ds_read_b64_tr_b16 v[42:43], v23 offset:12800
    v_mfma_f32_32x32x16_bf16 v[120:135], v[56:59], v[36:39], v[120:135]
    ds_read_b64_tr_b16 v[44:45], v23 offset:13312
    ds_read_b64_tr_b16 v[46:47], v23 offset:13824
    v_mfma_f32_32x32x16_bf16 v[136:151], v[36:39], v[60:63], v[136:151]
    ds_read_b64_tr_b16 v[48:49], v23 offset:14336
    ds_read_b64_tr_b16 v[50:51], v23 offset:14848
    s_waitcnt lgkmcnt(4)
    v_mfma_f32_16x16x32_bf16 v[64:67], v[40:43], v[76:79], v[64:67]
    v_mfma_f32_32x32x16_bf16 v[104:119], v[40:43], v[32:35], v[104:119]
    ds_read_b128 v[36:39], v6 offset:0
    ds_read_b64_tr_b16 v[52:53], v23 offset:18432
    ds_read_b64_tr_b16 v[54:55], v23 offset:18944
    s_waitcnt lgkmcnt(5)
    v_mfma_f32_16x16x32_bf16 v[68:71], v[44:47], v[76:79], v[68:71]
    v_mfma_f32_32x32x16_bf16 v[120:135], v[44:47], v[32:35], v[120:135]
    ds_read_b64_tr_b16 v[56:57], v23 offset:19456
    ds_read_b64_tr_b16 v[58:59], v23 offset:19968
    s_waitcnt lgkmcnt(5)
    v_mfma_f32_16x16x32_bf16 v[72:75], v[48:51], v[76:79], v[72:75]
    v_mfma_f32_32x32x16_bf16 v[136:151], v[32:35], v[48:51], v[136:151]
    ds_read_b64_tr_b16 v[60:61], v23 offset:20480
    ds_read_b64_tr_b16 v[62:63], v23 offset:20992
    s_waitcnt lgkmcnt(0)
    s_barrier
    v_mfma_f32_32x32x16_bf16 v[104:119], v[52:55], v[36:39], v[104:119]
    ds_read_b128 v[32:35], v3 offset:8192
    ds_read_b64_tr_b16 v[40:41], v23 offset:24576
    ds_read_b64_tr_b16 v[42:43], v23 offset:25088
    v_mfma_f32_32x32x16_bf16 v[120:135], v[56:59], v[36:39], v[120:135]
    ds_read_b64_tr_b16 v[44:45], v23 offset:25600
    ds_read_b64_tr_b16 v[46:47], v23 offset:26112
    v_mfma_f32_32x32x16_bf16 v[136:151], v[36:39], v[60:63], v[136:151]
    ds_read_b64_tr_b16 v[48:49], v23 offset:26624
    ds_read_b64_tr_b16 v[50:51], v23 offset:27136
    s_waitcnt lgkmcnt(4)
    v_mfma_f32_16x16x32_bf16 v[64:67], v[40:43], v[76:79], v[64:67]
    v_mfma_f32_32x32x16_bf16 v[104:119], v[40:43], v[32:35], v[104:119]
    ds_read_b128 v[36:39], v4 offset:8192
    ds_read_b64_tr_b16 v[52:53], v23 offset:30720
    ds_read_b64_tr_b16 v[54:55], v23 offset:31232
    s_waitcnt lgkmcnt(5)
    v_mfma_f32_16x16x32_bf16 v[68:71], v[44:47], v[76:79], v[68:71]
    v_mfma_f32_32x32x16_bf16 v[120:135], v[44:47], v[32:35], v[120:135]
    ds_read_b64_tr_b16 v[56:57], v23 offset:31744
    ds_read_b64_tr_b16 v[58:59], v23 offset:32256
    s_waitcnt lgkmcnt(5)
    v_mfma_f32_16x16x32_bf16 v[72:75], v[48:51], v[76:79], v[72:75]
    v_mfma_f32_32x32x16_bf16 v[136:151], v[32:35], v[48:51], v[136:151]
    ds_read_b64_tr_b16 v[60:61], v23 offset:32768
    ds_read_b64_tr_b16 v[62:63], v23 offset:33280
    s_waitcnt lgkmcnt(4)
    v_mfma_f32_32x32x16_bf16 v[104:119], v[52:55], v[36:39], v[104:119]
    ds_read_b128 v[32:35], v5 offset:8192
    ds_read_b64_tr_b16 v[40:41], v23 offset:36864
    ds_read_b64_tr_b16 v[42:43], v23 offset:37376
    s_waitcnt lgkmcnt(5)
    v_mfma_f32_32x32x16_bf16 v[120:135], v[56:59], v[36:39], v[120:135]
    ds_read_b64_tr_b16 v[44:45], v23 offset:37888
    ds_read_b64_tr_b16 v[46:47], v23 offset:38400
    s_waitcnt lgkmcnt(5)
    v_mfma_f32_32x32x16_bf16 v[136:151], v[36:39], v[60:63], v[136:151]
    ds_read_b64_tr_b16 v[48:49], v23 offset:38912
    ds_read_b64_tr_b16 v[50:51], v23 offset:39424
    s_waitcnt lgkmcnt(4)
    v_mfma_f32_16x16x32_bf16 v[64:67], v[40:43], v[76:79], v[64:67]
    v_mfma_f32_32x32x16_bf16 v[104:119], v[40:43], v[32:35], v[104:119]
    ds_read_b128 v[36:39], v6 offset:8192
    ds_read_b64_tr_b16 v[52:53], v23 offset:43008
    ds_read_b64_tr_b16 v[54:55], v23 offset:43520
    s_waitcnt lgkmcnt(5)
    v_mfma_f32_16x16x32_bf16 v[68:71], v[44:47], v[76:79], v[68:71]
    v_mfma_f32_32x32x16_bf16 v[120:135], v[44:47], v[32:35], v[120:135]
    ds_read_b64_tr_b16 v[56:57], v23 offset:44032
    ds_read_b64_tr_b16 v[58:59], v23 offset:44544
    s_waitcnt lgkmcnt(5)
    v_mfma_f32_16x16x32_bf16 v[72:75], v[48:51], v[76:79], v[72:75]
    v_mfma_f32_32x32x16_bf16 v[136:151], v[32:35], v[48:51], v[136:151]
    ds_read_b64_tr_b16 v[60:61], v23 offset:45056
    ds_read_b64_tr_b16 v[62:63], v23 offset:45568
    s_waitcnt lgkmcnt(0)
    s_barrier
    v_mfma_f32_32x32x16_bf16 v[104:119], v[52:55], v[36:39], v[104:119]
    ds_read_b128 v[32:35], v3 offset:16384
    ds_read_b64_tr_b16 v[40:41], v23 offset:49152
    ds_read_b64_tr_b16 v[42:43], v23 offset:49664
    v_mfma_f32_32x32x16_bf16 v[120:135], v[56:59], v[36:39], v[120:135]
    ds_read_b64_tr_b16 v[44:45], v23 offset:50176
    ds_read_b64_tr_b16 v[46:47], v23 offset:50688
    v_mfma_f32_32x32x16_bf16 v[136:151], v[36:39], v[60:63], v[136:151]
    ds_read_b64_tr_b16 v[48:49], v23 offset:51200
    ds_read_b64_tr_b16 v[50:51], v23 offset:51712
    s_waitcnt lgkmcnt(4)
    v_mfma_f32_16x16x32_bf16 v[64:67], v[40:43], v[76:79], v[64:67]
    v_mfma_f32_32x32x16_bf16 v[104:119], v[40:43], v[32:35], v[104:119]
    ds_read_b128 v[36:39], v4 offset:16384
    ds_read_b64_tr_b16 v[52:53], v23 offset:55296
    ds_read_b64_tr_b16 v[54:55], v23 offset:55808
    s_waitcnt lgkmcnt(5)
    v_mfma_f32_16x16x32_bf16 v[68:71], v[44:47], v[76:79], v[68:71]
    v_mfma_f32_32x32x16_bf16 v[120:135], v[44:47], v[32:35], v[120:135]
    ds_read_b64_tr_b16 v[56:57], v23 offset:56320
    ds_read_b64_tr_b16 v[58:59], v23 offset:56832
    s_waitcnt lgkmcnt(5)
    v_mfma_f32_16x16x32_bf16 v[72:75], v[48:51], v[76:79], v[72:75]
    v_mfma_f32_32x32x16_bf16 v[136:151], v[32:35], v[48:51], v[136:151]
    ds_read_b64_tr_b16 v[60:61], v23 offset:57344
    ds_read_b64_tr_b16 v[62:63], v23 offset:57856
    s_waitcnt lgkmcnt(4)
    v_mfma_f32_32x32x16_bf16 v[104:119], v[52:55], v[36:39], v[104:119]
    ds_read_b128 v[32:35], v5 offset:16384
    ds_read_b64_tr_b16 v[40:41], v23 offset:61440
    ds_read_b64_tr_b16 v[42:43], v23 offset:61952
    s_waitcnt lgkmcnt(5)
    v_mfma_f32_32x32x16_bf16 v[120:135], v[56:59], v[36:39], v[120:135]
    ds_read_b64_tr_b16 v[44:45], v23 offset:62464
    ds_read_b64_tr_b16 v[46:47], v23 offset:62976
    s_waitcnt lgkmcnt(5)
    v_mfma_f32_32x32x16_bf16 v[136:151], v[36:39], v[60:63], v[136:151]
    ds_read_b64_tr_b16 v[48:49], v23 offset:63488
    ds_read_b64_tr_b16 v[50:51], v23 offset:64000
    s_waitcnt lgkmcnt(4)
    v_mfma_f32_16x16x32_bf16 v[64:67], v[40:43], v[76:79], v[64:67]
    v_mfma_f32_32x32x16_bf16 v[104:119], v[40:43], v[32:35], v[104:119]
    ds_read_b128 v[36:39], v6 offset:16384
    ds_read_b64_tr_b16 v[52:53], v24 offset:2048
    ds_read_b64_tr_b16 v[54:55], v24 offset:2560
    s_waitcnt lgkmcnt(5)
    v_mfma_f32_16x16x32_bf16 v[68:71], v[44:47], v[76:79], v[68:71]
    v_mfma_f32_32x32x16_bf16 v[120:135], v[44:47], v[32:35], v[120:135]
    ds_read_b64_tr_b16 v[56:57], v24 offset:3072
    ds_read_b64_tr_b16 v[58:59], v24 offset:3584
    s_waitcnt lgkmcnt(5)
    v_mfma_f32_16x16x32_bf16 v[72:75], v[48:51], v[76:79], v[72:75]
    v_mfma_f32_32x32x16_bf16 v[136:151], v[32:35], v[48:51], v[136:151]
    ds_read_b64_tr_b16 v[60:61], v24 offset:4096
    ds_read_b64_tr_b16 v[62:63], v24 offset:4608
    s_waitcnt lgkmcnt(0)
    s_barrier
    v_mfma_f32_32x32x16_bf16 v[104:119], v[52:55], v[36:39], v[104:119]
    ds_read_b128 v[32:35], v3 offset:24576
    ds_read_b64_tr_b16 v[40:41], v24 offset:8192
    ds_read_b64_tr_b16 v[42:43], v24 offset:8704
    v_mfma_f32_32x32x16_bf16 v[120:135], v[56:59], v[36:39], v[120:135]
    ds_read_b64_tr_b16 v[44:45], v24 offset:9216
    ds_read_b64_tr_b16 v[46:47], v24 offset:9728
    v_mfma_f32_32x32x16_bf16 v[136:151], v[36:39], v[60:63], v[136:151]
    ds_read_b64_tr_b16 v[48:49], v24 offset:10240
    ds_read_b64_tr_b16 v[50:51], v24 offset:10752
    s_waitcnt lgkmcnt(4)
    v_mfma_f32_16x16x32_bf16 v[64:67], v[40:43], v[76:79], v[64:67]
    v_mfma_f32_32x32x16_bf16 v[104:119], v[40:43], v[32:35], v[104:119]
    ds_read_b128 v[36:39], v4 offset:24576
    ds_read_b64_tr_b16 v[52:53], v24 offset:14336
    ds_read_b64_tr_b16 v[54:55], v24 offset:14848
    s_waitcnt lgkmcnt(5)
    v_mfma_f32_16x16x32_bf16 v[68:71], v[44:47], v[76:79], v[68:71]
    v_mfma_f32_32x32x16_bf16 v[120:135], v[44:47], v[32:35], v[120:135]
    ds_read_b64_tr_b16 v[56:57], v24 offset:15360
    ds_read_b64_tr_b16 v[58:59], v24 offset:15872
    s_waitcnt lgkmcnt(5)
    v_mfma_f32_16x16x32_bf16 v[72:75], v[48:51], v[76:79], v[72:75]
    v_mfma_f32_32x32x16_bf16 v[136:151], v[32:35], v[48:51], v[136:151]
    ds_read_b64_tr_b16 v[60:61], v24 offset:16384
    ds_read_b64_tr_b16 v[62:63], v24 offset:16896
    s_waitcnt lgkmcnt(4)
    v_mfma_f32_32x32x16_bf16 v[104:119], v[52:55], v[36:39], v[104:119]
    ds_read_b128 v[32:35], v5 offset:24576
    ds_read_b64_tr_b16 v[40:41], v23 offset:0
    ds_read_b64_tr_b16 v[42:43], v23 offset:512
    s_waitcnt lgkmcnt(5)
    v_mfma_f32_32x32x16_bf16 v[120:135], v[56:59], v[36:39], v[120:135]
    ds_read_b64_tr_b16 v[44:45], v23 offset:1024
    ds_read_b64_tr_b16 v[46:47], v23 offset:1536
    s_waitcnt lgkmcnt(5)
    v_mfma_f32_32x32x16_bf16 v[136:151], v[36:39], v[60:63], v[136:151]
    ds_read_b64_tr_b16 v[48:49], v23 offset:2048
    ds_read_b64_tr_b16 v[50:51], v23 offset:2560
    s_waitcnt lgkmcnt(4)
    v_mfma_f32_16x16x32_bf16 v[64:67], v[40:43], v[76:79], v[64:67]
    v_mfma_f32_32x32x16_bf16 v[104:119], v[40:43], v[32:35], v[104:119]
    ds_read_b128 v[36:39], v6 offset:24576
    ds_read_b64_tr_b16 v[52:53], v23 offset:6144
    ds_read_b64_tr_b16 v[54:55], v23 offset:6656
    s_waitcnt lgkmcnt(5)
    v_mfma_f32_16x16x32_bf16 v[68:71], v[44:47], v[76:79], v[68:71]
    v_mfma_f32_32x32x16_bf16 v[120:135], v[44:47], v[32:35], v[120:135]
    ds_read_b64_tr_b16 v[56:57], v23 offset:7168
    ds_read_b64_tr_b16 v[58:59], v23 offset:7680
    s_waitcnt lgkmcnt(5)
    v_mfma_f32_16x16x32_bf16 v[72:75], v[48:51], v[76:79], v[72:75]
    v_mfma_f32_32x32x16_bf16 v[136:151], v[32:35], v[48:51], v[136:151]
    ds_read_b64_tr_b16 v[60:61], v23 offset:8192
    ds_read_b64_tr_b16 v[62:63], v23 offset:8704
    s_waitcnt lgkmcnt(0)
    s_barrier
    v_mfma_f32_32x32x16_bf16 v[104:119], v[52:55], v[36:39], v[104:119]
    ds_read_b128 v[32:35], v3 offset:32768
    ds_read_b64_tr_b16 v[40:41], v23 offset:12288
    ds_read_b64_tr_b16 v[42:43], v23 offset:12800
    v_mfma_f32_32x32x16_bf16 v[120:135], v[56:59], v[36:39], v[120:135]
    ds_read_b64_tr_b16 v[44:45], v23 offset:13312
    ds_read_b64_tr_b16 v[46:47], v23 offset:13824
    v_mfma_f32_32x32x16_bf16 v[136:151], v[36:39], v[60:63], v[136:151]
    ds_read_b64_tr_b16 v[48:49], v23 offset:14336
    ds_read_b64_tr_b16 v[50:51], v23 offset:14848
    s_waitcnt lgkmcnt(4)
    v_mfma_f32_16x16x32_bf16 v[64:67], v[40:43], v[76:79], v[64:67]
    v_mfma_f32_32x32x16_bf16 v[104:119], v[40:43], v[32:35], v[104:119]
    ds_read_b128 v[36:39], v4 offset:32768
    ds_read_b64_tr_b16 v[52:53], v23 offset:18432
    ds_read_b64_tr_b16 v[54:55], v23 offset:18944
    s_waitcnt lgkmcnt(5)
    v_mfma_f32_16x16x32_bf16 v[68:71], v[44:47], v[76:79], v[68:71]
    v_mfma_f32_32x32x16_bf16 v[120:135], v[44:47], v[32:35], v[120:135]
    ds_read_b64_tr_b16 v[56:57], v23 offset:19456
    ds_read_b64_tr_b16 v[58:59], v23 offset:19968
    s_waitcnt lgkmcnt(5)
    v_mfma_f32_16x16x32_bf16 v[72:75], v[48:51], v[76:79], v[72:75]
    v_mfma_f32_32x32x16_bf16 v[136:151], v[32:35], v[48:51], v[136:151]
    ds_read_b64_tr_b16 v[60:61], v23 offset:20480
    ds_read_b64_tr_b16 v[62:63], v23 offset:20992
    s_waitcnt lgkmcnt(4)
    v_mfma_f32_32x32x16_bf16 v[104:119], v[52:55], v[36:39], v[104:119]
    ds_read_b128 v[32:35], v5 offset:32768
    ds_read_b64_tr_b16 v[40:41], v23 offset:24576
    ds_read_b64_tr_b16 v[42:43], v23 offset:25088
    s_waitcnt lgkmcnt(5)
    v_mfma_f32_32x32x16_bf16 v[120:135], v[56:59], v[36:39], v[120:135]
    ds_read_b64_tr_b16 v[44:45], v23 offset:25600
    ds_read_b64_tr_b16 v[46:47], v23 offset:26112
    s_waitcnt lgkmcnt(5)
    v_mfma_f32_32x32x16_bf16 v[136:151], v[36:39], v[60:63], v[136:151]
    ds_read_b64_tr_b16 v[48:49], v23 offset:26624
    ds_read_b64_tr_b16 v[50:51], v23 offset:27136
    s_waitcnt lgkmcnt(4)
    v_mfma_f32_16x16x32_bf16 v[64:67], v[40:43], v[76:79], v[64:67]
    v_mfma_f32_32x32x16_bf16 v[104:119], v[40:43], v[32:35], v[104:119]
    ds_read_b128 v[36:39], v6 offset:32768
    ds_read_b64_tr_b16 v[52:53], v23 offset:30720
    ds_read_b64_tr_b16 v[54:55], v23 offset:31232
    s_waitcnt lgkmcnt(5)
    v_mfma_f32_16x16x32_bf16 v[68:71], v[44:47], v[76:79], v[68:71]
    v_mfma_f32_32x32x16_bf16 v[120:135], v[44:47], v[32:35], v[120:135]
    ds_read_b64_tr_b16 v[56:57], v23 offset:31744
    ds_read_b64_tr_b16 v[58:59], v23 offset:32256
    s_waitcnt lgkmcnt(5)
    v_mfma_f32_16x16x32_bf16 v[72:75], v[48:51], v[76:79], v[72:75]
    v_mfma_f32_32x32x16_bf16 v[136:151], v[32:35], v[48:51], v[136:151]
    ds_read_b64_tr_b16 v[60:61], v23 offset:32768
    ds_read_b64_tr_b16 v[62:63], v23 offset:33280
    s_waitcnt lgkmcnt(0)
    s_barrier
    v_mfma_f32_32x32x16_bf16 v[104:119], v[52:55], v[36:39], v[104:119]
    ds_read_b128 v[32:35], v3 offset:40960
    ds_read_b64_tr_b16 v[40:41], v23 offset:36864
    ds_read_b64_tr_b16 v[42:43], v23 offset:37376
    v_mfma_f32_32x32x16_bf16 v[120:135], v[56:59], v[36:39], v[120:135]
    ds_read_b64_tr_b16 v[44:45], v23 offset:37888
    ds_read_b64_tr_b16 v[46:47], v23 offset:38400
    v_mfma_f32_32x32x16_bf16 v[136:151], v[36:39], v[60:63], v[136:151]
    ds_read_b64_tr_b16 v[48:49], v23 offset:38912
    ds_read_b64_tr_b16 v[50:51], v23 offset:39424
    s_waitcnt lgkmcnt(4)
    v_mfma_f32_16x16x32_bf16 v[64:67], v[40:43], v[76:79], v[64:67]
    v_mfma_f32_32x32x16_bf16 v[104:119], v[40:43], v[32:35], v[104:119]
    ds_read_b128 v[36:39], v4 offset:40960
    ds_read_b64_tr_b16 v[52:53], v23 offset:43008
    ds_read_b64_tr_b16 v[54:55], v23 offset:43520
    s_waitcnt lgkmcnt(5)
    v_mfma_f32_16x16x32_bf16 v[68:71], v[44:47], v[76:79], v[68:71]
    v_mfma_f32_32x32x16_bf16 v[120:135], v[44:47], v[32:35], v[120:135]
    ds_read_b64_tr_b16 v[56:57], v23 offset:44032
    ds_read_b64_tr_b16 v[58:59], v23 offset:44544
    s_waitcnt lgkmcnt(5)
    v_mfma_f32_16x16x32_bf16 v[72:75], v[48:51], v[76:79], v[72:75]
    v_mfma_f32_32x32x16_bf16 v[136:151], v[32:35], v[48:51], v[136:151]
    ds_read_b64_tr_b16 v[60:61], v23 offset:45056
    ds_read_b64_tr_b16 v[62:63], v23 offset:45568
    s_waitcnt lgkmcnt(4)
    v_mfma_f32_32x32x16_bf16 v[104:119], v[52:55], v[36:39], v[104:119]
    ds_read_b128 v[32:35], v5 offset:40960
    ds_read_b64_tr_b16 v[40:41], v23 offset:49152
    ds_read_b64_tr_b16 v[42:43], v23 offset:49664
    s_waitcnt lgkmcnt(5)
    v_mfma_f32_32x32x16_bf16 v[120:135], v[56:59], v[36:39], v[120:135]
    ds_read_b64_tr_b16 v[44:45], v23 offset:50176
    ds_read_b64_tr_b16 v[46:47], v23 offset:50688
    s_waitcnt lgkmcnt(5)
    v_mfma_f32_32x32x16_bf16 v[136:151], v[36:39], v[60:63], v[136:151]
    ds_read_b64_tr_b16 v[48:49], v23 offset:51200
    ds_read_b64_tr_b16 v[50:51], v23 offset:51712
    s_waitcnt lgkmcnt(4)
    v_mfma_f32_16x16x32_bf16 v[64:67], v[40:43], v[76:79], v[64:67]
    v_mfma_f32_32x32x16_bf16 v[104:119], v[40:43], v[32:35], v[104:119]
    ds_read_b128 v[36:39], v6 offset:40960
    ds_read_b64_tr_b16 v[52:53], v23 offset:55296
    ds_read_b64_tr_b16 v[54:55], v23 offset:55808
    s_waitcnt lgkmcnt(5)
    v_mfma_f32_16x16x32_bf16 v[68:71], v[44:47], v[76:79], v[68:71]
    v_mfma_f32_32x32x16_bf16 v[120:135], v[44:47], v[32:35], v[120:135]
    ds_read_b64_tr_b16 v[56:57], v23 offset:56320
    ds_read_b64_tr_b16 v[58:59], v23 offset:56832
    s_waitcnt lgkmcnt(5)
    v_mfma_f32_16x16x32_bf16 v[72:75], v[48:51], v[76:79], v[72:75]
    v_mfma_f32_32x32x16_bf16 v[136:151], v[32:35], v[48:51], v[136:151]
    ds_read_b64_tr_b16 v[60:61], v23 offset:57344
    ds_read_b64_tr_b16 v[62:63], v23 offset:57856
    s_waitcnt lgkmcnt(0)
    s_barrier
    v_mfma_f32_32x32x16_bf16 v[104:119], v[52:55], v[36:39], v[104:119]
    ds_read_b128 v[32:35], v3 offset:49152
    ds_read_b64_tr_b16 v[40:41], v23 offset:61440
    ds_read_b64_tr_b16 v[42:43], v23 offset:61952
    v_mfma_f32_32x32x16_bf16 v[120:135], v[56:59], v[36:39], v[120:135]
    ds_read_b64_tr_b16 v[44:45], v23 offset:62464
    ds_read_b64_tr_b16 v[46:47], v23 offset:62976
    v_mfma_f32_32x32x16_bf16 v[136:151], v[36:39], v[60:63], v[136:151]
    ds_read_b64_tr_b16 v[48:49], v23 offset:63488
    ds_read_b64_tr_b16 v[50:51], v23 offset:64000
    s_waitcnt lgkmcnt(4)
    v_mfma_f32_16x16x32_bf16 v[64:67], v[40:43], v[76:79], v[64:67]
    v_mfma_f32_32x32x16_bf16 v[104:119], v[40:43], v[32:35], v[104:119]
    ds_read_b128 v[36:39], v4 offset:49152
    ds_read_b64_tr_b16 v[52:53], v24 offset:2048
    ds_read_b64_tr_b16 v[54:55], v24 offset:2560
    s_waitcnt lgkmcnt(5)
    v_mfma_f32_16x16x32_bf16 v[68:71], v[44:47], v[76:79], v[68:71]
    v_mfma_f32_32x32x16_bf16 v[120:135], v[44:47], v[32:35], v[120:135]
    ds_read_b64_tr_b16 v[56:57], v24 offset:3072
    ds_read_b64_tr_b16 v[58:59], v24 offset:3584
    s_waitcnt lgkmcnt(5)
    v_mfma_f32_16x16x32_bf16 v[72:75], v[48:51], v[76:79], v[72:75]
    v_mfma_f32_32x32x16_bf16 v[136:151], v[32:35], v[48:51], v[136:151]
    ds_read_b64_tr_b16 v[60:61], v24 offset:4096
    ds_read_b64_tr_b16 v[62:63], v24 offset:4608
    s_waitcnt lgkmcnt(4)
    v_mfma_f32_32x32x16_bf16 v[104:119], v[52:55], v[36:39], v[104:119]
    ds_read_b128 v[32:35], v5 offset:49152
    ds_read_b64_tr_b16 v[40:41], v24 offset:8192
    ds_read_b64_tr_b16 v[42:43], v24 offset:8704
    s_waitcnt lgkmcnt(5)
    v_mfma_f32_32x32x16_bf16 v[120:135], v[56:59], v[36:39], v[120:135]
    ds_read_b64_tr_b16 v[44:45], v24 offset:9216
    ds_read_b64_tr_b16 v[46:47], v24 offset:9728
    s_waitcnt lgkmcnt(5)
    v_mfma_f32_32x32x16_bf16 v[136:151], v[36:39], v[60:63], v[136:151]
    ds_read_b64_tr_b16 v[48:49], v24 offset:10240
    ds_read_b64_tr_b16 v[50:51], v24 offset:10752
    s_waitcnt lgkmcnt(4)
    v_mfma_f32_16x16x32_bf16 v[64:67], v[40:43], v[76:79], v[64:67]
    v_mfma_f32_32x32x16_bf16 v[104:119], v[40:43], v[32:35], v[104:119]
    ds_read_b128 v[36:39], v6 offset:49152
    ds_read_b64_tr_b16 v[52:53], v24 offset:14336
    ds_read_b64_tr_b16 v[54:55], v24 offset:14848
    s_waitcnt lgkmcnt(5)
    v_mfma_f32_16x16x32_bf16 v[68:71], v[44:47], v[76:79], v[68:71]
    v_mfma_f32_32x32x16_bf16 v[120:135], v[44:47], v[32:35], v[120:135]
    ds_read_b64_tr_b16 v[56:57], v24 offset:15360
    ds_read_b64_tr_b16 v[58:59], v24 offset:15872
    s_waitcnt lgkmcnt(5)
    v_mfma_f32_16x16x32_bf16 v[72:75], v[48:51], v[76:79], v[72:75]
    v_mfma_f32_32x32x16_bf16 v[136:151], v[32:35], v[48:51], v[136:151]
    ds_read_b64_tr_b16 v[60:61], v24 offset:16384
    ds_read_b64_tr_b16 v[62:63], v24 offset:16896
    s_waitcnt lgkmcnt(0)
    s_barrier
    v_mfma_f32_32x32x16_bf16 v[104:119], v[52:55], v[36:39], v[104:119]
    ds_read_b128 v[32:35], v3 offset:57344
    ds_read_b64_tr_b16 v[40:41], v23 offset:0
    ds_read_b64_tr_b16 v[42:43], v23 offset:512
    v_mfma_f32_32x32x16_bf16 v[120:135], v[56:59], v[36:39], v[120:135]
    ds_read_b64_tr_b16 v[44:45], v23 offset:1024
    ds_read_b64_tr_b16 v[46:47], v23 offset:1536
    v_mfma_f32_32x32x16_bf16 v[136:151], v[36:39], v[60:63], v[136:151]
    ds_read_b64_tr_b16 v[48:49], v23 offset:2048
    ds_read_b64_tr_b16 v[50:51], v23 offset:2560
    ds_read_b64 v[102:103], v30
    s_waitcnt lgkmcnt(5)
    v_mfma_f32_16x16x32_bf16 v[64:67], v[40:43], v[76:79], v[64:67]
    v_mfma_f32_32x32x16_bf16 v[104:119], v[40:43], v[32:35], v[104:119]
    ds_read_b128 v[36:39], v4 offset:57344
    ds_read_b64_tr_b16 v[52:53], v23 offset:6144
    ds_read_b64_tr_b16 v[54:55], v23 offset:6656
    s_waitcnt lgkmcnt(6)
    v_mfma_f32_16x16x32_bf16 v[68:71], v[44:47], v[76:79], v[68:71]
    v_mfma_f32_32x32x16_bf16 v[120:135], v[44:47], v[32:35], v[120:135]
    ds_read_b64_tr_b16 v[56:57], v23 offset:7168
    ds_read_b64_tr_b16 v[58:59], v23 offset:7680
    s_waitcnt lgkmcnt(6)
    v_mfma_f32_16x16x32_bf16 v[72:75], v[48:51], v[76:79], v[72:75]
    v_mfma_f32_32x32x16_bf16 v[136:151], v[32:35], v[48:51], v[136:151]
    ds_read_b64_tr_b16 v[60:61], v23 offset:8192
    ds_read_b64_tr_b16 v[62:63], v23 offset:8704
    s_waitcnt lgkmcnt(4)
    v_mfma_f32_32x32x16_bf16 v[104:119], v[52:55], v[36:39], v[104:119]
    ds_read_b128 v[32:35], v5 offset:57344
    ds_read_b64_tr_b16 v[40:41], v23 offset:12288
    ds_read_b64_tr_b16 v[42:43], v23 offset:12800
    s_waitcnt lgkmcnt(5)
    v_mfma_f32_32x32x16_bf16 v[120:135], v[56:59], v[36:39], v[120:135]
    ds_read_b64_tr_b16 v[44:45], v23 offset:13312
    ds_read_b64_tr_b16 v[46:47], v23 offset:13824
    s_waitcnt lgkmcnt(5)
    v_mfma_f32_32x32x16_bf16 v[136:151], v[36:39], v[60:63], v[136:151]
    ds_read_b64_tr_b16 v[48:49], v23 offset:14336
    ds_read_b64_tr_b16 v[50:51], v23 offset:14848
    s_waitcnt lgkmcnt(4)
    v_mfma_f32_16x16x32_bf16 v[64:67], v[40:43], v[76:79], v[64:67]
    v_mfma_f32_32x32x16_bf16 v[104:119], v[40:43], v[32:35], v[104:119]
    ds_read_b128 v[36:39], v6 offset:57344
    ds_read_b64_tr_b16 v[52:53], v23 offset:18432
    ds_read_b64_tr_b16 v[54:55], v23 offset:18944
    s_waitcnt lgkmcnt(5)
    v_mfma_f32_16x16x32_bf16 v[68:71], v[44:47], v[76:79], v[68:71]
    v_mfma_f32_32x32x16_bf16 v[120:135], v[44:47], v[32:35], v[120:135]
    ds_read_b64_tr_b16 v[56:57], v23 offset:19456
    ds_read_b64_tr_b16 v[58:59], v23 offset:19968
    s_waitcnt lgkmcnt(5)
    v_mfma_f32_16x16x32_bf16 v[72:75], v[48:51], v[76:79], v[72:75]
    v_mfma_f32_32x32x16_bf16 v[136:151], v[32:35], v[48:51], v[136:151]
    ds_read_b64_tr_b16 v[60:61], v23 offset:20480
    ds_read_b64_tr_b16 v[62:63], v23 offset:20992
    s_waitcnt lgkmcnt(0)
L_p1_join:
    v_mfma_f32_32x32x16_bf16 v[104:119], v[52:55], v[36:39], v[104:119]
    v_readfirstlane_b32 s54, v102
    v_readfirstlane_b32 s53, v103
    s_nop 3
    s_mov_b32 exec_lo, 0x00030003
    s_mov_b32 exec_hi, 0x00030003
    ds_write_b128 v25, v[64:67] offset:0
    ds_write_b128 v25, v[68:71] offset:128
    ds_write_b128 v25, v[72:75] offset:256
    s_mov_b64 exec, -1
    v_mfma_f32_32x32x16_bf16 v[120:135], v[56:59], v[36:39], v[120:135]
    v_mov_b32 v42, 0
    v_mov_b32 v43, 0
    v_mov_b32 v46, 0
    v_mov_b32 v47, 0
    v_mov_b32 v50, 0
    v_mov_b32 v51, 0
    s_waitcnt lgkmcnt(0)
    s_barrier
    ds_read_b128 v[80:83], v27
    ds_read_b32 v100, v28
    ds_read_b32 v12, v26 offset:0
    ds_read_b32 v13, v26 offset:128
    ds_read_b32 v14, v26 offset:256
    v_mfma_f32_32x32x16_bf16 v[136:151], v[36:39], v[60:63], v[136:151]
    s_waitcnt lgkmcnt(2)
    v_cvt_pk_bf16_f32 v41, v12, 0
    v_lshlrev_b32 v8, 16, v41
    v_sub_f32 v8, v12, v8
    v_cvt_pk_bf16_f32 v40, v12, v8
    s_waitcnt lgkmcnt(1)
    v_cvt_pk_bf16_f32 v45, v13, 0
    v_lshlrev_b32 v8, 16, v45
    v_sub_f32 v8, v13, v8
    v_cvt_pk_bf16_f32 v44, v13, v8
    s_waitcnt lgkmcnt(0)
    v_cvt_pk_bf16_f32 v49, v14, 0
    v_lshlrev_b32 v8, 16, v49
    v_sub_f32 v8, v14, v8
    v_cvt_pk_bf16_f32 v48, v14, v8
    v_mfma_f32_32x32x16_bf16 v[104:119], v[40:43], v[80:83], v[104:119]
    v_mfma_f32_32x32x16_bf16 v[120:135], v[44:47], v[80:83], v[120:135]
    v_mfma_f32_32x32x16_bf16 v[136:151], v[80:83], v[48:51], v[136:151]
    v_mul_f32 v101, 0x3eb8aa3b, v100
    ds_read_b128 v[84:87], v29 offset:0
    ds_read_b128 v[88:91], v29 offset:32
    ds_read_b128 v[92:95], v29 offset:64
    ds_read_b128 v[96:99], v29 offset:96
    s_nop 4
    v_pk_mul_f32 v[104:105], v[104:105], v[100:101] op_sel:[0,1] op_sel_hi:[1,1]
    v_pk_mul_f32 v[106:107], v[106:107], v[100:101] op_sel:[0,1] op_sel_hi:[1,1]
    v_pk_mul_f32 v[108:109], v[108:109], v[100:101] op_sel:[0,1] op_sel_hi:[1,1]
    v_pk_mul_f32 v[110:111], v[110:111], v[100:101] op_sel:[0,1] op_sel_hi:[1,1]
    v_pk_mul_f32 v[112:113], v[112:113], v[100:101] op_sel:[0,1] op_sel_hi:[1,1]
    v_pk_mul_f32 v[114:115], v[114:115], v[100:101] op_sel:[0,1] op_sel_hi:[1,1]
    v_pk_mul_f32 v[116:117], v[116:117], v[100:101] op_sel:[0,1] op_sel_hi:[1,1]
    v_pk_mul_f32 v[118:119], v[118:119], v[100:101] op_sel:[0,1] op_sel_hi:[1,1]
    v_cvt_pk_bf16_f32 v32, v104, v105
    v_cvt_pk_bf16_f32 v33, v106, v107
    v_cvt_pk_bf16_f32 v34, v108, v109
    v_cvt_pk_bf16_f32 v35, v110, v111
    v_cvt_pk_bf16_f32 v36, v112, v113
    v_cvt_pk_bf16_f32 v37, v114, v115
    v_cvt_pk_bf16_f32 v38, v116, v117
    v_cvt_pk_bf16_f32 v39, v118, v119
    s_cmp_eq_u32 s54, 0
    s_cbranch_scc1 L_st_1_s
    buffer_store_dwordx4 v[32:35], v2, s[12:15], s46 offen
    buffer_store_dwordx4 v[36:39], v2, s[12:15], s47 offen
    s_branch L_st_1_j
L_st_1_s:
    buffer_store_dwordx4 v[32:35], v2, s[12:15], s46 offen sc1
    buffer_store_dwordx4 v[36:39], v2, s[12:15], s47 offen sc1
L_st_1_j:
    v_pk_mul_f32 v[120:121], v[120:121], v[100:101] op_sel_hi:[1,0]
    v_pk_mul_f32 v[122:123], v[122:123], v[100:101] op_sel_hi:[1,0]
    v_pk_mul_f32 v[124:125], v[124:125], v[100:101] op_sel_hi:[1,0]
    v_pk_mul_f32 v[126:127], v[126:127], v[100:101] op_sel_hi:[1,0]
    v_pk_mul_f32 v[128:129], v[128:129], v[100:101] op_sel_hi:[1,0]
    v_pk_mul_f32 v[130:131], v[130:131], v[100:101] op_sel_hi:[1,0]
    v_pk_mul_f32 v[132:133], v[132:133], v[100:101] op_sel_hi:[1,0]
    v_pk_mul_f32 v[134:135], v[134:135], v[100:101] op_sel_hi:[1,0]
    v_cvt_pk_bf16_f32 v40, v120, v121
    v_cvt_pk_bf16_f32 v41, v122, v123
    v_cvt_pk_bf16_f32 v42, v124, v125
    v_cvt_pk_bf16_f32 v43, v126, v127
    v_cvt_pk_bf16_f32 v44, v128, v129
    v_cvt_pk_bf16_f32 v45, v130, v131
    v_cvt_pk_bf16_f32 v46, v132, v133
    v_cvt_pk_bf16_f32 v47, v134, v135
    s_cmp_eq_u32 s54, 0
    s_cbranch_scc1 L_st_2_s
    buffer_store_dwordx4 v[40:43], v20, s[12:15], s38 offen
    buffer_store_dwordx4 v[44:47], v20, s[12:15], s39 offen
    s_branch L_st_2_j
L_st_2_s:
    buffer_store_dwordx4 v[40:43], v20, s[12:15], s38 offen sc1
    buffer_store_dwordx4 v[44:47], v20, s[12:15], s39 offen sc1
L_st_2_j:
    s_waitcnt lgkmcnt(0)
    v_pk_mul_f32 v[136:137], v[136:137], v[84:85]
    v_pk_mul_f32 v[138:139], v[138:139], v[86:87]
    v_pk_mul_f32 v[140:141], v[140:141], v[88:89]
    v_pk_mul_f32 v[142:143], v[142:143], v[90:91]
    v_pk_mul_f32 v[144:145], v[144:145], v[92:93]
    v_pk_mul_f32 v[146:147], v[146:147], v[94:95]
    v_pk_mul_f32 v[148:149], v[148:149], v[96:97]
    v_pk_mul_f32 v[150:151], v[150:151], v[98:99]
    v_cvt_pk_bf16_f32 v48, v136, v137
    v_cvt_pk_bf16_f32 v49, v138, v139
    v_cvt_pk_bf16_f32 v50, v140, v141
    v_cvt_pk_bf16_f32 v51, v142, v143
    v_cvt_pk_bf16_f32 v52, v144, v145
    v_cvt_pk_bf16_f32 v53, v146, v147
    v_cvt_pk_bf16_f32 v54, v148, v149
    v_cvt_pk_bf16_f32 v55, v150, v151
    s_cmp_eq_u32 s54, 0
    s_cbranch_scc1 L_st_3_s
    buffer_store_dwordx4 v[48:51], v21, s[12:15], s38 offen offset:1024
    buffer_store_dwordx4 v[52:55], v21, s[12:15], s38 offen offset:1536
    s_branch L_st_3_j
L_st_3_s:
    buffer_store_dwordx4 v[48:51], v21, s[12:15], s38 offen offset:1024 sc1
    buffer_store_dwordx4 v[52:55], v21, s[12:15], s38 offen offset:1536 sc1
L_st_3_j:
    buffer_store_dwordx4 v[40:43], v20, s[12:15], s36 offen sc1
    buffer_store_dwordx4 v[44:47], v20, s[12:15], s37 offen sc1
    buffer_store_dwordx4 v[48:51], v156, s[12:15], s36 offen offset:1024 sc1
    buffer_store_dwordx4 v[52:55], v156, s[12:15], s36 offen offset:1536 sc1
    v_mov_b32 v8, 0
    v_mov_b32 v9, s53
    s_mov_b64 exec, 1
    s_waitcnt vmcnt(4)
    s_cmp_eq_u32 s54, 0
    s_cbranch_scc1 L_st_4_s
    buffer_store_dword v9, v8, s[12:15], s48 offen
    s_branch L_st_4_j
L_st_4_s:
    buffer_store_dword v9, v8, s[12:15], s48 offen sc1
L_st_4_j:
    s_mov_b64 exec, -1
    s_lshr_b32 s25, s2, 3
    s_and_b32 s26, s2, 7
    s_lshr_b32 s27, s24, 2
    s_and_b32 s28, s24, 3
    v_and_b32 v144, 27, v1
    v_cmp_eq_u32 vcc, 16, v144
    v_mov_b32 v144, 0x3f803f80
    v_mov_b32 v5, 0xdddd
    v_cndmask_b32 v32, 0, v144, vcc
    v_cndmask_b32 v33, 0, v144, vcc
    v_cndmask_b32 v34, 0, v144, vcc
    v_cndmask_b32 v35, 0, v144, vcc
    v_cndmask_b32 v36, 0, v144, vcc
    v_cndmask_b32 v37, 0, v144, vcc
    v_cndmask_b32 v38, 0, v144, vcc
    v_cndmask_b32 v39, 0, v144, vcc
    v_cndmask_b32 v40, 0, v144, vcc
    v_cndmask_b32 v41, 0, v144, vcc
    v_cndmask_b32 v42, 0, v144, vcc
    v_cndmask_b32 v43, 0, v144, vcc
    v_cndmask_b32 v44, 0, v144, vcc
    v_cndmask_b32 v45, 0, v144, vcc
    v_cndmask_b32 v46, 0, v144, vcc
    v_cndmask_b32 v47, 0, v144, vcc
    v_cndmask_b32 v48, 0, v144, vcc
    v_cndmask_b32 v49, 0, v144, vcc
    v_cndmask_b32 v50, 0, v144, vcc
    v_cndmask_b32 v51, 0, v144, vcc
    v_cndmask_b32 v52, 0, v144, vcc
    v_cndmask_b32 v53, 0, v144, vcc
    v_cndmask_b32 v54, 0, v144, vcc
    v_cndmask_b32 v55, 0, v144, vcc
    v_cndmask_b32 v56, 0, v144, vcc
    v_cndmask_b32 v57, 0, v144, vcc
    v_cndmask_b32 v58, 0, v144, vcc
    v_cndmask_b32 v59, 0, v144, vcc
    v_cndmask_b32 v60, 0, v144, vcc
    v_cndmask_b32 v61, 0, v144, vcc
    v_cndmask_b32 v62, 0, v144, vcc
    v_cndmask_b32 v63, 0, v144, vcc
    s_mov_b32 s34, 0x0000ffff
    s_mov_b32 s35, 0x0000ffff
    s_lshl_b32 s30, s27, 16
    v_add_u32 v3, s30, v2
    v_lshrrev_b32 v144, 5, v1
    v_and_b32 v145, 15, v1
    v_lshlrev_b32 v145, 4, v145
    v_lshl_add_u32 v144, v144, 8, v145
    v_add_u32 v4, s30, v144
    s_mul_i32 s30, s24, 3072
    s_add_u32 s30, s30, 131072
    v_add_u32 v6, s30, v2
    s_xor_b32 s31, s24, 4
    s_mul_i32 s30, s31, 3072
    s_add_u32 s30, s30, 131072
    v_add_u32 v7, s30, v2
    s_lshl_b32 s30, s28, 1
    s_add_u32 s30, s30, s27
    s_lshl_b32 s30, s30, 10
    s_add_u32 s30, s30, 131072
    v_add_u32 v146, s30, v2
    v_xor_b32 v147, 1024, v146
    s_lshl_b32 s30, s27, 4
    s_add_u32 s30, s30, 142340
    v_mov_b32 v150, s30
    v_mov_b32 v151, 1
    v_mov_b32 v96, 0
    v_mov_b32 v97, 0
    v_mov_b32 v98, 0
    v_mov_b32 v99, 0
    v_mov_b32 v100, 0
    v_mov_b32 v101, 0
    v_mov_b32 v102, 0
    v_mov_b32 v103, 0
    v_mov_b32 v104, 0
    v_mov_b32 v105, 0
    v_mov_b32 v106, 0
    v_mov_b32 v107, 0
    v_mov_b32 v108, 0
    v_mov_b32 v109, 0
    v_mov_b32 v110, 0
    v_mov_b32 v111, 0
    v_mov_b32 v112, 0
    v_mov_b32 v113, 0
    v_mov_b32 v114, 0
    v_mov_b32 v115, 0
    v_mov_b32 v116, 0
    v_mov_b32 v117, 0
    v_mov_b32 v118, 0
    v_mov_b32 v119, 0
    v_mov_b32 v120, 0
    v_mov_b32 v121, 0
    v_mov_b32 v122, 0
    v_mov_b32 v123, 0
    v_mov_b32 v124, 0
    v_mov_b32 v125, 0
    v_mov_b32 v126, 0
    v_mov_b32 v127, 0
    s_lshl_b32 s57, s26, 2
    s_add_u32 s57, s57, s28
    s_lshl_b32 s55, s57, 8
    s_lshl_b32 s31, s25, 1
    s_add_u32 s31, s31, s27
    s_lshl_b32 s31, s31, 2
    s_add_u32 s55, s55, s31
    s_add_u32 s55, s55, 11534336
    s_lshl_b32 s57, s57, 1
    s_add_u32 s57, s57, s27
    s_mul_i32 s57, s57, 126976
    s_lshl_b32 s31, s25, 10
    s_add_u32 s57, s57, s31
    s_add_u32 s57, s57, 65536
    v_mov_b32 v148, 0
    v_mov_b32 v149, s53
    s_waitcnt vmcnt(0)
    s_mov_b64 exec, 1
    buffer_store_dword v149, v148, s[12:15], s49 offen sc1
    s_mov_b64 exec, -1
L_p2_b0:
    s_mov_b32 s59, 0x100000
    s_barrier
    ds_read_b128 v[12:15], v147
    ds_read_b128 v[8:11], v146
    ds_read_b128 v[16:19], v3 offset:0
    ds_read_b128 v[20:23], v3 offset:2048
    s_mov_b64 exec, s[34:35]
    ds_read_b128 v[32:35], v4 offset:1024
    ds_read_b128 v[36:39], v4 offset:1536
    ds_read_b128 v[40:43], v4 offset:3072
    ds_read_b128 v[44:47], v4 offset:3584
    s_mov_b64 exec, -1
    s_waitcnt lgkmcnt(5)
    v_mfma_f32_32x32x16_bf16 v[64:79], v[16:19], v[12:15], 0
    s_waitcnt lgkmcnt(0)
    s_nop 9
    s_setprio 2
    v_exp_f32 v64, v64
    v_exp_f32 v65, v65
    v_exp_f32 v66, v66
    v_exp_f32 v67, v67
    v_exp_f32 v68, v68
    v_mfma_f32_32x32x16_bf16 v[80:95], v[16:19], v[8:11], 0
    ds_read_b128 v[24:27], v3 offset:4096
    ds_read_b128 v[28:31], v3 offset:6144
    s_mov_b64 exec, s[34:35]
    ds_read_b128 v[48:51], v4 offset:5120
    ds_read_b128 v[52:55], v4 offset:5632
    ds_read_b128 v[56:59], v4 offset:7168
    ds_read_b128 v[60:63], v4 offset:7680
    s_mov_b64 exec, -1
    v_exp_f32 v69, v69
    v_exp_f32 v70, v70
    v_exp_f32 v71, v71
    v_exp_f32 v72, v72
    v_exp_f32 v73, v73
    v_smfmac_f32_32x32x32_bf16 v[112:127], v[32:35], v[64:71], v5
    v_exp_f32 v74, v74
    v_exp_f32 v75, v75
    v_exp_f32 v76, v76
    v_exp_f32 v77, v77
    v_exp_f32 v78, v78
    v_exp_f32 v79, v79
    v_exp_f32 v80, v80
    v_exp_f32 v81, v81
    v_smfmac_f32_32x32x32_bf16 v[112:127], v[36:39], v[72:79], v5
    v_exp_f32 v82, v82
    v_exp_f32 v83, v83
    v_exp_f32 v84, v84
    v_mfma_f32_32x32x16_bf16 v[64:79], v[20:23], v[12:15], 0
    v_exp_f32 v85, v85
    v_exp_f32 v86, v86
    v_exp_f32 v87, v87
    v_exp_f32 v88, v88
    v_exp_f32 v89, v89
    v_smfmac_f32_32x32x32_bf16 v[96:111], v[32:35], v[80:87], v5
    v_exp_f32 v90, v90
    v_exp_f32 v91, v91
    v_exp_f32 v92, v92
    v_exp_f32 v93, v93
    v_exp_f32 v94, v94
    v_exp_f32 v95, v95
    v_exp_f32 v64, v64
    v_exp_f32 v65, v65
    v_smfmac_f32_32x32x32_bf16 v[96:111], v[36:39], v[88:95], v5
    v_exp_f32 v66, v66
    v_exp_f32 v67, v67
    v_exp_f32 v68, v68
    v_mfma_f32_32x32x16_bf16 v[80:95], v[20:23], v[8:11], 0
    v_exp_f32 v69, v69
    v_exp_f32 v70, v70
    v_exp_f32 v71, v71
    v_exp_f32 v72, v72
    v_exp_f32 v73, v73
    v_smfmac_f32_32x32x32_bf16 v[112:127], v[40:43], v[64:71], v5
    v_exp_f32 v74, v74
    v_exp_f32 v75, v75
    v_exp_f32 v76, v76
    v_exp_f32 v77, v77
    v_exp_f32 v78, v78
    v_exp_f32 v79, v79
    v_exp_f32 v80, v80
    v_exp_f32 v81, v81
    v_smfmac_f32_32x32x32_bf16 v[112:127], v[44:47], v[72:79], v5
    v_exp_f32 v82, v82
    v_exp_f32 v83, v83
    v_exp_f32 v84, v84
    s_waitcnt lgkmcnt(0)
    v_mfma_f32_32x32x16_bf16 v[64:79], v[24:27], v[12:15], 0
    v_exp_f32 v85, v85
    v_exp_f32 v86, v86
    v_exp_f32 v87, v87
    v_exp_f32 v88, v88
    v_exp_f32 v89, v89
    v_smfmac_f32_32x32x32_bf16 v[96:111], v[40:43], v[80:87], v5
    v_exp_f32 v90, v90
    v_exp_f32 v91, v91
    v_exp_f32 v92, v92
    v_exp_f32 v93, v93
    v_exp_f32 v94, v94
    v_exp_f32 v95, v95
    v_exp_f32 v64, v64
    v_exp_f32 v65, v65
    v_smfmac_f32_32x32x32_bf16 v[96:111], v[44:47], v[88:95], v5
    v_exp_f32 v66, v66
    v_exp_f32 v67, v67
    v_exp_f32 v68, v68
    v_mfma_f32_32x32x16_bf16 v[80:95], v[24:27], v[8:11], 0
    v_exp_f32 v69, v69
    v_exp_f32 v70, v70
    v_exp_f32 v71, v71
    v_exp_f32 v72, v72
    v_exp_f32 v73, v73
    v_smfmac_f32_32x32x32_bf16 v[112:127], v[48:51], v[64:71], v5
    v_exp_f32 v74, v74
    v_exp_f32 v75, v75
    v_exp_f32 v76, v76
    v_exp_f32 v77, v77
    v_exp_f32 v78, v78
    v_exp_f32 v79, v79
    v_exp_f32 v80, v80
    v_exp_f32 v81, v81
    v_smfmac_f32_32x32x32_bf16 v[112:127], v[52:55], v[72:79], v5
    v_exp_f32 v82, v82
    v_exp_f32 v83, v83
    v_exp_f32 v84, v84
    v_mfma_f32_32x32x16_bf16 v[64:79], v[28:31], v[12:15], 0
    ds_read_b32 v152, v150
    v_exp_f32 v85, v85
    v_exp_f32 v86, v86
    v_exp_f32 v87, v87
    v_exp_f32 v88, v88
    v_exp_f32 v89, v89
    v_smfmac_f32_32x32x32_bf16 v[96:111], v[48:51], v[80:87], v5
    v_exp_f32 v90, v90
    v_exp_f32 v91, v91
    v_exp_f32 v92, v92
    v_exp_f32 v93, v93
    v_exp_f32 v94, v94
    v_exp_f32 v95, v95
    v_exp_f32 v64, v64
    v_exp_f32 v65, v65
    v_smfmac_f32_32x32x32_bf16 v[96:111], v[52:55], v[88:95], v5
    v_exp_f32 v66, v66
    v_exp_f32 v67, v67
    v_exp_f32 v68, v68
    v_mfma_f32_32x32x16_bf16 v[80:95], v[28:31], v[8:11], 0
    s_waitcnt lgkmcnt(0)
L_rdy6:
    v_readfirstlane_b32 s36, v152
    s_nop 0
    s_cmp_ge_u32 s36, 1
    s_cbranch_scc0 L_rdy6_spin
    ds_read_b128 v[16:19], v3 offset:8192
    ds_read_b128 v[20:23], v3 offset:10240
    s_mov_b64 exec, s[34:35]
    ds_read_b128 v[32:35], v4 offset:9216
    ds_read_b128 v[36:39], v4 offset:9728
    ds_read_b128 v[40:43], v4 offset:11264
    ds_read_b128 v[44:47], v4 offset:11776
    s_mov_b64 exec, -1
    v_exp_f32 v69, v69
    v_exp_f32 v70, v70
    v_exp_f32 v71, v71
    v_exp_f32 v72, v72
    v_exp_f32 v73, v73
    v_smfmac_f32_32x32x32_bf16 v[112:127], v[56:59], v[64:71], v5
    v_exp_f32 v74, v74
    v_exp_f32 v75, v75
    v_exp_f32 v76, v76
    v_exp_f32 v77, v77
    v_exp_f32 v78, v78
    v_exp_f32 v79, v79
    v_exp_f32 v80, v80
    v_exp_f32 v81, v81
    v_smfmac_f32_32x32x32_bf16 v[112:127], v[60:63], v[72:79], v5
    v_exp_f32 v82, v82
    v_exp_f32 v83, v83
    v_exp_f32 v84, v84
    s_waitcnt lgkmcnt(0)
    v_mfma_f32_32x32x16_bf16 v[64:79], v[16:19], v[12:15], 0
    v_exp_f32 v85, v85
    v_exp_f32 v86, v86
    v_exp_f32 v87, v87
    v_exp_f32 v88, v88
    v_exp_f32 v89, v89
    v_smfmac_f32_32x32x32_bf16 v[96:111], v[56:59], v[80:87], v5
    v_exp_f32 v90, v90
    v_exp_f32 v91, v91
    v_exp_f32 v92, v92
    v_exp_f32 v93, v93
    v_exp_f32 v94, v94
    v_exp_f32 v95, v95
    v_exp_f32 v64, v64
    v_exp_f32 v65, v65
    v_smfmac_f32_32x32x32_bf16 v[96:111], v[60:63], v[88:95], v5
    v_exp_f32 v66, v66
    v_exp_f32 v67, v67
    v_exp_f32 v68, v68
    v_mfma_f32_32x32x16_bf16 v[80:95], v[16:19], v[8:11], 0
    ds_read_b128 v[24:27], v3 offset:12288
    ds_read_b128 v[28:31], v3 offset:14336
    s_mov_b64 exec, s[34:35]
    ds_read_b128 v[48:51], v4 offset:13312
    ds_read_b128 v[52:55], v4 offset:13824
    ds_read_b128 v[56:59], v4 offset:15360
    ds_read_b128 v[60:63], v4 offset:15872
    s_mov_b64 exec, -1
    v_exp_f32 v69, v69
    v_exp_f32 v70, v70
    v_exp_f32 v71, v71
    v_exp_f32 v72, v72
    v_exp_f32 v73, v73
    v_smfmac_f32_32x32x32_bf16 v[112:127], v[32:35], v[64:71], v5
    v_exp_f32 v74, v74
    v_exp_f32 v75, v75
    v_exp_f32 v76, v76
    v_exp_f32 v77, v77
    v_exp_f32 v78, v78
    v_exp_f32 v79, v79
    v_exp_f32 v80, v80
    v_exp_f32 v81, v81
    v_smfmac_f32_32x32x32_bf16 v[112:127], v[36:39], v[72:79], v5
    v_exp_f32 v82, v82
    v_exp_f32 v83, v83
    v_exp_f32 v84, v84
    v_mfma_f32_32x32x16_bf16 v[64:79], v[20:23], v[12:15], 0
    v_exp_f32 v85, v85
    v_exp_f32 v86, v86
    v_exp_f32 v87, v87
    v_exp_f32 v88, v88
    v_exp_f32 v89, v89
    v_smfmac_f32_32x32x32_bf16 v[96:111], v[32:35], v[80:87], v5
    v_exp_f32 v90, v90
    v_exp_f32 v91, v91
    v_exp_f32 v92, v92
    v_exp_f32 v93, v93
    v_exp_f32 v94, v94
    v_exp_f32 v95, v95
    v_exp_f32 v64, v64
    v_exp_f32 v65, v65
    v_smfmac_f32_32x32x32_bf16 v[96:111], v[36:39], v[88:95], v5
    v_exp_f32 v66, v66
    v_exp_f32 v67, v67
    v_exp_f32 v68, v68
    v_mfma_f32_32x32x16_bf16 v[80:95], v[20:23], v[8:11], 0
    v_exp_f32 v69, v69
    v_exp_f32 v70, v70
    v_exp_f32 v71, v71
    v_exp_f32 v72, v72
    v_exp_f32 v73, v73
    v_smfmac_f32_32x32x32_bf16 v[112:127], v[40:43], v[64:71], v5
    v_exp_f32 v74, v74
    v_exp_f32 v75, v75
    v_exp_f32 v76, v76
    v_exp_f32 v77, v77
    v_exp_f32 v78, v78
    v_exp_f32 v79, v79
    v_exp_f32 v80, v80
    v_exp_f32 v81, v81
    v_smfmac_f32_32x32x32_bf16 v[112:127], v[44:47], v[72:79], v5
    v_exp_f32 v82, v82
    v_exp_f32 v83, v83
    v_exp_f32 v84, v84
    s_waitcnt lgkmcnt(0)
    v_mfma_f32_32x32x16_bf16 v[64:79], v[24:27], v[12:15], 0
    ds_read_b32 v152, v150
    v_exp_f32 v85, v85
    v_exp_f32 v86, v86
    v_exp_f32 v87, v87
    v_exp_f32 v88, v88
    v_exp_f32 v89, v89
    v_smfmac_f32_32x32x32_bf16 v[96:111], v[40:43], v[80:87], v5
    v_exp_f32 v90, v90
    v_exp_f32 v91, v91
    v_exp_f32 v92, v92
    v_exp_f32 v93, v93
    v_exp_f32 v94, v94
    v_exp_f32 v95, v95
    v_exp_f32 v64, v64
    v_exp_f32 v65, v65
    v_smfmac_f32_32x32x32_bf16 v[96:111], v[44:47], v[88:95], v5
    v_exp_f32 v66, v66
    v_exp_f32 v67, v67
    v_exp_f32 v68, v68
    v_mfma_f32_32x32x16_bf16 v[80:95], v[24:27], v[8:11], 0
    s_waitcnt lgkmcnt(0)
L_rdy12:
    v_readfirstlane_b32 s36, v152
    s_nop 0
    s_cmp_ge_u32 s36, 2
    s_cbranch_scc0 L_rdy12_spin
    ds_read_b128 v[16:19], v3 offset:16384
    ds_read_b128 v[20:23], v3 offset:18432
    s_mov_b64 exec, s[34:35]
    ds_read_b128 v[32:35], v4 offset:17408
    ds_read_b128 v[36:39], v4 offset:17920
    ds_read_b128 v[40:43], v4 offset:19456
    ds_read_b128 v[44:47], v4 offset:19968
    s_mov_b64 exec, -1
    v_exp_f32 v69, v69
    v_exp_f32 v70, v70
    v_exp_f32 v71, v71
    v_exp_f32 v72, v72
    v_exp_f32 v73, v73
    v_smfmac_f32_32x32x32_bf16 v[112:127], v[48:51], v[64:71], v5
    v_exp_f32 v74, v74
    v_exp_f32 v75, v75
    v_exp_f32 v76, v76
    v_exp_f32 v77, v77
    v_exp_f32 v78, v78
    v_exp_f32 v79, v79
    v_exp_f32 v80, v80
    v_exp_f32 v81, v81
    v_smfmac_f32_32x32x32_bf16 v[112:127], v[52:55], v[72:79], v5
    v_exp_f32 v82, v82
    v_exp_f32 v83, v83
    v_exp_f32 v84, v84
    v_mfma_f32_32x32x16_bf16 v[64:79], v[28:31], v[12:15], 0
    v_exp_f32 v85, v85
    v_exp_f32 v86, v86
    v_exp_f32 v87, v87
    v_exp_f32 v88, v88
    v_exp_f32 v89, v89
    v_smfmac_f32_32x32x32_bf16 v[96:111], v[48:51], v[80:87], v5
    v_exp_f32 v90, v90
    v_exp_f32 v91, v91
    v_exp_f32 v92, v92
    v_exp_f32 v93, v93
    v_exp_f32 v94, v94
    v_exp_f32 v95, v95
    v_exp_f32 v64, v64
    v_exp_f32 v65, v65
    v_smfmac_f32_32x32x32_bf16 v[96:111], v[52:55], v[88:95], v5
    v_exp_f32 v66, v66
    v_exp_f32 v67, v67
    v_exp_f32 v68, v68
    v_mfma_f32_32x32x16_bf16 v[80:95], v[28:31], v[8:11], 0
    v_exp_f32 v69, v69
    v_exp_f32 v70, v70
    v_exp_f32 v71, v71
    v_exp_f32 v72, v72
    v_exp_f32 v73, v73
    v_smfmac_f32_32x32x32_bf16 v[112:127], v[56:59], v[64:71], v5
    v_exp_f32 v74, v74
    v_exp_f32 v75, v75
    v_exp_f32 v76, v76
    v_exp_f32 v77, v77
    v_exp_f32 v78, v78
    v_exp_f32 v79, v79
    v_exp_f32 v80, v80
    v_exp_f32 v81, v81
    v_smfmac_f32_32x32x32_bf16 v[112:127], v[60:63], v[72:79], v5
    v_exp_f32 v82, v82
    v_exp_f32 v83, v83
    v_exp_f32 v84, v84
    s_waitcnt lgkmcnt(0)
    v_mfma_f32_32x32x16_bf16 v[64:79], v[16:19], v[12:15], 0
    v_exp_f32 v85, v85
    v_exp_f32 v86, v86
    v_exp_f32 v87, v87
    v_exp_f32 v88, v88
    v_exp_f32 v89, v89
    v_smfmac_f32_32x32x32_bf16 v[96:111], v[56:59], v[80:87], v5
    v_exp_f32 v90, v90
    v_exp_f32 v91, v91
    v_exp_f32 v92, v92
    v_exp_f32 v93, v93
    v_exp_f32 v94, v94
    v_exp_f32 v95, v95
    v_exp_f32 v64, v64
    v_exp_f32 v65, v65
    v_smfmac_f32_32x32x32_bf16 v[96:111], v[60:63], v[88:95], v5
    v_exp_f32 v66, v66
    v_exp_f32 v67, v67
    v_exp_f32 v68, v68
    v_mfma_f32_32x32x16_bf16 v[80:95], v[16:19], v[8:11], 0
    ds_read_b128 v[24:27], v3 offset:20480
    ds_read_b128 v[28:31], v3 offset:22528
    s_mov_b64 exec, s[34:35]
    ds_read_b128 v[48:51], v4 offset:21504
    ds_read_b128 v[52:55], v4 offset:22016
    ds_read_b128 v[56:59], v4 offset:23552
    ds_read_b128 v[60:63], v4 offset:24064
    s_mov_b64 exec, -1
    v_exp_f32 v69, v69
    v_exp_f32 v70, v70
    v_exp_f32 v71, v71
    v_exp_f32 v72, v72
    v_exp_f32 v73, v73
    v_smfmac_f32_32x32x32_bf16 v[112:127], v[32:35], v[64:71], v5
    v_exp_f32 v74, v74
    v_exp_f32 v75, v75
    v_exp_f32 v76, v76
    v_exp_f32 v77, v77
    v_exp_f32 v78, v78
    v_exp_f32 v79, v79
    v_exp_f32 v80, v80
    v_exp_f32 v81, v81
    v_smfmac_f32_32x32x32_bf16 v[112:127], v[36:39], v[72:79], v5
    v_exp_f32 v82, v82
    v_exp_f32 v83, v83
    v_exp_f32 v84, v84
    v_mfma_f32_32x32x16_bf16 v[64:79], v[20:23], v[12:15], 0
    v_exp_f32 v85, v85
    v_exp_f32 v86, v86
    v_exp_f32 v87, v87
    v_exp_f32 v88, v88
    v_exp_f32 v89, v89
    v_smfmac_f32_32x32x32_bf16 v[96:111], v[32:35], v[80:87], v5
    v_exp_f32 v90, v90
    v_exp_f32 v91, v91
    v_exp_f32 v92, v92
    v_exp_f32 v93, v93
    v_exp_f32 v94, v94
    v_exp_f32 v95, v95
    v_exp_f32 v64, v64
    v_exp_f32 v65, v65
    v_smfmac_f32_32x32x32_bf16 v[96:111], v[36:39], v[88:95], v5
    v_exp_f32 v66, v66
    v_exp_f32 v67, v67
    v_exp_f32 v68, v68
    v_mfma_f32_32x32x16_bf16 v[80:95], v[20:23], v[8:11], 0
    v_exp_f32 v69, v69
    v_exp_f32 v70, v70
    v_exp_f32 v71, v71
    v_exp_f32 v72, v72
    v_exp_f32 v73, v73
    v_smfmac_f32_32x32x32_bf16 v[112:127], v[40:43], v[64:71], v5
    v_exp_f32 v74, v74
    v_exp_f32 v75, v75
    v_exp_f32 v76, v76
    v_exp_f32 v77, v77
    v_exp_f32 v78, v78
    v_exp_f32 v79, v79
    v_exp_f32 v80, v80
    v_exp_f32 v81, v81
    v_smfmac_f32_32x32x32_bf16 v[112:127], v[44:47], v[72:79], v5
    v_exp_f32 v82, v82
    v_exp_f32 v83, v83
    v_exp_f32 v84, v84
    s_waitcnt lgkmcnt(0)
    v_mfma_f32_32x32x16_bf16 v[64:79], v[24:27], v[12:15], 0
    ds_read_b32 v152, v150
    v_exp_f32 v85, v85
    v_exp_f32 v86, v86
    v_exp_f32 v87, v87
    v_exp_f32 v88, v88
    v_exp_f32 v89, v89
    v_smfmac_f32_32x32x32_bf16 v[96:111], v[40:43], v[80:87], v5
    v_exp_f32 v90, v90
    v_exp_f32 v91, v91
    v_exp_f32 v92, v92
    v_exp_f32 v93, v93
    v_exp_f32 v94, v94
    v_exp_f32 v95, v95
    v_exp_f32 v64, v64
    v_exp_f32 v65, v65
    v_smfmac_f32_32x32x32_bf16 v[96:111], v[44:47], v[88:95], v5
    v_exp_f32 v66, v66
    v_exp_f32 v67, v67
    v_exp_f32 v68, v68
    v_mfma_f32_32x32x16_bf16 v[80:95], v[24:27], v[8:11], 0
    s_waitcnt lgkmcnt(0)
L_rdy20:
    v_readfirstlane_b32 s36, v152
    s_nop 0
    s_cmp_ge_u32 s36, 3
    s_cbranch_scc0 L_rdy20_spin
    ds_read_b128 v[16:19], v3 offset:24576
    ds_read_b128 v[20:23], v3 offset:26624
    s_mov_b64 exec, s[34:35]
    ds_read_b128 v[32:35], v4 offset:25600
    ds_read_b128 v[36:39], v4 offset:26112
    ds_read_b128 v[40:43], v4 offset:27648
    ds_read_b128 v[44:47], v4 offset:28160
    s_mov_b64 exec, -1
    v_exp_f32 v69, v69
    v_exp_f32 v70, v70
    v_exp_f32 v71, v71
    v_exp_f32 v72, v72
    v_exp_f32 v73, v73
    v_smfmac_f32_32x32x32_bf16 v[112:127], v[48:51], v[64:71], v5
    v_exp_f32 v74, v74
    v_exp_f32 v75, v75
    v_exp_f32 v76, v76
    v_exp_f32 v77, v77
    v_exp_f32 v78, v78
    v_exp_f32 v79, v79
    v_exp_f32 v80, v80
    v_exp_f32 v81, v81
    v_smfmac_f32_32x32x32_bf16 v[112:127], v[52:55], v[72:79], v5
    v_exp_f32 v82, v82
    v_exp_f32 v83, v83
    v_exp_f32 v84, v84
    v_mfma_f32_32x32x16_bf16 v[64:79], v[28:31], v[12:15], 0
    v_exp_f32 v85, v85
    v_exp_f32 v86, v86
    v_exp_f32 v87, v87
    v_exp_f32 v88, v88
    v_exp_f32 v89, v89
    v_smfmac_f32_32x32x32_bf16 v[96:111], v[48:51], v[80:87], v5
    v_exp_f32 v90, v90
    v_exp_f32 v91, v91
    v_exp_f32 v92, v92
    v_exp_f32 v93, v93
    v_exp_f32 v94, v94
    v_exp_f32 v95, v95
    v_exp_f32 v64, v64
    v_exp_f32 v65, v65
    v_smfmac_f32_32x32x32_bf16 v[96:111], v[52:55], v[88:95], v5
    v_exp_f32 v66, v66
    v_exp_f32 v67, v67
    v_exp_f32 v68, v68
    v_mfma_f32_32x32x16_bf16 v[80:95], v[28:31], v[8:11], 0
    v_exp_f32 v69, v69
    v_exp_f32 v70, v70
    v_exp_f32 v71, v71
    v_exp_f32 v72, v72
    v_exp_f32 v73, v73
    v_smfmac_f32_32x32x32_bf16 v[112:127], v[56:59], v[64:71], v5
    v_exp_f32 v74, v74
    v_exp_f32 v75, v75
    v_exp_f32 v76, v76
    v_exp_f32 v77, v77
    v_exp_f32 v78, v78
    v_exp_f32 v79, v79
    v_exp_f32 v80, v80
    v_exp_f32 v81, v81
    v_smfmac_f32_32x32x32_bf16 v[112:127], v[60:63], v[72:79], v5
    v_exp_f32 v82, v82
    v_exp_f32 v83, v83
    v_exp_f32 v84, v84
    s_waitcnt lgkmcnt(0)
    v_mfma_f32_32x32x16_bf16 v[64:79], v[16:19], v[12:15], 0
    v_exp_f32 v85, v85
    v_exp_f32 v86, v86
    v_exp_f32 v87, v87
    v_exp_f32 v88, v88
    v_exp_f32 v89, v89
    v_smfmac_f32_32x32x32_bf16 v[96:111], v[56:59], v[80:87], v5
    v_exp_f32 v90, v90
    v_exp_f32 v91, v91
    v_exp_f32 v92, v92
    v_exp_f32 v93, v93
    v_exp_f32 v94, v94
    v_exp_f32 v95, v95
    v_exp_f32 v64, v64
    v_exp_f32 v65, v65
    v_smfmac_f32_32x32x32_bf16 v[96:111], v[60:63], v[88:95], v5
    v_exp_f32 v66, v66
    v_exp_f32 v67, v67
    v_exp_f32 v68, v68
    v_mfma_f32_32x32x16_bf16 v[80:95], v[16:19], v[8:11], 0
    ds_read_b128 v[24:27], v3 offset:28672
    ds_read_b128 v[28:31], v3 offset:30720
    s_mov_b64 exec, s[34:35]
    ds_read_b128 v[48:51], v4 offset:29696
    ds_read_b128 v[52:55], v4 offset:30208
    ds_read_b128 v[56:59], v4 offset:31744
    ds_read_b128 v[60:63], v4 offset:32256
    s_mov_b64 exec, -1
    v_exp_f32 v69, v69
    v_exp_f32 v70, v70
    v_exp_f32 v71, v71
    v_exp_f32 v72, v72
    v_exp_f32 v73, v73
    v_smfmac_f32_32x32x32_bf16 v[112:127], v[32:35], v[64:71], v5
    v_exp_f32 v74, v74
    v_exp_f32 v75, v75
    v_exp_f32 v76, v76
    v_exp_f32 v77, v77
    v_exp_f32 v78, v78
    v_exp_f32 v79, v79
    v_exp_f32 v80, v80
    v_exp_f32 v81, v81
    v_smfmac_f32_32x32x32_bf16 v[112:127], v[36:39], v[72:79], v5
    v_exp_f32 v82, v82
    v_exp_f32 v83, v83
    v_exp_f32 v84, v84
    v_mfma_f32_32x32x16_bf16 v[64:79], v[20:23], v[12:15], 0
    v_exp_f32 v85, v85
    v_exp_f32 v86, v86
    v_exp_f32 v87, v87
    v_exp_f32 v88, v88
    v_exp_f32 v89, v89
    v_smfmac_f32_32x32x32_bf16 v[96:111], v[32:35], v[80:87], v5
    v_exp_f32 v90, v90
    v_exp_f32 v91, v91
    v_exp_f32 v92, v92
    v_exp_f32 v93, v93
    v_exp_f32 v94, v94
    v_exp_f32 v95, v95
    v_exp_f32 v64, v64
    v_exp_f32 v65, v65
    v_smfmac_f32_32x32x32_bf16 v[96:111], v[36:39], v[88:95], v5
    v_exp_f32 v66, v66
    v_exp_f32 v67, v67
    v_exp_f32 v68, v68
    v_mfma_f32_32x32x16_bf16 v[80:95], v[20:23], v[8:11], 0
    v_exp_f32 v69, v69
    v_exp_f32 v70, v70
    v_exp_f32 v71, v71
    v_exp_f32 v72, v72
    v_exp_f32 v73, v73
    v_smfmac_f32_32x32x32_bf16 v[112:127], v[40:43], v[64:71], v5
    v_exp_f32 v74, v74
    v_exp_f32 v75, v75
    v_exp_f32 v76, v76
    v_exp_f32 v77, v77
    v_exp_f32 v78, v78
    v_exp_f32 v79, v79
    v_exp_f32 v80, v80
    v_exp_f32 v81, v81
    v_smfmac_f32_32x32x32_bf16 v[112:127], v[44:47], v[72:79], v5
    v_exp_f32 v82, v82
    v_exp_f32 v83, v83
    v_exp_f32 v84, v84
    s_waitcnt lgkmcnt(0)
    v_mfma_f32_32x32x16_bf16 v[64:79], v[24:27], v[12:15], 0
    ds_read_b32 v152, v150
    v_exp_f32 v85, v85
    v_exp_f32 v86, v86
    v_exp_f32 v87, v87
    v_exp_f32 v88, v88
    v_exp_f32 v89, v89
    v_smfmac_f32_32x32x32_bf16 v[96:111], v[40:43], v[80:87], v5
    v_exp_f32 v90, v90
    v_exp_f32 v91, v91
    v_exp_f32 v92, v92
    v_exp_f32 v93, v93
    v_exp_f32 v94, v94
    v_exp_f32 v95, v95
    v_exp_f32 v64, v64
    v_exp_f32 v65, v65
    v_smfmac_f32_32x32x32_bf16 v[96:111], v[44:47], v[88:95], v5
    v_exp_f32 v66, v66
    v_exp_f32 v67, v67
    v_exp_f32 v68, v68
    v_mfma_f32_32x32x16_bf16 v[80:95], v[24:27], v[8:11], 0
    s_waitcnt lgkmcnt(0)
L_rdy28:
    v_readfirstlane_b32 s36, v152
    s_nop 0
    s_cmp_ge_u32 s36, 4
    s_cbranch_scc0 L_rdy28_spin
    ds_read_b128 v[16:19], v3 offset:32768
    ds_read_b128 v[20:23], v3 offset:34816
    s_mov_b64 exec, s[34:35]
    ds_read_b128 v[32:35], v4 offset:33792
    ds_read_b128 v[36:39], v4 offset:34304
    ds_read_b128 v[40:43], v4 offset:35840
    ds_read_b128 v[44:47], v4 offset:36352
    s_mov_b64 exec, 1
    ds_add_u32 v150, v151 offset:8
    s_mov_b64 exec, -1
    v_exp_f32 v69, v69
    v_exp_f32 v70, v70
    v_exp_f32 v71, v71
    v_exp_f32 v72, v72
    v_exp_f32 v73, v73
    v_smfmac_f32_32x32x32_bf16 v[112:127], v[48:51], v[64:71], v5
    v_exp_f32 v74, v74
    v_exp_f32 v75, v75
    v_exp_f32 v76, v76
    v_exp_f32 v77, v77
    v_exp_f32 v78, v78
    v_exp_f32 v79, v79
    s_setprio 1
    v_exp_f32 v80, v80
    v_exp_f32 v81, v81
    v_smfmac_f32_32x32x32_bf16 v[112:127], v[52:55], v[72:79], v5
    v_exp_f32 v82, v82
    v_exp_f32 v83, v83
    v_exp_f32 v84, v84
    v_mfma_f32_32x32x16_bf16 v[64:79], v[28:31], v[12:15], 0
    v_exp_f32 v85, v85
    v_exp_f32 v86, v86
    v_exp_f32 v87, v87
    v_exp_f32 v88, v88
    v_exp_f32 v89, v89
    v_smfmac_f32_32x32x32_bf16 v[96:111], v[48:51], v[80:87], v5
    v_exp_f32 v90, v90
    v_exp_f32 v91, v91
    v_exp_f32 v92, v92
    v_exp_f32 v93, v93
    v_exp_f32 v94, v94
    v_exp_f32 v95, v95
    v_exp_f32 v64, v64
    v_exp_f32 v65, v65
    v_smfmac_f32_32x32x32_bf16 v[96:111], v[52:55], v[88:95], v5
    v_exp_f32 v66, v66
    v_exp_f32 v67, v67
    v_exp_f32 v68, v68
    v_mfma_f32_32x32x16_bf16 v[80:95], v[28:31], v[8:11], 0
    v_exp_f32 v69, v69
    v_exp_f32 v70, v70
    v_exp_f32 v71, v71
    v_exp_f32 v72, v72
    v_exp_f32 v73, v73
    v_smfmac_f32_32x32x32_bf16 v[112:127], v[56:59], v[64:71], v5
    v_exp_f32 v74, v74
    v_exp_f32 v75, v75
    v_exp_f32 v76, v76
    v_exp_f32 v77, v77
    v_exp_f32 v78, v78
    v_exp_f32 v79, v79
    v_exp_f32 v80, v80
    v_exp_f32 v81, v81
    v_smfmac_f32_32x32x32_bf16 v[112:127], v[60:63], v[72:79], v5
    v_exp_f32 v82, v82
    v_exp_f32 v83, v83
    v_exp_f32 v84, v84
    s_waitcnt lgkmcnt(1)
    v_mfma_f32_32x32x16_bf16 v[64:79], v[16:19], v[12:15], 0
    v_exp_f32 v85, v85
    v_exp_f32 v86, v86
    v_exp_f32 v87, v87
    v_exp_f32 v88, v88
    v_exp_f32 v89, v89
    v_smfmac_f32_32x32x32_bf16 v[96:111], v[56:59], v[80:87], v5
    v_exp_f32 v90, v90
    v_exp_f32 v91, v91
    v_exp_f32 v92, v92
    v_exp_f32 v93, v93
    v_exp_f32 v94, v94
    v_exp_f32 v95, v95
    v_exp_f32 v64, v64
    v_exp_f32 v65, v65
    v_smfmac_f32_32x32x32_bf16 v[96:111], v[60:63], v[88:95], v5
    v_exp_f32 v66, v66
    v_exp_f32 v67, v67
    v_exp_f32 v68, v68
    v_mfma_f32_32x32x16_bf16 v[80:95], v[16:19], v[8:11], 0
    ds_read_b128 v[24:27], v3 offset:36864
    ds_read_b128 v[28:31], v3 offset:38912
    s_mov_b64 exec, s[34:35]
    ds_read_b128 v[48:51], v4 offset:37888
    ds_read_b128 v[52:55], v4 offset:38400
    ds_read_b128 v[56:59], v4 offset:39936
    ds_read_b128 v[60:63], v4 offset:40448
    s_mov_b64 exec, -1
    v_exp_f32 v69, v69
    v_exp_f32 v70, v70
    v_exp_f32 v71, v71
    v_exp_f32 v72, v72
    v_exp_f32 v73, v73
    v_smfmac_f32_32x32x32_bf16 v[112:127], v[32:35], v[64:71], v5
    v_exp_f32 v74, v74
    v_exp_f32 v75, v75
    v_exp_f32 v76, v76
    v_exp_f32 v77, v77
    v_exp_f32 v78, v78
    v_exp_f32 v79, v79
    v_exp_f32 v80, v80
    v_exp_f32 v81, v81
    v_smfmac_f32_32x32x32_bf16 v[112:127], v[36:39], v[72:79], v5
    v_exp_f32 v82, v82
    v_exp_f32 v83, v83
    v_exp_f32 v84, v84
    v_mfma_f32_32x32x16_bf16 v[64:79], v[20:23], v[12:15], 0
    v_exp_f32 v85, v85
    v_exp_f32 v86, v86
    v_exp_f32 v87, v87
    v_exp_f32 v88, v88
    v_exp_f32 v89, v89
    v_smfmac_f32_32x32x32_bf16 v[96:111], v[32:35], v[80:87], v5
    v_exp_f32 v90, v90
    v_exp_f32 v91, v91
    v_exp_f32 v92, v92
    v_exp_f32 v93, v93
    v_exp_f32 v94, v94
    v_exp_f32 v95, v95
    v_exp_f32 v64, v64
    v_exp_f32 v65, v65
    v_smfmac_f32_32x32x32_bf16 v[96:111], v[36:39], v[88:95], v5
    v_exp_f32 v66, v66
    v_exp_f32 v67, v67
    v_exp_f32 v68, v68
    v_mfma_f32_32x32x16_bf16 v[80:95], v[20:23], v[8:11], 0
    v_exp_f32 v69, v69
    v_exp_f32 v70, v70
    v_exp_f32 v71, v71
    v_exp_f32 v72, v72
    v_exp_f32 v73, v73
    v_smfmac_f32_32x32x32_bf16 v[112:127], v[40:43], v[64:71], v5
    v_exp_f32 v74, v74
    v_exp_f32 v75, v75
    v_exp_f32 v76, v76
    v_exp_f32 v77, v77
    v_exp_f32 v78, v78
    v_exp_f32 v79, v79
    v_exp_f32 v80, v80
    v_exp_f32 v81, v81
    v_smfmac_f32_32x32x32_bf16 v[112:127], v[44:47], v[72:79], v5
    v_exp_f32 v82, v82
    v_exp_f32 v83, v83
    v_exp_f32 v84, v84
    s_waitcnt lgkmcnt(0)
    v_mfma_f32_32x32x16_bf16 v[64:79], v[24:27], v[12:15], 0
    ds_read_b32 v152, v150
    v_exp_f32 v85, v85
    v_exp_f32 v86, v86
    v_exp_f32 v87, v87
    v_exp_f32 v88, v88
    v_exp_f32 v89, v89
    v_smfmac_f32_32x32x32_bf16 v[96:111], v[40:43], v[80:87], v5
    v_exp_f32 v90, v90
    v_exp_f32 v91, v91
    v_exp_f32 v92, v92
    v_exp_f32 v93, v93
    v_exp_f32 v94, v94
    v_exp_f32 v95, v95
    v_exp_f32 v64, v64
    v_exp_f32 v65, v65
    v_smfmac_f32_32x32x32_bf16 v[96:111], v[44:47], v[88:95], v5
    v_exp_f32 v66, v66
    v_exp_f32 v67, v67
    v_exp_f32 v68, v68
    v_mfma_f32_32x32x16_bf16 v[80:95], v[24:27], v[8:11], 0
    s_waitcnt lgkmcnt(0)
L_rdy36:
    v_readfirstlane_b32 s36, v152
    s_nop 0
    s_cmp_ge_u32 s36, 5
    s_cbranch_scc0 L_rdy36_spin
    ds_read_b128 v[16:19], v3 offset:40960
    ds_read_b128 v[20:23], v3 offset:43008
    s_mov_b64 exec, s[34:35]
    ds_read_b128 v[32:35], v4 offset:41984
    ds_read_b128 v[36:39], v4 offset:42496
    ds_read_b128 v[40:43], v4 offset:44032
    ds_read_b128 v[44:47], v4 offset:44544
    s_mov_b64 exec, -1
    v_exp_f32 v69, v69
    v_exp_f32 v70, v70
    v_exp_f32 v71, v71
    v_exp_f32 v72, v72
    v_exp_f32 v73, v73
    v_smfmac_f32_32x32x32_bf16 v[112:127], v[48:51], v[64:71], v5
    v_exp_f32 v74, v74
    v_exp_f32 v75, v75
    v_exp_f32 v76, v76
    v_exp_f32 v77, v77
    v_exp_f32 v78, v78
    v_exp_f32 v79, v79
    v_exp_f32 v80, v80
    v_exp_f32 v81, v81
    v_smfmac_f32_32x32x32_bf16 v[112:127], v[52:55], v[72:79], v5
    v_exp_f32 v82, v82
    v_exp_f32 v83, v83
    v_exp_f32 v84, v84
    v_mfma_f32_32x32x16_bf16 v[64:79], v[28:31], v[12:15], 0
    v_exp_f32 v85, v85
    v_exp_f32 v86, v86
    v_exp_f32 v87, v87
    v_exp_f32 v88, v88
    v_exp_f32 v89, v89
    v_smfmac_f32_32x32x32_bf16 v[96:111], v[48:51], v[80:87], v5
    v_exp_f32 v90, v90
    v_exp_f32 v91, v91
    v_exp_f32 v92, v92
    v_exp_f32 v93, v93
    v_exp_f32 v94, v94
    v_exp_f32 v95, v95
    v_exp_f32 v64, v64
    v_exp_f32 v65, v65
    v_smfmac_f32_32x32x32_bf16 v[96:111], v[52:55], v[88:95], v5
    v_exp_f32 v66, v66
    v_exp_f32 v67, v67
    v_exp_f32 v68, v68
    v_mfma_f32_32x32x16_bf16 v[80:95], v[28:31], v[8:11], 0
    v_exp_f32 v69, v69
    v_exp_f32 v70, v70
    v_exp_f32 v71, v71
    v_exp_f32 v72, v72
    v_exp_f32 v73, v73
    v_smfmac_f32_32x32x32_bf16 v[112:127], v[56:59], v[64:71], v5
    v_exp_f32 v74, v74
    v_exp_f32 v75, v75
    v_exp_f32 v76, v76
    v_exp_f32 v77, v77
    v_exp_f32 v78, v78
    v_exp_f32 v79, v79
    v_exp_f32 v80, v80
    v_exp_f32 v81, v81
    v_smfmac_f32_32x32x32_bf16 v[112:127], v[60:63], v[72:79], v5
    v_exp_f32 v82, v82
    v_exp_f32 v83, v83
    v_exp_f32 v84, v84
    s_waitcnt lgkmcnt(0)
    v_mfma_f32_32x32x16_bf16 v[64:79], v[16:19], v[12:15], 0
    v_exp_f32 v85, v85
    v_exp_f32 v86, v86
    v_exp_f32 v87, v87
    v_exp_f32 v88, v88
    v_exp_f32 v89, v89
    v_smfmac_f32_32x32x32_bf16 v[96:111], v[56:59], v[80:87], v5
    v_exp_f32 v90, v90
    v_exp_f32 v91, v91
    v_exp_f32 v92, v92
    v_exp_f32 v93, v93
    v_exp_f32 v94, v94
    v_exp_f32 v95, v95
    v_exp_f32 v64, v64
    v_exp_f32 v65, v65
    v_smfmac_f32_32x32x32_bf16 v[96:111], v[60:63], v[88:95], v5
    v_exp_f32 v66, v66
    v_exp_f32 v67, v67
    v_exp_f32 v68, v68
    v_mfma_f32_32x32x16_bf16 v[80:95], v[16:19], v[8:11], 0
    ds_read_b128 v[24:27], v3 offset:45056
    ds_read_b128 v[28:31], v3 offset:47104
    s_mov_b64 exec, s[34:35]
    ds_read_b128 v[48:51], v4 offset:46080
    ds_read_b128 v[52:55], v4 offset:46592
    ds_read_b128 v[56:59], v4 offset:48128
    ds_read_b128 v[60:63], v4 offset:48640
    s_mov_b64 exec, -1
    v_exp_f32 v69, v69
    v_exp_f32 v70, v70
    v_exp_f32 v71, v71
    v_exp_f32 v72, v72
    v_exp_f32 v73, v73
    v_smfmac_f32_32x32x32_bf16 v[112:127], v[32:35], v[64:71], v5
    v_exp_f32 v74, v74
    v_exp_f32 v75, v75
    v_exp_f32 v76, v76
    v_exp_f32 v77, v77
    v_exp_f32 v78, v78
    v_exp_f32 v79, v79
    v_exp_f32 v80, v80
    v_exp_f32 v81, v81
    v_smfmac_f32_32x32x32_bf16 v[112:127], v[36:39], v[72:79], v5
    v_exp_f32 v82, v82
    v_exp_f32 v83, v83
    v_exp_f32 v84, v84
    v_mfma_f32_32x32x16_bf16 v[64:79], v[20:23], v[12:15], 0
    v_exp_f32 v85, v85
    v_exp_f32 v86, v86
    v_exp_f32 v87, v87
    v_exp_f32 v88, v88
    v_exp_f32 v89, v89
    v_smfmac_f32_32x32x32_bf16 v[96:111], v[32:35], v[80:87], v5
    v_exp_f32 v90, v90
    v_exp_f32 v91, v91
    v_exp_f32 v92, v92
    v_exp_f32 v93, v93
    v_exp_f32 v94, v94
    v_exp_f32 v95, v95
    v_exp_f32 v64, v64
    v_exp_f32 v65, v65
    v_smfmac_f32_32x32x32_bf16 v[96:111], v[36:39], v[88:95], v5
    v_exp_f32 v66, v66
    v_exp_f32 v67, v67
    v_exp_f32 v68, v68
    v_mfma_f32_32x32x16_bf16 v[80:95], v[20:23], v[8:11], 0
    v_exp_f32 v69, v69
    v_exp_f32 v70, v70
    v_exp_f32 v71, v71
    v_exp_f32 v72, v72
    v_exp_f32 v73, v73
    v_smfmac_f32_32x32x32_bf16 v[112:127], v[40:43], v[64:71], v5
    v_exp_f32 v74, v74
    v_exp_f32 v75, v75
    v_exp_f32 v76, v76
    v_exp_f32 v77, v77
    v_exp_f32 v78, v78
    v_exp_f32 v79, v79
    v_exp_f32 v80, v80
    v_exp_f32 v81, v81
    v_smfmac_f32_32x32x32_bf16 v[112:127], v[44:47], v[72:79], v5
    v_exp_f32 v82, v82
    v_exp_f32 v83, v83
    v_exp_f32 v84, v84
    s_waitcnt lgkmcnt(0)
    v_mfma_f32_32x32x16_bf16 v[64:79], v[24:27], v[12:15], 0
    ds_read_b32 v152, v150
    v_exp_f32 v85, v85
    v_exp_f32 v86, v86
    v_exp_f32 v87, v87
    v_exp_f32 v88, v88
    v_exp_f32 v89, v89
    v_smfmac_f32_32x32x32_bf16 v[96:111], v[40:43], v[80:87], v5
    v_exp_f32 v90, v90
    v_exp_f32 v91, v91
    v_exp_f32 v92, v92
    v_exp_f32 v93, v93
    v_exp_f32 v94, v94
    v_exp_f32 v95, v95
    v_exp_f32 v64, v64
    v_exp_f32 v65, v65
    v_smfmac_f32_32x32x32_bf16 v[96:111], v[44:47], v[88:95], v5
    v_exp_f32 v66, v66
    v_exp_f32 v67, v67
    v_exp_f32 v68, v68
    v_mfma_f32_32x32x16_bf16 v[80:95], v[24:27], v[8:11], 0
    s_waitcnt lgkmcnt(0)
L_rdy44:
    v_readfirstlane_b32 s36, v152
    s_nop 0
    s_cmp_ge_u32 s36, 6
    s_cbranch_scc0 L_rdy44_spin
    ds_read_b128 v[16:19], v3 offset:49152
    ds_read_b128 v[20:23], v3 offset:51200
    s_mov_b64 exec, s[34:35]
    ds_read_b128 v[32:35], v4 offset:50176
    ds_read_b128 v[36:39], v4 offset:50688
    ds_read_b128 v[40:43], v4 offset:52224
    ds_read_b128 v[44:47], v4 offset:52736
    s_mov_b64 exec, -1
    v_exp_f32 v69, v69
    v_exp_f32 v70, v70
    v_exp_f32 v71, v71
    v_exp_f32 v72, v72
    v_exp_f32 v73, v73
    v_smfmac_f32_32x32x32_bf16 v[112:127], v[48:51], v[64:71], v5
    v_exp_f32 v74, v74
    v_exp_f32 v75, v75
    v_exp_f32 v76, v76
    v_exp_f32 v77, v77
    v_exp_f32 v78, v78
    v_exp_f32 v79, v79
    v_exp_f32 v80, v80
    v_exp_f32 v81, v81
    v_smfmac_f32_32x32x32_bf16 v[112:127], v[52:55], v[72:79], v5
    v_exp_f32 v82, v82
    v_exp_f32 v83, v83
    v_exp_f32 v84, v84
    v_mfma_f32_32x32x16_bf16 v[64:79], v[28:31], v[12:15], 0
    v_exp_f32 v85, v85
    v_exp_f32 v86, v86
    v_exp_f32 v87, v87
    v_exp_f32 v88, v88
    v_exp_f32 v89, v89
    v_smfmac_f32_32x32x32_bf16 v[96:111], v[48:51], v[80:87], v5
    v_exp_f32 v90, v90
    v_exp_f32 v91, v91
    v_exp_f32 v92, v92
    v_exp_f32 v93, v93
    v_exp_f32 v94, v94
    v_exp_f32 v95, v95
    v_exp_f32 v64, v64
    v_exp_f32 v65, v65
    v_smfmac_f32_32x32x32_bf16 v[96:111], v[52:55], v[88:95], v5
    v_exp_f32 v66, v66
    v_exp_f32 v67, v67
    v_exp_f32 v68, v68
    v_mfma_f32_32x32x16_bf16 v[80:95], v[28:31], v[8:11], 0
    v_exp_f32 v69, v69
    v_exp_f32 v70, v70
    v_exp_f32 v71, v71
    v_exp_f32 v72, v72
    v_exp_f32 v73, v73
    v_smfmac_f32_32x32x32_bf16 v[112:127], v[56:59], v[64:71], v5
    v_exp_f32 v74, v74
    v_exp_f32 v75, v75
    v_exp_f32 v76, v76
    v_exp_f32 v77, v77
    v_exp_f32 v78, v78
    v_exp_f32 v79, v79
    v_exp_f32 v80, v80
    v_exp_f32 v81, v81
    v_smfmac_f32_32x32x32_bf16 v[112:127], v[60:63], v[72:79], v5
    v_exp_f32 v82, v82
    v_exp_f32 v83, v83
    v_exp_f32 v84, v84
    s_waitcnt lgkmcnt(0)
    v_mfma_f32_32x32x16_bf16 v[64:79], v[16:19], v[12:15], 0
    v_exp_f32 v85, v85
    v_exp_f32 v86, v86
    v_exp_f32 v87, v87
    v_exp_f32 v88, v88
    v_exp_f32 v89, v89
    v_smfmac_f32_32x32x32_bf16 v[96:111], v[56:59], v[80:87], v5
    v_exp_f32 v90, v90
    v_exp_f32 v91, v91
    v_exp_f32 v92, v92
    v_exp_f32 v93, v93
    v_exp_f32 v94, v94
    v_exp_f32 v95, v95
    v_exp_f32 v64, v64
    v_exp_f32 v65, v65
    v_smfmac_f32_32x32x32_bf16 v[96:111], v[60:63], v[88:95], v5
    v_exp_f32 v66, v66
    v_exp_f32 v67, v67
    v_exp_f32 v68, v68
    v_mfma_f32_32x32x16_bf16 v[80:95], v[16:19], v[8:11], 0
    ds_read_b128 v[24:27], v3 offset:53248
    ds_read_b128 v[28:31], v3 offset:55296
    s_mov_b64 exec, s[34:35]
    ds_read_b128 v[48:51], v4 offset:54272
    ds_read_b128 v[52:55], v4 offset:54784
    ds_read_b128 v[56:59], v4 offset:56320
    ds_read_b128 v[60:63], v4 offset:56832
    s_mov_b64 exec, -1
    v_exp_f32 v69, v69
    v_exp_f32 v70, v70
    v_exp_f32 v71, v71
    v_exp_f32 v72, v72
    v_exp_f32 v73, v73
    v_smfmac_f32_32x32x32_bf16 v[112:127], v[32:35], v[64:71], v5
    v_exp_f32 v74, v74
    v_exp_f32 v75, v75
    v_exp_f32 v76, v76
    v_exp_f32 v77, v77
    v_exp_f32 v78, v78
    v_exp_f32 v79, v79
    v_exp_f32 v80, v80
    v_exp_f32 v81, v81
    v_smfmac_f32_32x32x32_bf16 v[112:127], v[36:39], v[72:79], v5
    v_exp_f32 v82, v82
    v_exp_f32 v83, v83
    v_exp_f32 v84, v84
    v_mfma_f32_32x32x16_bf16 v[64:79], v[20:23], v[12:15], 0
    v_exp_f32 v85, v85
    v_exp_f32 v86, v86
    v_exp_f32 v87, v87
    v_exp_f32 v88, v88
    v_exp_f32 v89, v89
    v_smfmac_f32_32x32x32_bf16 v[96:111], v[32:35], v[80:87], v5
    v_exp_f32 v90, v90
    v_exp_f32 v91, v91
    v_exp_f32 v92, v92
    v_exp_f32 v93, v93
    v_exp_f32 v94, v94
    v_exp_f32 v95, v95
    v_exp_f32 v64, v64
    v_exp_f32 v65, v65
    v_smfmac_f32_32x32x32_bf16 v[96:111], v[36:39], v[88:95], v5
    v_exp_f32 v66, v66
    v_exp_f32 v67, v67
    v_exp_f32 v68, v68
    v_mfma_f32_32x32x16_bf16 v[80:95], v[20:23], v[8:11], 0
    v_exp_f32 v69, v69
    v_exp_f32 v70, v70
    v_exp_f32 v71, v71
    v_exp_f32 v72, v72
    v_exp_f32 v73, v73
    v_smfmac_f32_32x32x32_bf16 v[112:127], v[40:43], v[64:71], v5
    v_exp_f32 v74, v74
    v_exp_f32 v75, v75
    v_exp_f32 v76, v76
    v_exp_f32 v77, v77
    v_exp_f32 v78, v78
    v_exp_f32 v79, v79
    v_exp_f32 v80, v80
    v_exp_f32 v81, v81
    v_smfmac_f32_32x32x32_bf16 v[112:127], v[44:47], v[72:79], v5
    v_exp_f32 v82, v82
    v_exp_f32 v83, v83
    v_exp_f32 v84, v84
    s_waitcnt lgkmcnt(0)
    v_mfma_f32_32x32x16_bf16 v[64:79], v[24:27], v[12:15], 0
    ds_read_b32 v152, v150
    v_exp_f32 v85, v85
    v_exp_f32 v86, v86
    v_exp_f32 v87, v87
    v_exp_f32 v88, v88
    v_exp_f32 v89, v89
    v_smfmac_f32_32x32x32_bf16 v[96:111], v[40:43], v[80:87], v5
    v_exp_f32 v90, v90
    v_exp_f32 v91, v91
    v_exp_f32 v92, v92
    v_exp_f32 v93, v93
    v_exp_f32 v94, v94
    v_exp_f32 v95, v95
    v_exp_f32 v64, v64
    v_exp_f32 v65, v65
    v_smfmac_f32_32x32x32_bf16 v[96:111], v[44:47], v[88:95], v5
    v_exp_f32 v66, v66
    v_exp_f32 v67, v67
    v_exp_f32 v68, v68
    v_mfma_f32_32x32x16_bf16 v[80:95], v[24:27], v[8:11], 0
    s_waitcnt lgkmcnt(0)
L_rdy52:
    v_readfirstlane_b32 s36, v152
    s_nop 0
    s_cmp_ge_u32 s36, 7
    s_cbranch_scc0 L_rdy52_spin
    ds_read_b128 v[16:19], v3 offset:57344
    ds_read_b128 v[20:23], v3 offset:59392
    s_mov_b64 exec, s[34:35]
    ds_read_b128 v[32:35], v4 offset:58368
    ds_read_b128 v[36:39], v4 offset:58880
    ds_read_b128 v[40:43], v4 offset:60416
    ds_read_b128 v[44:47], v4 offset:60928
    s_mov_b64 exec, 1
    ds_add_u32 v150, v151 offset:32
    s_mov_b64 exec, -1
    v_exp_f32 v69, v69
    v_exp_f32 v70, v70
    v_exp_f32 v71, v71
    v_exp_f32 v72, v72
    v_exp_f32 v73, v73
    v_smfmac_f32_32x32x32_bf16 v[112:127], v[48:51], v[64:71], v5
    v_exp_f32 v74, v74
    v_exp_f32 v75, v75
    v_exp_f32 v76, v76
    v_exp_f32 v77, v77
    v_exp_f32 v78, v78
    v_exp_f32 v79, v79
    s_setprio 0
    v_exp_f32 v80, v80
    v_exp_f32 v81, v81
    v_smfmac_f32_32x32x32_bf16 v[112:127], v[52:55], v[72:79], v5
    v_exp_f32 v82, v82
    v_exp_f32 v83, v83
    v_exp_f32 v84, v84
    v_mfma_f32_32x32x16_bf16 v[64:79], v[28:31], v[12:15], 0
    v_exp_f32 v85, v85
    v_exp_f32 v86, v86
    v_exp_f32 v87, v87
    v_exp_f32 v88, v88
    v_exp_f32 v89, v89
    v_smfmac_f32_32x32x32_bf16 v[96:111], v[48:51], v[80:87], v5
    v_exp_f32 v90, v90
    v_exp_f32 v91, v91
    v_exp_f32 v92, v92
    v_exp_f32 v93, v93
    v_exp_f32 v94, v94
    v_exp_f32 v95, v95
    v_exp_f32 v64, v64
    v_exp_f32 v65, v65
    v_smfmac_f32_32x32x32_bf16 v[96:111], v[52:55], v[88:95], v5
    v_exp_f32 v66, v66
    v_exp_f32 v67, v67
    v_exp_f32 v68, v68
    v_mfma_f32_32x32x16_bf16 v[80:95], v[28:31], v[8:11], 0
    v_exp_f32 v69, v69
    v_exp_f32 v70, v70
    v_exp_f32 v71, v71
    v_exp_f32 v72, v72
    v_exp_f32 v73, v73
    v_smfmac_f32_32x32x32_bf16 v[112:127], v[56:59], v[64:71], v5
    v_exp_f32 v74, v74
    v_exp_f32 v75, v75
    v_exp_f32 v76, v76
    v_exp_f32 v77, v77
    v_exp_f32 v78, v78
    v_exp_f32 v79, v79
    v_exp_f32 v80, v80
    v_exp_f32 v81, v81
    v_smfmac_f32_32x32x32_bf16 v[112:127], v[60:63], v[72:79], v5
    v_exp_f32 v82, v82
    v_exp_f32 v83, v83
    v_exp_f32 v84, v84
    s_waitcnt lgkmcnt(1)
    v_mfma_f32_32x32x16_bf16 v[64:79], v[16:19], v[12:15], 0
    v_exp_f32 v85, v85
    v_exp_f32 v86, v86
    v_exp_f32 v87, v87
    v_exp_f32 v88, v88
    v_exp_f32 v89, v89
    v_smfmac_f32_32x32x32_bf16 v[96:111], v[56:59], v[80:87], v5
    v_exp_f32 v90, v90
    v_exp_f32 v91, v91
    v_exp_f32 v92, v92
    v_exp_f32 v93, v93
    v_exp_f32 v94, v94
    v_exp_f32 v95, v95
    v_exp_f32 v64, v64
    v_exp_f32 v65, v65
    v_smfmac_f32_32x32x32_bf16 v[96:111], v[60:63], v[88:95], v5
    v_exp_f32 v66, v66
    v_exp_f32 v67, v67
    v_exp_f32 v68, v68
    v_mfma_f32_32x32x16_bf16 v[80:95], v[16:19], v[8:11], 0
    ds_read_b128 v[24:27], v3 offset:61440
    ds_read_b128 v[28:31], v3 offset:63488
    s_mov_b64 exec, s[34:35]
    ds_read_b128 v[48:51], v4 offset:62464
    ds_read_b128 v[52:55], v4 offset:62976
    ds_read_b128 v[56:59], v4 offset:64512
    ds_read_b128 v[60:63], v4 offset:65024
    s_mov_b64 exec, -1
    v_exp_f32 v69, v69
    v_exp_f32 v70, v70
    v_exp_f32 v71, v71
    v_exp_f32 v72, v72
    v_exp_f32 v73, v73
    v_smfmac_f32_32x32x32_bf16 v[112:127], v[32:35], v[64:71], v5
    v_exp_f32 v74, v74
    v_exp_f32 v75, v75
    v_exp_f32 v76, v76
    v_exp_f32 v77, v77
    v_exp_f32 v78, v78
    v_exp_f32 v79, v79
    v_exp_f32 v80, v80
    v_exp_f32 v81, v81
    v_smfmac_f32_32x32x32_bf16 v[112:127], v[36:39], v[72:79], v5
    v_exp_f32 v82, v82
    v_exp_f32 v83, v83
    v_exp_f32 v84, v84
    v_mfma_f32_32x32x16_bf16 v[64:79], v[20:23], v[12:15], 0
    v_exp_f32 v85, v85
    v_exp_f32 v86, v86
    v_exp_f32 v87, v87
    v_exp_f32 v88, v88
    v_exp_f32 v89, v89
    v_smfmac_f32_32x32x32_bf16 v[96:111], v[32:35], v[80:87], v5
    v_exp_f32 v90, v90
    v_exp_f32 v91, v91
    v_exp_f32 v92, v92
    v_exp_f32 v93, v93
    v_exp_f32 v94, v94
    v_exp_f32 v95, v95
    v_exp_f32 v64, v64
    v_exp_f32 v65, v65
    v_smfmac_f32_32x32x32_bf16 v[96:111], v[36:39], v[88:95], v5
    v_exp_f32 v66, v66
    v_exp_f32 v67, v67
    v_exp_f32 v68, v68
    v_mfma_f32_32x32x16_bf16 v[80:95], v[20:23], v[8:11], 0
    v_exp_f32 v69, v69
    v_exp_f32 v70, v70
    v_exp_f32 v71, v71
    v_exp_f32 v72, v72
    v_exp_f32 v73, v73
    v_smfmac_f32_32x32x32_bf16 v[112:127], v[40:43], v[64:71], v5
    v_exp_f32 v74, v74
    v_exp_f32 v75, v75
    v_exp_f32 v76, v76
    v_exp_f32 v77, v77
    v_exp_f32 v78, v78
    v_exp_f32 v79, v79
    v_exp_f32 v80, v80
    v_exp_f32 v81, v81
    v_smfmac_f32_32x32x32_bf16 v[112:127], v[44:47], v[72:79], v5
    v_exp_f32 v82, v82
    v_exp_f32 v83, v83
    v_exp_f32 v84, v84
    s_waitcnt lgkmcnt(0)
    v_mfma_f32_32x32x16_bf16 v[64:79], v[24:27], v[12:15], 0
    v_exp_f32 v85, v85
    v_exp_f32 v86, v86
    v_exp_f32 v87, v87
    v_exp_f32 v88, v88
    v_exp_f32 v89, v89
    v_smfmac_f32_32x32x32_bf16 v[96:111], v[40:43], v[80:87], v5
    v_exp_f32 v90, v90
    v_exp_f32 v91, v91
    v_exp_f32 v92, v92
    v_exp_f32 v93, v93
    v_exp_f32 v94, v94
    v_exp_f32 v95, v95
    v_exp_f32 v64, v64
    v_exp_f32 v65, v65
    v_smfmac_f32_32x32x32_bf16 v[96:111], v[44:47], v[88:95], v5
    v_exp_f32 v66, v66
    v_exp_f32 v67, v67
    v_exp_f32 v68, v68
    v_mfma_f32_32x32x16_bf16 v[80:95], v[24:27], v[8:11], 0
    v_exp_f32 v69, v69
    v_exp_f32 v70, v70
    v_exp_f32 v71, v71
    v_exp_f32 v72, v72
    v_exp_f32 v73, v73
    v_smfmac_f32_32x32x32_bf16 v[112:127], v[48:51], v[64:71], v5
    v_exp_f32 v74, v74
    v_exp_f32 v75, v75
    v_exp_f32 v76, v76
    v_exp_f32 v77, v77
    v_exp_f32 v78, v78
    v_exp_f32 v79, v79
    v_exp_f32 v80, v80
    v_exp_f32 v81, v81
    v_smfmac_f32_32x32x32_bf16 v[112:127], v[52:55], v[72:79], v5
    v_exp_f32 v82, v82
    v_exp_f32 v83, v83
    v_exp_f32 v84, v84
    v_mfma_f32_32x32x16_bf16 v[64:79], v[28:31], v[12:15], 0
    v_exp_f32 v85, v85
    v_exp_f32 v86, v86
    v_exp_f32 v87, v87
    v_exp_f32 v88, v88
    v_exp_f32 v89, v89
    v_smfmac_f32_32x32x32_bf16 v[96:111], v[48:51], v[80:87], v5
    v_exp_f32 v90, v90
    v_exp_f32 v91, v91
    v_exp_f32 v92, v92
    v_exp_f32 v93, v93
    v_exp_f32 v94, v94
    v_exp_f32 v95, v95
    v_exp_f32 v64, v64
    v_exp_f32 v65, v65
    v_smfmac_f32_32x32x32_bf16 v[96:111], v[52:55], v[88:95], v5
    v_exp_f32 v66, v66
    v_exp_f32 v67, v67
    v_exp_f32 v68, v68
    v_mfma_f32_32x32x16_bf16 v[80:95], v[28:31], v[8:11], 0
    v_exp_f32 v69, v69
    v_exp_f32 v70, v70
    v_exp_f32 v71, v71
    v_exp_f32 v72, v72
    v_exp_f32 v73, v73
    v_smfmac_f32_32x32x32_bf16 v[112:127], v[56:59], v[64:71], v5
    v_exp_f32 v74, v74
    v_exp_f32 v75, v75
    v_exp_f32 v76, v76
    v_exp_f32 v77, v77
    v_exp_f32 v78, v78
    v_exp_f32 v79, v79
    v_exp_f32 v80, v80
    v_exp_f32 v81, v81
    v_smfmac_f32_32x32x32_bf16 v[112:127], v[60:63], v[72:79], v5
    v_exp_f32 v82, v82
    v_exp_f32 v83, v83
    v_exp_f32 v84, v84
    v_exp_f32 v85, v85
    v_exp_f32 v86, v86
    v_exp_f32 v87, v87
    v_exp_f32 v88, v88
    v_exp_f32 v89, v89
    v_smfmac_f32_32x32x32_bf16 v[96:111], v[56:59], v[80:87], v5
    v_exp_f32 v90, v90
    v_exp_f32 v91, v91
    v_exp_f32 v92, v92
    v_exp_f32 v93, v93
    ds_write_b128 v6, v[112:115]
    ds_write_b128 v6, v[116:119] offset:1024
    ds_write_b32 v6, v120 offset:2048
    v_exp_f32 v94, v94
    v_exp_f32 v95, v95
L_p2_tail:
    s_nop 1
    v_smfmac_f32_32x32x32_bf16 v[96:111], v[60:63], v[88:95], v5
    s_mov_b32 s30, 0x67800000
    s_mov_b32 s31, 0x17800000
    s_mov_b32 s56, 0
    s_waitcnt lgkmcnt(0)
    s_barrier
    ds_read_b32 v152, v7 offset:2048
    ds_read_b128 v[144:147], v7
    ds_read_b128 v[148:151], v7 offset:1024
    s_nop 2
    s_waitcnt lgkmcnt(2)
    v_add_f32 v104, v104, v152
    s_waitcnt lgkmcnt(0)
    v_pk_add_f32 v[96:97], v[96:97], v[144:145]
    v_pk_add_f32 v[98:99], v[98:99], v[146:147]
    v_pk_add_f32 v[100:101], v[100:101], v[148:149]
    v_pk_add_f32 v[102:103], v[102:103], v[150:151]
L_p2_finish:
    v_rcp_f32 v152, v104
    v_cmp_gt_f32 s[40:41], s30, v104
    v_cmp_lt_f32 s[42:43], s31, v104
    v_pk_mul_f32 v[96:97], v[96:97], v[152:153] op_sel_hi:[1,0]
    v_pk_mul_f32 v[98:99], v[98:99], v[152:153] op_sel_hi:[1,0]
    v_pk_mul_f32 v[100:101], v[100:101], v[152:153] op_sel_hi:[1,0]
    v_pk_mul_f32 v[102:103], v[102:103], v[152:153] op_sel_hi:[1,0]
    v_cvt_pk_bf16_f32 v148, v96, v97
    v_cvt_pk_bf16_f32 v149, v98, v99
    v_cvt_pk_bf16_f32 v150, v100, v101
    v_cvt_pk_bf16_f32 v151, v102, v103
    v_dot2_f32_bf16 v144, v148, v148, 0
    v_dot2_f32_bf16 v144, v149, v149, v144
    v_dot2_f32_bf16 v144, v150, v150, v144
    v_dot2_f32_bf16 v144, v151, v151, v144
    s_and_b64 s[40:41], s[40:41], s[42:43]
    s_cmp_lg_u32 s56, 0
    s_cbranch_scc1 L_p2_store
    v_cmp_gt_f32 vcc, s30, v144
    s_nop 0
    s_and_b64 s[40:41], s[40:41], vcc
    s_cmp_eq_u64 s[40:41], -1
    s_cbranch_scc0 L_p2_fallback
L_p2_store:
    s_cmp_eq_u32 s54, 0
    s_cbranch_scc1 L_st_5_s
    buffer_store_dwordx4 v[148:151], v2, s[12:15], s57 offen
    s_branch L_st_5_j
L_st_5_s:
    buffer_store_dwordx4 v[148:151], v2, s[12:15], s57 offen sc1
L_st_5_j:
    s_barrier
    s_cmp_ge_u32 s24, 4
    s_cbranch_scc0 L_compute
    s_and_b32 s30, s2, 7
    s_lshl_b32 s27, s30, 2
    s_lshr_b32 s34, s2, 6
    s_add_u32 s27, s27, s34
    s_bfe_u32 s28, s2, 0x30003
    s_and_b32 s25, s24, 1
    s_bfe_u32 s26, s24, 0x10001
    v_lshrrev_b32 v12, 3, v1
    v_and_b32 v13, 7, v1
    v_lshrrev_b32 v14, 2, v1
    v_and_b32 v14, 4, v14
    v_xor_b32 v14, v14, v13
    v_lshlrev_b32 v14, 4, v14
    v_lshl_add_u32 v14, v12, 10, v14
    s_mul_i32 s44, s29, 49152
    s_lshl_b32 s30, s28, 7
    v_add_u32 v3, s30, v14
    v_add_u32 v4, 7168, v3
    s_lshl_b32 s32, s29, 11
    s_lshl_b32 s33, s27, 1
    s_add_u32 s33, s33, s25
    s_mul_i32 s34, s33, 126976
    s_lshl_b32 s31, s26, 11
    s_add_u32 s34, s34, s31
    s_add_u32 s34, s34, 65536
    s_lshl_b32 s35, s25, 12
    s_add_u32 s35, s35, s31
    s_mov_b32 s16, s68
    s_mov_b32 s17, s69
    s_mov_b32 s18, 0x00080000
    s_mov_b32 s19, 0x00020000
    v_mov_b32 v16, 0
    v_mov_b32 v17, s53
    s_mov_b64 exec, 1
    s_waitcnt vmcnt(0)
    s_cmp_eq_u32 s54, 0
    s_cbranch_scc1 L_st_6_s
    buffer_store_dword v17, v16, s[12:15], s55 offen
    s_branch L_st_6_j
L_st_6_s:
    buffer_store_dword v17, v16, s[12:15], s55 offen sc1
L_st_6_j:
    s_mov_b64 exec, -1
    s_barrier
    s_add_u32 m0, s35, 122880
    s_add_u32 s43, s34, 0
    buffer_load_dwordx4 v2, s[12:15], s43 offen sc1 lds
    buffer_load_dwordx4 v2, s[12:15], s43 offen offset:1024 sc1 lds
    s_add_u32 m0, s35, 131072
    s_add_u32 s43, s34, 4096
    buffer_load_dwordx4 v2, s[12:15], s43 offen sc1 lds
    buffer_load_dwordx4 v2, s[12:15], s43 offen offset:1024 sc1 lds
    s_add_u32 m0, s35, 139264
    s_add_u32 s43, s34, 8192
    buffer_load_dwordx4 v2, s[12:15], s43 offen sc1 lds
    buffer_load_dwordx4 v2, s[12:15], s43 offen offset:1024 sc1 lds
    s_add_u32 m0, s35, 147456
    s_add_u32 s43, s34, 12288
    buffer_load_dwordx4 v2, s[12:15], s43 offen sc1 lds
    buffer_load_dwordx4 v2, s[12:15], s43 offen offset:1024 sc1 lds
    s_add_u32 m0, s35, 57344
    s_add_u32 s43, s34, 16384
    buffer_load_dwordx4 v2, s[12:15], s43 offen sc1 lds
    buffer_load_dwordx4 v2, s[12:15], s43 offen offset:1024 sc1 lds
    s_waitcnt vmcnt(8)
    s_barrier
    s_waitcnt vmcnt(6)
    s_barrier
    s_waitcnt vmcnt(4)
    s_barrier
    s_add_u32 m0, s35, 122880
    s_add_u32 s43, s34, 20480
    buffer_load_dwordx4 v2, s[12:15], s43 offen sc1 lds
    buffer_load_dwordx4 v2, s[12:15], s43 offen offset:1024 sc1 lds
    s_add_u32 m0, s35, 0
    s_add_u32 s43, s34, 24576
    buffer_load_dwordx4 v2, s[12:15], s43 offen sc1 lds
    buffer_load_dwordx4 v2, s[12:15], s43 offen offset:1024 sc1 lds
    s_waitcnt vmcnt(6)
    s_barrier
    s_add_u32 m0, s35, 131072
    s_add_u32 s43, s34, 28672
    buffer_load_dwordx4 v2, s[12:15], s43 offen sc1 lds
    buffer_load_dwordx4 v2, s[12:15], s43 offen offset:1024 sc1 lds
    s_waitcnt vmcnt(6)
    s_barrier
    s_waitcnt vmcnt(4)
    s_barrier
    s_waitcnt vmcnt(2)
    s_barrier
    s_waitcnt vmcnt(0)
    s_barrier
    s_barrier
    s_and_b32 s30, s2, 7
    s_lshl_b32 s30, s30, 1
    s_bfe_u32 s31, s2, 0x10003
    s_add_u32 s25, s30, s31
    s_lshr_b32 s26, s2, 4
    s_cmp_ge_u32 s2, 240
    s_cbranch_scc1 L_p4_skip_l
    s_lshl_b32 s33, s25, 2
    s_add_u32 s33, s33, s29
    s_mul_i32 s33, s33, 126976
    s_add_u32 s38, s33, 120832
    s_lshr_b32 s34, s29, 1
    s_and_b32 s35, s29, 1
    s_mul_i32 s30, s34, 44032
    s_mul_i32 s31, s26, 192
    s_add_u32 s30, s30, s31
    v_and_b32 v19, 2, v1
    v_lshlrev_b32 v19, 5, v19
    v_sub_u32 v19, 32, v19
    v_mul_lo_u32 v19, v19, s35
    v_add_u32 v19, s30, v19
    v_add_u32 v16, 0, v1
    v_mul_u32_u24 v17, 171, v16
    v_lshrrev_b32 v17, 11, v17
    v_mul_u32_u24 v18, 2560, v17
    v_add3_u32 v3, v2, v18, v19
    v_add_u32 v16, 64, v1
    v_mul_u32_u24 v17, 171, v16
    v_lshrrev_b32 v17, 11, v17
    v_mul_u32_u24 v18, 2560, v17
    v_add3_u32 v4, v2, v18, v19
    v_add_u32 v16, 128, v1
    v_mul_u32_u24 v17, 171, v16
    v_lshrrev_b32 v17, 11, v17
    v_mul_u32_u24 v18, 2560, v17
    v_add3_u32 v5, v2, v18, v19
    s_mul_i32 s32, s29, 3072
    s_lshl_b32 s36, s29, 11
    s_add_u32 s36, s36, 122880
    s_cmp_eq_u32 s35, 0
    s_cselect_b32 s16, s72, s74
    s_cselect_b32 s17, s73, s75
    s_mov_b32 s18, 0x00158000
    s_mov_b32 s19, 0x00020000
    s_add_u32 m0, s32, 0
    s_mov_b32 s42, 352256
    buffer_load_dwordx4 v3, s[16:19], s42 offen offset:0 lds
    buffer_load_dwordx4 v4, s[16:19], s42 offen offset:1024 lds
    buffer_load_dwordx4 v5, s[16:19], s42 offen offset:2048 lds
    s_mov_b32 s44, s76
    s_mov_b32 s45, s77
    s_mov_b32 s46, 0x00158000
    s_mov_b32 s47, 0x00020000
    s_lshr_b32 s30, s2, 3
    s_lshl_b32 s30, s30, 2
    s_add_u32 s30, s30, s29
    s_lshl_b32 s30, s30, 13
    v_lshlrev_b32 v13, 7, v1
    v_add_u32 v13, s30, v13
    v_add_u32 v15, 983040, v13
    v_lshrrev_b32 v19, 5, v1
    v_and_b32 v20, 31, v1
    v_lshlrev_b32 v20, 3, v20
    v_lshl_add_u32 v20, v19, 11, v20
    s_mul_i32 s30, s29, 1536
    s_add_u32 s30, s30, 26112
    v_add_u32 v21, s30, v2
    v_lshl_add_u32 v22, v1, 3, s30
    s_barrier
    s_add_u32 m0, s36, 0
    s_add_u32 s43, s33, 0
    buffer_load_dwordx4 v2, s[12:15], s43 offen offset:0 sc1 lds
    buffer_load_dwordx4 v2, s[12:15], s43 offen offset:1024 sc1 lds
    s_add_u32 m0, s36, 8192
    s_add_u32 s43, s33, 2048
    buffer_load_dwordx4 v2, s[12:15], s43 offen offset:0 sc1 lds
    buffer_load_dwordx4 v2, s[12:15], s43 offen offset:1024 sc1 lds
    s_add_u32 m0, s36, 16384
    s_add_u32 s43, s33, 4096
    buffer_load_dwordx4 v2, s[12:15], s43 offen offset:0 sc1 lds
    buffer_load_dwordx4 v2, s[12:15], s43 offen offset:1024 sc1 lds
    s_add_u32 m0, s36, 24576
    s_add_u32 s43, s33, 6144
    buffer_load_dwordx4 v2, s[12:15], s43 offen offset:0 sc1 lds
    buffer_load_dwordx4 v2, s[12:15], s43 offen offset:1024 sc1 lds
    s_add_u32 m0, s32, 12288
    s_mov_b32 s42, 440320
    buffer_load_dwordx4 v3, s[16:19], s42 offen offset:0 lds
    s_add_u32 m0, s32, 12288
    s_mov_b32 s42, 440320
    buffer_load_dwordx4 v4, s[16:19], s42 offen offset:1024 lds
    s_waitcnt vmcnt(8)
    s_barrier
    s_add_u32 m0, s36, 32768
    s_add_u32 s43, s33, 8192
    buffer_load_dwordx4 v2, s[12:15], s43 offen offset:0 sc1 lds
    buffer_load_dwordx4 v2, s[12:15], s43 offen offset:1024 sc1 lds
    s_add_u32 m0, s32, 12288
    s_mov_b32 s42, 440320
    buffer_load_dwordx4 v5, s[16:19], s42 offen offset:2048 lds
    s_add_u32 m0, s32, 57344
    s_mov_b32 s42, 528384
    buffer_load_dwordx4 v3, s[16:19], s42 offen offset:0 lds
    s_add_u32 m0, s32, 57344
    s_mov_b32 s42, 528384
    buffer_load_dwordx4 v4, s[16:19], s42 offen offset:1024 lds
    buffer_load_dwordx2 v[32:33], v20, s[12:15], s38 offen offset:0 sc1
    s_waitcnt vmcnt(12)
    s_barrier
    s_add_u32 m0, s36, 0
    s_add_u32 s43, s33, 10240
    buffer_load_dwordx4 v2, s[12:15], s43 offen offset:0 sc1 lds
    buffer_load_dwordx4 v2, s[12:15], s43 offen offset:1024 sc1 lds
    s_add_u32 m0, s32, 57344
    s_mov_b32 s42, 528384
    buffer_load_dwordx4 v5, s[16:19], s42 offen offset:2048 lds
    s_add_u32 m0, s32, 69632
    s_mov_b32 s42, 616448
    buffer_load_dwordx4 v3, s[16:19], s42 offen offset:0 lds
    buffer_load_dwordx2 v[34:35], v20, s[12:15], s38 offen offset:256 sc1
    s_waitcnt vmcnt(15)
    s_barrier
    s_add_u32 m0, s36, 8192
    s_add_u32 s43, s33, 12288
    buffer_load_dwordx4 v2, s[12:15], s43 offen offset:0 sc1 lds
    buffer_load_dwordx4 v2, s[12:15], s43 offen offset:1024 sc1 lds
    s_add_u32 m0, s32, 69632
    s_mov_b32 s42, 616448
    buffer_load_dwordx4 v4, s[16:19], s42 offen offset:1024 lds
    s_add_u32 m0, s32, 69632
    s_mov_b32 s42, 616448
    buffer_load_dwordx4 v5, s[16:19], s42 offen offset:2048 lds
    s_add_u32 m0, s32, 81920
    s_mov_b32 s42, 704512
    buffer_load_dwordx4 v3, s[16:19], s42 offen offset:0 lds
    buffer_load_dwordx2 v[36:37], v20, s[12:15], s38 offen offset:512 sc1
    s_waitcnt vmcnt(19)
    s_barrier
    s_add_u32 m0, s36, 16384
    s_add_u32 s43, s33, 14336
    buffer_load_dwordx4 v2, s[12:15], s43 offen offset:0 sc1 lds
    buffer_load_dwordx4 v2, s[12:15], s43 offen offset:1024 sc1 lds
    s_add_u32 m0, s32, 81920
    s_mov_b32 s42, 704512
    buffer_load_dwordx4 v4, s[16:19], s42 offen offset:1024 lds
    s_add_u32 m0, s32, 81920
    s_mov_b32 s42, 704512
    buffer_load_dwordx4 v5, s[16:19], s42 offen offset:2048 lds
    buffer_load_dwordx2 v[38:39], v20, s[12:15], s38 offen offset:768 sc1
    s_waitcnt vmcnt(20)
    s_barrier
    s_add_u32 m0, s36, 24576
    s_add_u32 s43, s33, 16384
    buffer_load_dwordx4 v2, s[12:15], s43 offen offset:0 sc1 lds
    buffer_load_dwordx4 v2, s[12:15], s43 offen offset:1024 sc1 lds
    s_add_u32 m0, s32, 32768
    s_mov_b32 s42, 792576
    buffer_load_dwordx4 v3, s[16:19], s42 offen offset:0 lds
    s_add_u32 m0, s32, 32768
    s_mov_b32 s42, 792576
    buffer_load_dwordx4 v4, s[16:19], s42 offen offset:1024 lds
    s_add_u32 m0, s32, 32768
    s_mov_b32 s42, 792576
    buffer_load_dwordx4 v5, s[16:19], s42 offen offset:2048 lds
    buffer_load_dwordx2 v[40:41], v20, s[12:15], s38 offen offset:1024 sc1
    s_waitcnt vmcnt(20)
    s_barrier
    s_add_u32 m0, s36, 32768
    s_add_u32 s43, s33, 18432
    buffer_load_dwordx4 v2, s[12:15], s43 offen offset:0 sc1 lds
    buffer_load_dwordx4 v2, s[12:15], s43 offen offset:1024 sc1 lds
    s_add_u32 m0, s32, 45056
    s_mov_b32 s42, 880640
    buffer_load_dwordx4 v3, s[16:19], s42 offen offset:0 lds
    s_add_u32 m0, s32, 45056
    s_mov_b32 s42, 880640
    buffer_load_dwordx4 v4, s[16:19], s42 offen offset:1024 lds
    buffer_load_dwordx2 v[42:43], v20, s[12:15], s38 offen offset:1280 sc1
    s_waitcnt vmcnt(20)
    s_barrier
    s_add_u32 m0, s36, 0
    s_add_u32 s43, s33, 20480
    buffer_load_dwordx4 v2, s[12:15], s43 offen offset:0 sc1 lds
    buffer_load_dwordx4 v2, s[12:15], s43 offen offset:1024 sc1 lds
    s_add_u32 m0, s32, 45056
    s_mov_b32 s42, 880640
    buffer_load_dwordx4 v5, s[16:19], s42 offen offset:2048 lds
    s_add_u32 m0, s32, 98304
    s_mov_b32 s42, 968704
    buffer_load_dwordx4 v3, s[16:19], s42 offen offset:0 lds
    s_add_u32 m0, s32, 98304
    s_mov_b32 s42, 968704
    buffer_load_dwordx4 v4, s[16:19], s42 offen offset:1024 lds
    buffer_load_dwordx2 v[44:45], v20, s[12:15], s38 offen offset:1536 sc1
    s_waitcnt vmcnt(20)
    s_barrier
    s_add_u32 m0, s36, 8192
    s_add_u32 s43, s33, 22528
    buffer_load_dwordx4 v2, s[12:15], s43 offen offset:0 sc1 lds
    buffer_load_dwordx4 v2, s[12:15], s43 offen offset:1024 sc1 lds
    s_add_u32 m0, s32, 98304
    s_mov_b32 s42, 968704
    buffer_load_dwordx4 v5, s[16:19], s42 offen offset:2048 lds
    s_add_u32 m0, s32, 110592
    s_mov_b32 s42, 1056768
    buffer_load_dwordx4 v3, s[16:19], s42 offen offset:0 lds
    buffer_load_dwordx2 v[46:47], v20, s[12:15], s38 offen offset:1792 sc1
    s_waitcnt vmcnt(20)
    s_barrier
    s_add_u32 m0, s36, 16384
    s_add_u32 s43, s33, 24576
    buffer_load_dwordx4 v2, s[12:15], s43 offen offset:0 sc1 lds
    buffer_load_dwordx4 v2, s[12:15], s43 offen offset:1024 sc1 lds
    s_add_u32 m0, s32, 110592
    s_mov_b32 s42, 1056768
    buffer_load_dwordx4 v4, s[16:19], s42 offen offset:1024 lds
    s_add_u32 m0, s32, 110592
    s_mov_b32 s42, 1056768
    buffer_load_dwordx4 v5, s[16:19], s42 offen offset:2048 lds
    s_add_u32 m0, s32, 0
    s_mov_b32 s42, 1144832
    buffer_load_dwordx4 v3, s[16:19], s42 offen offset:0 lds
    s_waitcnt vmcnt(19)
    s_barrier
    s_add_u32 m0, s36, 24576
    s_add_u32 s43, s33, 26624
    buffer_load_dwordx4 v2, s[12:15], s43 offen offset:0 sc1 lds
    buffer_load_dwordx4 v2, s[12:15], s43 offen offset:1024 sc1 lds
    s_add_u32 m0, s32, 0
    s_mov_b32 s42, 1144832
    buffer_load_dwordx4 v4, s[16:19], s42 offen offset:1024 lds
    s_add_u32 m0, s32, 0
    s_mov_b32 s42, 1144832
    buffer_load_dwordx4 v5, s[16:19], s42 offen offset:2048 lds
    s_waitcnt vmcnt(17)
    s_barrier
    s_add_u32 m0, s36, 32768
    s_add_u32 s43, s33, 28672
    buffer_load_dwordx4 v2, s[12:15], s43 offen offset:0 sc1 lds
    buffer_load_dwordx4 v2, s[12:15], s43 offen offset:1024 sc1 lds
    s_add_u32 m0, s32, 12288
    s_mov_b32 s42, 1232896
    buffer_load_dwordx4 v3, s[16:19], s42 offen offset:0 lds
    s_add_u32 m0, s32, 12288
    s_mov_b32 s42, 1232896
    buffer_load_dwordx4 v4, s[16:19], s42 offen offset:1024 lds
    s_add_u32 m0, s32, 12288
    s_mov_b32 s42, 1232896
    buffer_load_dwordx4 v5, s[16:19], s42 offen offset:2048 lds
    s_waitcnt vmcnt(16)
    s_waitcnt vmcnt(14)
    v_add_f32 v60, v32, v34
    v_add_f32 v61, v33, v35
    v_add_f32 v60, v60, v36
    v_add_f32 v61, v61, v37
    v_add_f32 v60, v60, v38
    v_add_f32 v61, v61, v39
    v_add_f32 v60, v60, v40
    v_add_f32 v61, v61, v41
    v_add_f32 v60, v60, v42
    v_add_f32 v61, v61, v43
    v_add_f32 v60, v60, v44
    v_add_f32 v61, v61, v45
    v_add_f32 v60, v60, v46
    v_add_f32 v61, v61, v47
    s_barrier
    s_add_u32 m0, s36, 0
    s_add_u32 s43, s33, 30720
    buffer_load_dwordx4 v2, s[12:15], s43 offen offset:0 sc1 lds
    buffer_load_dwordx4 v2, s[12:15], s43 offen offset:1024 sc1 lds
    s_add_u32 m0, s32, 57344
    s_mov_b32 s42, 1320960
    buffer_load_dwordx4 v3, s[16:19], s42 offen offset:0 lds
    s_add_u32 m0, s32, 57344
    s_mov_b32 s42, 1320960
    buffer_load_dwordx4 v4, s[16:19], s42 offen offset:1024 lds
    s_waitcnt vmcnt(14)
    v_mov_b32 v16, v60
    s_nop 1
    v_permlane32_swap_b32 v60, v16
    s_nop 1
    v_add_f32 v60, v60, v16
    v_mov_b32 v16, v61
    s_nop 1
    v_permlane32_swap_b32 v61, v16
    s_nop 1
    v_add_f32 v61, v61, v16
    v_mul_f32 v62, 0xbb000000, v60
    v_mul_f32 v61, 0x3b000000, v61
    v_fma_f32 v61, -v62, v62, v61
    v_max_f32 v61, 0, v61
    v_add_f32 v61, 0x3727c5ac, v61
    s_barrier
    s_add_u32 m0, s32, 57344
    s_mov_b32 s42, 1320960
    buffer_load_dwordx4 v5, s[16:19], s42 offen offset:2048 lds
    s_waitcnt vmcnt(10)
    v_rsq_f32 v64, v61
    v_cvt_pk_bf16_f32 v68, v62, v62
    v_lshlrev_b32 v17, 16, v68
    v_sub_f32 v16, v62, v17
    v_mul_f32 v65, v61, v64
    v_mul_f32 v64, 0xbfb8aa3b, v64
    v_cvt_pk_bf16_f32 v69, v16, 0
    v_mov_b32 v70, 0
    v_mov_b32 v71, 0
    ds_write_b128 v21, v[68:71]
    ds_write_b64 v22, v[64:65] offset:1024
    s_barrier
    buffer_load_dword v100, v13, s[44:47], 0 offen
    s_waitcnt vmcnt(6)
    s_waitcnt lgkmcnt(0)
    s_barrier
    buffer_load_dword v100, v15, s[44:47], 0 offen
    s_waitcnt vmcnt(2)
    s_barrier
    s_barrier
L_p4_skip_l:
    s_and_b32 s30, s2, 7
    s_lshl_b32 s27, s30, 2
    s_lshr_b32 s34, s2, 6
    s_add_u32 s27, s27, s34
    s_bfe_u32 s28, s2, 0x30003
    s_and_b32 s25, s24, 1
    s_bfe_u32 s26, s24, 0x10001
    v_lshrrev_b32 v12, 3, v1
    v_and_b32 v13, 7, v1
    v_lshrrev_b32 v14, 2, v1
    v_and_b32 v14, 4, v14
    v_xor_b32 v14, v14, v13
    v_lshlrev_b32 v14, 4, v14
    v_lshl_add_u32 v14, v12, 10, v14
    s_mul_i32 s44, s29, 49152
    s_lshl_b32 s30, s28, 7
    v_add_u32 v3, s30, v14
    v_add_u32 v4, 7168, v3
    s_lshl_b32 s32, s29, 11
    s_lshl_b32 s33, s27, 1
    s_add_u32 s33, s33, s25
    s_mul_i32 s34, s33, 126976
    s_lshl_b32 s31, s26, 11
    s_add_u32 s34, s34, s31
    s_add_u32 s34, s34, 32768
    s_lshl_b32 s35, s25, 12
    s_add_u32 s35, s35, s31
    s_mul_i32 s36, s33, 126976
    s_lshl_b32 s30, s28, 12
    s_add_u32 s36, s36, s30
    s_add_u32 s36, s36, s31
    s_mov_b32 s16, s76
    s_mov_b32 s17, s77
    s_mov_b32 s18, 0x00158000
    s_mov_b32 s19, 0x00020000
    s_add_u32 m0, s32, 0
    s_add_u32 s42, s44, 0x00000000
    buffer_load_dwordx4 v3, s[16:19], s42 offen lds
    buffer_load_dwordx4 v4, s[16:19], s42 offen offset:1024 lds
    s_add_u32 m0, s32, 8192
    s_add_u32 s42, s44, 0x00030000
    buffer_load_dwordx4 v3, s[16:19], s42 offen lds
    buffer_load_dwordx4 v4, s[16:19], s42 offen offset:1024 lds
    s_add_u32 m0, s32, 16384
    s_add_u32 s42, s44, 0x00060000
    buffer_load_dwordx4 v3, s[16:19], s42 offen lds
    buffer_load_dwordx4 v4, s[16:19], s42 offen offset:1024 lds
    s_add_u32 m0, s32, 32768
    s_add_u32 s42, s44, 0x00090000
    buffer_load_dwordx4 v3, s[16:19], s42 offen lds
    buffer_load_dwordx4 v4, s[16:19], s42 offen offset:1024 lds
    s_add_u32 m0, s32, 40960
    s_add_u32 s42, s44, 0x000c0000
    buffer_load_dwordx4 v3, s[16:19], s42 offen lds
    buffer_load_dwordx4 v4, s[16:19], s42 offen offset:1024 lds
    s_add_u32 m0, s32, 49152
    s_add_u32 s42, s44, 0x000f0000
    buffer_load_dwordx4 v3, s[16:19], s42 offen lds
    buffer_load_dwordx4 v4, s[16:19], s42 offen offset:1024 lds
    s_add_u32 m0, s32, 57344
    s_add_u32 s42, s44, 0x00120000
    buffer_load_dwordx4 v3, s[16:19], s42 offen lds
    buffer_load_dwordx4 v4, s[16:19], s42 offen offset:1024 lds
    s_add_u32 m0, s32, 65536
    s_add_u32 s42, s44, 0x00150000
    s_add_u32 s45, s44, 0xffff8000
    s_cmp_ge_u32 s29, 1
    s_cselect_b32 s42, s45, s42
    buffer_load_dwordx4 v3, s[16:19], s42 offen lds
    buffer_load_dwordx4 v4, s[16:19], s42 offen offset:1024 lds
    s_add_u32 m0, s32, 73728
    s_add_u32 s42, s44, 0x00028000
    buffer_load_dwordx4 v3, s[16:19], s42 offen lds
    buffer_load_dwordx4 v4, s[16:19], s42 offen offset:1024 lds
    s_add_u32 m0, s32, 81920
    s_add_u32 s42, s44, 0x00058000
    buffer_load_dwordx4 v3, s[16:19], s42 offen lds
    buffer_load_dwordx4 v4, s[16:19], s42 offen offset:1024 lds
    s_add_u32 m0, s32, 90112
    s_add_u32 s42, s44, 0x00088000
    buffer_load_dwordx4 v3, s[16:19], s42 offen lds
    buffer_load_dwordx4 v4, s[16:19], s42 offen offset:1024 lds
    s_add_u32 m0, s32, 98304
    s_add_u32 s42, s44, 0x000b8000
    buffer_load_dwordx4 v3, s[16:19], s42 offen lds
    buffer_load_dwordx4 v4, s[16:19], s42 offen offset:1024 lds
    s_add_u32 m0, s32, 106496
    s_add_u32 s42, s44, 0x000e8000
    buffer_load_dwordx4 v3, s[16:19], s42 offen lds
    buffer_load_dwordx4 v4, s[16:19], s42 offen offset:1024 lds
    s_lshl_b32 s40, s27, 9
    s_add_u32 s40, s40, 11583488
    v_lshlrev_b32 v16, 2, v1
    s_mov_b32 s59, 0x40000
    s_mov_b64 exec, 0x3fffffff
L_poll_p5l:
    buffer_load_dword v17, v16, s[12:15], s40 offen offset:0 sc1
L_poll_p5l_c:
    s_sub_u32 s59, s59, 1
    s_waitcnt vmcnt(0)
    v_cmp_ne_u32 vcc, s53, v17
    s_cmp_eq_u32 s59, 0
    s_cbranch_scc1 L_poll_p5l_x
    s_cbranch_vccnz L_poll_p5l
L_poll_p5l_x:
    s_mov_b64 exec, -1
L_poll_p5l_go:
    s_add_u32 m0, s35, 114688
    s_add_u32 s43, s34, 0
    buffer_load_dwordx4 v2, s[12:15], s43 offen sc1 lds
    buffer_load_dwordx4 v2, s[12:15], s43 offen offset:1024 sc1 lds
    s_add_u32 m0, s35, 122880
    s_add_u32 s43, s34, 4096
    buffer_load_dwordx4 v2, s[12:15], s43 offen sc1 lds
    buffer_load_dwordx4 v2, s[12:15], s43 offen offset:1024 sc1 lds
    s_add_u32 m0, s35, 131072
    s_add_u32 s43, s34, 8192
    buffer_load_dwordx4 v2, s[12:15], s43 offen sc1 lds
    buffer_load_dwordx4 v2, s[12:15], s43 offen offset:1024 sc1 lds
    s_add_u32 m0, s35, 139264
    s_add_u32 s43, s34, 12288
    buffer_load_dwordx4 v2, s[12:15], s43 offen sc1 lds
    buffer_load_dwordx4 v2, s[12:15], s43 offen offset:1024 sc1 lds
    s_add_u32 m0, s35, 147456
    s_add_u32 s43, s34, 16384
    buffer_load_dwordx4 v2, s[12:15], s43 offen sc1 lds
    buffer_load_dwordx4 v2, s[12:15], s43 offen offset:1024 sc1 lds
    s_add_u32 m0, s35, 155648
    s_add_u32 s43, s34, 20480
    buffer_load_dwordx4 v2, s[12:15], s43 offen sc1 lds
    buffer_load_dwordx4 v2, s[12:15], s43 offen offset:1024 sc1 lds
    s_waitcnt vmcnt(10)
    s_barrier
    s_add_u32 m0, s35, 24576
    s_nop 0
    buffer_load_dwordx4 v2, s[12:15], s36 offen sc1 lds
    buffer_load_dwordx4 v2, s[12:15], s36 offen offset:1024 sc1 lds
    s_waitcnt vmcnt(10)
    s_barrier
    s_waitcnt vmcnt(8)
    s_barrier
    s_add_u32 m0, s32, 0
    s_add_u32 s42, s44, 0x00118000
    buffer_load_dwordx4 v3, s[16:19], s42 offen lds
    buffer_load_dwordx4 v4, s[16:19], s42 offen offset:1024 lds
    s_add_u32 m0, s35, 114688
    s_add_u32 s43, s34, 24576
    buffer_load_dwordx4 v2, s[12:15], s43 offen sc1 lds
    buffer_load_dwordx4 v2, s[12:15], s43 offen offset:1024 sc1 lds
    s_waitcnt vmcnt(10)
    s_barrier
    s_add_u32 m0, s32, 8192
    s_add_u32 s42, s44, 0x00148000
    s_add_u32 s45, s44, 0xffff0000
    s_cmp_ge_u32 s29, 2
    s_cselect_b32 s42, s45, s42
    buffer_load_dwordx4 v3, s[16:19], s42 offen lds
    buffer_load_dwordx4 v4, s[16:19], s42 offen offset:1024 lds
    s_add_u32 m0, s35, 122880
    s_add_u32 s43, s34, 28672
    buffer_load_dwordx4 v2, s[12:15], s43 offen sc1 lds
    buffer_load_dwordx4 v2, s[12:15], s43 offen offset:1024 sc1 lds
    s_waitcnt vmcnt(8)
    s_barrier
    s_add_u32 m0, s32, 16384
    s_add_u32 s42, s44, 0x00020000
    buffer_load_dwordx4 v3, s[16:19], s42 offen lds
    buffer_load_dwordx4 v4, s[16:19], s42 offen offset:1024 lds
    s_add_u32 m0, s35, 131072
    s_add_u32 s43, s34, 32768
    buffer_load_dwordx4 v2, s[12:15], s43 offen sc1 lds
    buffer_load_dwordx4 v2, s[12:15], s43 offen offset:1024 sc1 lds
    s_barrier
    s_add_u32 m0, s32, 32768
    s_add_u32 s42, s44, 0x00050000
    buffer_load_dwordx4 v3, s[16:19], s42 offen lds
    buffer_load_dwordx4 v4, s[16:19], s42 offen offset:1024 lds
    s_add_u32 m0, s35, 139264
    s_add_u32 s43, s34, 36864
    buffer_load_dwordx4 v2, s[12:15], s43 offen sc1 lds
    buffer_load_dwordx4 v2, s[12:15], s43 offen offset:1024 sc1 lds
    s_waitcnt vmcnt(12)
    s_barrier
    s_add_u32 m0, s32, 40960
    s_add_u32 s42, s44, 0x00080000
    buffer_load_dwordx4 v3, s[16:19], s42 offen lds
    buffer_load_dwordx4 v4, s[16:19], s42 offen offset:1024 lds
    s_add_u32 m0, s35, 147456
    s_add_u32 s43, s34, 40960
    buffer_load_dwordx4 v2, s[12:15], s43 offen sc1 lds
    buffer_load_dwordx4 v2, s[12:15], s43 offen offset:1024 sc1 lds
    s_waitcnt vmcnt(12)
    s_barrier
    s_add_u32 m0, s32, 49152
    s_add_u32 s42, s44, 0x000b0000
    buffer_load_dwordx4 v3, s[16:19], s42 offen lds
    buffer_load_dwordx4 v4, s[16:19], s42 offen offset:1024 lds
    s_add_u32 m0, s35, 155648
    s_add_u32 s43, s34, 45056
    buffer_load_dwordx4 v2, s[12:15], s43 offen sc1 lds
    buffer_load_dwordx4 v2, s[12:15], s43 offen offset:1024 sc1 lds
    s_waitcnt vmcnt(12)
    s_barrier
    s_add_u32 m0, s32, 57344
    s_add_u32 s42, s44, 0x000e0000
    buffer_load_dwordx4 v3, s[16:19], s42 offen lds
    buffer_load_dwordx4 v4, s[16:19], s42 offen offset:1024 lds
    s_add_u32 m0, s35, 114688
    s_add_u32 s43, s34, 49152
    buffer_load_dwordx4 v2, s[12:15], s43 offen sc1 lds
    buffer_load_dwordx4 v2, s[12:15], s43 offen offset:1024 sc1 lds
    s_waitcnt vmcnt(12)
    s_barrier
    s_add_u32 m0, s32, 65536
    s_add_u32 s42, s44, 0x00110000
    buffer_load_dwordx4 v3, s[16:19], s42 offen lds
    buffer_load_dwordx4 v4, s[16:19], s42 offen offset:1024 lds
    s_add_u32 m0, s35, 122880
    s_add_u32 s43, s34, 53248
    buffer_load_dwordx4 v2, s[12:15], s43 offen sc1 lds
    buffer_load_dwordx4 v2, s[12:15], s43 offen offset:1024 sc1 lds
    s_waitcnt vmcnt(12)
    s_barrier
    s_add_u32 m0, s32, 73728
    s_add_u32 s42, s44, 0x00140000
    buffer_load_dwordx4 v3, s[16:19], s42 offen lds
    buffer_load_dwordx4 v4, s[16:19], s42 offen offset:1024 lds
    s_add_u32 m0, s35, 131072
    s_add_u32 s43, s34, 57344
    buffer_load_dwordx4 v2, s[12:15], s43 offen sc1 lds
    buffer_load_dwordx4 v2, s[12:15], s43 offen offset:1024 sc1 lds
    s_waitcnt vmcnt(12)
    s_barrier
    s_add_u32 m0, s35, 139264
    s_add_u32 s43, s34, 61440
    buffer_load_dwordx4 v2, s[12:15], s43 offen sc1 lds
    buffer_load_dwordx4 v2, s[12:15], s43 offen offset:1024 sc1 lds
    s_waitcnt vmcnt(10)
    s_barrier
    s_add_u32 m0, s35, 147456
    s_add_u32 s43, s34, 65536
    buffer_load_dwordx4 v2, s[12:15], s43 offen sc1 lds
    buffer_load_dwordx4 v2, s[12:15], s43 offen offset:1024 sc1 lds
    s_waitcnt vmcnt(8)
    s_barrier
    s_add_u32 m0, s35, 155648
    s_add_u32 s43, s34, 69632
    buffer_load_dwordx4 v2, s[12:15], s43 offen sc1 lds
    buffer_load_dwordx4 v2, s[12:15], s43 offen offset:1024 sc1 lds
    s_waitcnt vmcnt(6)
    s_barrier
    s_add_u32 m0, s35, 114688
    s_add_u32 s43, s34, 73728
    buffer_load_dwordx4 v2, s[12:15], s43 offen sc1 lds
    buffer_load_dwordx4 v2, s[12:15], s43 offen offset:1024 sc1 lds
    s_waitcnt vmcnt(6)
    s_barrier
    s_add_u32 m0, s35, 122880
    s_add_u32 s43, s34, 77824
    buffer_load_dwordx4 v2, s[12:15], s43 offen sc1 lds
    buffer_load_dwordx4 v2, s[12:15], s43 offen offset:1024 sc1 lds
    s_waitcnt vmcnt(6)
    s_barrier
    s_add_u32 m0, s35, 131072
    s_add_u32 s43, s34, 81920
    buffer_load_dwordx4 v2, s[12:15], s43 offen sc1 lds
    buffer_load_dwordx4 v2, s[12:15], s43 offen offset:1024 sc1 lds
    s_waitcnt vmcnt(6)
    s_barrier
    s_add_u32 m0, s35, 139264
    s_add_u32 s43, s34, 86016
    buffer_load_dwordx4 v2, s[12:15], s43 offen sc1 lds
    buffer_load_dwordx4 v2, s[12:15], s43 offen offset:1024 sc1 lds
    s_waitcnt vmcnt(6)
    s_barrier
    s_waitcnt vmcnt(4)
    s_barrier
    s_waitcnt vmcnt(2)
    s_barrier
    s_waitcnt vmcnt(0)
    s_barrier
    s_endpgm
L_compute:
    s_and_b32 s30, s2, 7
    s_lshl_b32 s27, s30, 2
    s_lshr_b32 s34, s2, 6
    s_add_u32 s27, s27, s34
    s_bfe_u32 s28, s2, 0x30003
    s_and_b32 s25, s24, 1
    s_bfe_u32 s26, s24, 0x10001
    v_and_b32 v12, 31, v1
    v_lshrrev_b32 v13, 5, v1
    v_bfe_u32 v14, v1, 2, 2
    v_lshl_add_u32 v15, v13, 2, v14
    v_lshlrev_b32 v15, 7, v15
    v_bfe_u32 v16, v1, 4, 1
    v_lshl_add_u32 v15, v16, 5, v15
    v_and_b32 v16, 3, v1
    v_lshl_add_u32 v15, v16, 3, v15
    v_lshrrev_b32 v14, 1, v14
    v_xor_b32 v14, s26, v14
    v_lshl_add_u32 v3, v14, 6, v15
    v_add_u32 v4, 0x00010000, v3
    s_lshl_b32 s30, s25, 12
    v_add_u32 v5, s30, v2
    v_add_u32 v6, 0x00010000, v5
    v_add_u32 v22, 0x00020000, v5
    v_bfe_u32 v14, v1, 1, 3
    v_xor_b32 v14, v14, v13
    s_lshl_b32 s31, s26, 2
    v_xor_b32 v14, s31, v14
    v_lshlrev_b32 v14, 4, v14
    v_lshl_add_u32 v14, v12, 7, v14
    s_add_u32 s30, s30, 155648
    v_add_u32 v7, s30, v14
    v_xor_b32 v8, 32, v7
    v_mov_b32 v18, 0
    v_mov_b32 v19, s53
    s_mov_b64 exec, 1
    s_waitcnt vmcnt(0)
    s_cmp_eq_u32 s54, 0
    s_cbranch_scc1 L_st_7_s
    buffer_store_dword v19, v18, s[12:15], s55 offen
    s_branch L_st_7_j
L_st_7_s:
    buffer_store_dword v19, v18, s[12:15], s55 offen sc1
L_st_7_j:
    s_mov_b64 exec, -1
    v_mov_b32 v17, 0x3f80
    v_lshlrev_b32 v14, 3, v13
    v_sub_u32 v14, v12, v14
    v_subrev_u32 v14, 0, v14
    v_and_b32 v15, 1, v14
    v_lshlrev_b32 v15, 4, v15
    v_lshlrev_b32 v15, v15, v17
    v_lshrrev_b32 v14, 1, v14
    v_cmp_eq_u32 vcc, 0, v14
    s_nop 1
    v_cndmask_b32 v24, 0, v15, vcc
    v_cmp_eq_u32 vcc, 1, v14
    s_nop 1
    v_cndmask_b32 v25, 0, v15, vcc
    v_cmp_eq_u32 vcc, 2, v14
    s_nop 1
    v_cndmask_b32 v26, 0, v15, vcc
    v_cmp_eq_u32 vcc, 3, v14
    s_nop 1
    v_cndmask_b32 v27, 0, v15, vcc
    v_lshlrev_b32 v14, 3, v13
    v_sub_u32 v14, v12, v14
    v_subrev_u32 v14, 16, v14
    v_and_b32 v15, 1, v14
    v_lshlrev_b32 v15, 4, v15
    v_lshlrev_b32 v15, v15, v17
    v_lshrrev_b32 v14, 1, v14
    v_cmp_eq_u32 vcc, 0, v14
    s_nop 1
    v_cndmask_b32 v28, 0, v15, vcc
    v_cmp_eq_u32 vcc, 1, v14
    s_nop 1
    v_cndmask_b32 v29, 0, v15, vcc
    v_cmp_eq_u32 vcc, 2, v14
    s_nop 1
    v_cndmask_b32 v30, 0, v15, vcc
    v_cmp_eq_u32 vcc, 3, v14
    s_nop 1
    v_cndmask_b32 v31, 0, v15, vcc
    s_lshl_b32 s33, s27, 1
    s_add_u32 s33, s33, s25
    s_lshl_b32 s34, s28, 1
    s_add_u32 s34, s34, s26
    s_mul_i32 s31, s33, 126976
    s_lshl_b32 s36, s34, 11
    s_add_u32 s36, s36, s31
    s_lshl_b32 s37, s34, 8
    s_add_u32 s37, s37, s31
    s_add_u32 s37, s37, 120832
    s_mov_b32 s41, 0x3f803f80
    v_lshlrev_b32 v11, 3, v1
    s_lshl_b32 s55, s27, 7
    s_lshl_b32 s31, s28, 4
    s_add_u32 s55, s55, s31
    s_lshl_b32 s31, s24, 2
    s_add_u32 s55, s55, s31
    s_add_u32 s55, s55, 11542528
    s_lshl_b32 s40, s27, 8
    s_add_u32 s40, s40, 11534336
    s_cmp_lg_u32 s24, 0
    s_cbranch_scc1 L_poll_p3_go
    v_lshlrev_b32 v18, 2, v1
    s_mov_b32 s59, 0x40000
L_poll_p3:
    buffer_load_dword v19, v18, s[12:15], s40 offen offset:0 sc1
L_poll_p3_c:
    s_sub_u32 s59, s59, 1
    s_waitcnt vmcnt(0)
    v_cmp_ne_u32 vcc, s53, v19
    s_cmp_eq_u32 s59, 0
    s_cbranch_scc1 L_poll_p3_x
    s_cbranch_vccnz L_poll_p3
L_poll_p3_x:
    s_mov_b64 exec, -1
L_poll_p3_go:
    s_barrier
    s_barrier
    ds_read_b128 v[32:35], v6 offset:57344
    ds_read_b64_tr_b16 v[36:37], v3 offset:0
    ds_read_b64_tr_b16 v[38:39], v3 offset:1024
    ds_read_b128 v[40:43], v6 offset:58368
    ds_read_b64_tr_b16 v[44:45], v3 offset:2048
    ds_read_b64_tr_b16 v[46:47], v3 offset:3072
    ds_read_b128 v[48:51], v6 offset:59392
    ds_read_b64_tr_b16 v[52:53], v3 offset:4096
    ds_read_b64_tr_b16 v[54:55], v3 offset:5120
    ds_read_b128 v[56:59], v6 offset:60416
    ds_read_b64_tr_b16 v[60:61], v3 offset:6144
    ds_read_b64_tr_b16 v[62:63], v3 offset:7168
    ds_read_b128 v[64:67], v7
    ds_read_b128 v[68:71], v8
    s_barrier
    s_waitcnt lgkmcnt(11)
    v_mfma_f32_32x32x16_bf16 v[112:127], v[36:39], v[32:35], 0
    ds_read_b128 v[72:75], v22 offset:0
    ds_read_b64_tr_b16 v[76:77], v3 offset:8192
    ds_read_b64_tr_b16 v[78:79], v3 offset:9216
    s_waitcnt lgkmcnt(11)
    v_mfma_f32_32x32x16_bf16 v[112:127], v[44:47], v[40:43], v[112:127]
    ds_read_b128 v[80:83], v22 offset:1024
    ds_read_b64_tr_b16 v[84:85], v3 offset:10240
    ds_read_b64_tr_b16 v[86:87], v3 offset:11264
    s_waitcnt lgkmcnt(11)
    v_mfma_f32_32x32x16_bf16 v[112:127], v[52:55], v[48:51], v[112:127]
    ds_read_b128 v[88:91], v22 offset:2048
    ds_read_b64_tr_b16 v[92:93], v3 offset:12288
    ds_read_b64_tr_b16 v[94:95], v3 offset:13312
    s_waitcnt lgkmcnt(11)
    v_mfma_f32_32x32x16_bf16 v[112:127], v[60:63], v[56:59], v[112:127]
    ds_read_b128 v[96:99], v22 offset:3072
    ds_read_b64_tr_b16 v[100:101], v3 offset:14336
    ds_read_b64_tr_b16 v[102:103], v3 offset:15360
    s_waitcnt lgkmcnt(13)
    v_mfma_f32_32x32x16_bf16 v[112:127], v[24:27], v[64:67], v[112:127]
    s_waitcnt lgkmcnt(12)
    v_mfma_f32_32x32x16_bf16 v[112:127], v[28:31], v[68:71], v[112:127]
    s_barrier
    s_waitcnt lgkmcnt(9)
    v_mfma_f32_32x32x16_bf16 v[112:127], v[76:79], v[72:75], v[112:127]
    ds_read_b128 v[32:35], v22 offset:8192
    ds_read_b64_tr_b16 v[36:37], v3 offset:16384
    ds_read_b64_tr_b16 v[38:39], v3 offset:17408
    s_waitcnt lgkmcnt(9)
    v_mfma_f32_32x32x16_bf16 v[112:127], v[84:87], v[80:83], v[112:127]
    ds_read_b128 v[40:43], v22 offset:9216
    ds_read_b64_tr_b16 v[44:45], v3 offset:18432
    ds_read_b64_tr_b16 v[46:47], v3 offset:19456
    s_waitcnt lgkmcnt(9)
    v_mfma_f32_32x32x16_bf16 v[112:127], v[92:95], v[88:91], v[112:127]
    ds_read_b128 v[48:51], v22 offset:10240
    ds_read_b64_tr_b16 v[52:53], v3 offset:20480
    ds_read_b64_tr_b16 v[54:55], v3 offset:21504
    s_waitcnt lgkmcnt(9)
    v_mfma_f32_32x32x16_bf16 v[112:127], v[100:103], v[96:99], v[112:127]
    ds_read_b128 v[56:59], v22 offset:11264
    ds_read_b64_tr_b16 v[60:61], v3 offset:22528
    ds_read_b64_tr_b16 v[62:63], v3 offset:23552
    s_barrier
    s_waitcnt lgkmcnt(9)
    v_mfma_f32_32x32x16_bf16 v[112:127], v[36:39], v[32:35], v[112:127]
    ds_read_b128 v[72:75], v22 offset:16384
    ds_read_b64_tr_b16 v[76:77], v3 offset:24576
    ds_read_b64_tr_b16 v[78:79], v3 offset:25600
    s_waitcnt lgkmcnt(9)
    v_mfma_f32_32x32x16_bf16 v[112:127], v[44:47], v[40:43], v[112:127]
    ds_read_b128 v[80:83], v22 offset:17408
    ds_read_b64_tr_b16 v[84:85], v3 offset:26624
    ds_read_b64_tr_b16 v[86:87], v3 offset:27648
    s_waitcnt lgkmcnt(9)
    v_mfma_f32_32x32x16_bf16 v[112:127], v[52:55], v[48:51], v[112:127]
    ds_read_b128 v[88:91], v22 offset:18432
    ds_read_b64_tr_b16 v[92:93], v3 offset:28672
    ds_read_b64_tr_b16 v[94:95], v3 offset:29696
    s_waitcnt lgkmcnt(9)
    v_mfma_f32_32x32x16_bf16 v[112:127], v[60:63], v[56:59], v[112:127]
    ds_read_b128 v[96:99], v22 offset:19456
    ds_read_b64_tr_b16 v[100:101], v3 offset:30720
    ds_read_b64_tr_b16 v[102:103], v3 offset:31744
    s_barrier
    s_waitcnt lgkmcnt(9)
    v_mfma_f32_32x32x16_bf16 v[112:127], v[76:79], v[72:75], v[112:127]
    ds_read_b128 v[32:35], v5 offset:57344
    ds_read_b64_tr_b16 v[36:37], v4 offset:0
    ds_read_b64_tr_b16 v[38:39], v4 offset:1024
    s_waitcnt lgkmcnt(9)
    v_mfma_f32_32x32x16_bf16 v[112:127], v[84:87], v[80:83], v[112:127]
    ds_read_b128 v[40:43], v5 offset:58368
    ds_read_b64_tr_b16 v[44:45], v4 offset:2048
    ds_read_b64_tr_b16 v[46:47], v4 offset:3072
    s_waitcnt lgkmcnt(9)
    v_mfma_f32_32x32x16_bf16 v[112:127], v[92:95], v[88:91], v[112:127]
    ds_read_b128 v[48:51], v5 offset:59392
    ds_read_b64_tr_b16 v[52:53], v4 offset:4096
    ds_read_b64_tr_b16 v[54:55], v4 offset:5120
    s_waitcnt lgkmcnt(9)
    v_mfma_f32_32x32x16_bf16 v[112:127], v[100:103], v[96:99], v[112:127]
    ds_read_b128 v[56:59], v5 offset:60416
    ds_read_b64_tr_b16 v[60:61], v4 offset:6144
    ds_read_b64_tr_b16 v[62:63], v4 offset:7168
    s_barrier
    s_waitcnt lgkmcnt(9)
    v_mfma_f32_32x32x16_bf16 v[112:127], v[36:39], v[32:35], v[112:127]
    ds_read_b128 v[72:75], v6 offset:57344
    ds_read_b64_tr_b16 v[76:77], v4 offset:8192
    ds_read_b64_tr_b16 v[78:79], v4 offset:9216
    s_waitcnt lgkmcnt(9)
    v_mfma_f32_32x32x16_bf16 v[112:127], v[44:47], v[40:43], v[112:127]
    ds_read_b128 v[80:83], v6 offset:58368
    ds_read_b64_tr_b16 v[84:85], v4 offset:10240
    ds_read_b64_tr_b16 v[86:87], v4 offset:11264
    s_waitcnt lgkmcnt(9)
    v_mfma_f32_32x32x16_bf16 v[112:127], v[52:55], v[48:51], v[112:127]
    ds_read_b128 v[88:91], v6 offset:59392
    ds_read_b64_tr_b16 v[92:93], v4 offset:12288
    ds_read_b64_tr_b16 v[94:95], v4 offset:13312
    s_waitcnt lgkmcnt(9)
    v_mfma_f32_32x32x16_bf16 v[112:127], v[60:63], v[56:59], v[112:127]
    ds_read_b128 v[96:99], v6 offset:60416
    ds_read_b64_tr_b16 v[100:101], v4 offset:14336
    ds_read_b64_tr_b16 v[102:103], v4 offset:15360
    s_barrier
    s_waitcnt lgkmcnt(9)
    v_mfma_f32_32x32x16_bf16 v[112:127], v[76:79], v[72:75], v[112:127]
    ds_read_b128 v[32:35], v5 offset:0
    ds_read_b64_tr_b16 v[36:37], v4 offset:16384
    ds_read_b64_tr_b16 v[38:39], v4 offset:17408
    s_waitcnt lgkmcnt(9)
    v_mfma_f32_32x32x16_bf16 v[112:127], v[84:87], v[80:83], v[112:127]
    ds_read_b128 v[40:43], v5 offset:1024
    ds_read_b64_tr_b16 v[44:45], v4 offset:18432
    ds_read_b64_tr_b16 v[46:47], v4 offset:19456
    s_waitcnt lgkmcnt(9)
    v_mfma_f32_32x32x16_bf16 v[112:127], v[92:95], v[88:91], v[112:127]
    ds_read_b128 v[48:51], v5 offset:2048
    ds_read_b64_tr_b16 v[52:53], v4 offset:20480
    ds_read_b64_tr_b16 v[54:55], v4 offset:21504
    s_waitcnt lgkmcnt(9)
    v_mfma_f32_32x32x16_bf16 v[112:127], v[100:103], v[96:99], v[112:127]
    ds_read_b128 v[56:59], v5 offset:3072
    ds_read_b64_tr_b16 v[60:61], v4 offset:22528
    ds_read_b64_tr_b16 v[62:63], v4 offset:23552
    s_barrier
    s_waitcnt lgkmcnt(9)
    v_mfma_f32_32x32x16_bf16 v[112:127], v[36:39], v[32:35], v[112:127]
    ds_read_b128 v[72:75], v22 offset:0
    ds_read_b64_tr_b16 v[76:77], v4 offset:24576
    ds_read_b64_tr_b16 v[78:79], v4 offset:25600
    s_waitcnt lgkmcnt(9)
    v_mfma_f32_32x32x16_bf16 v[112:127], v[44:47], v[40:43], v[112:127]
    ds_read_b128 v[80:83], v22 offset:1024
    ds_read_b64_tr_b16 v[84:85], v4 offset:26624
    ds_read_b64_tr_b16 v[86:87], v4 offset:27648
    s_waitcnt lgkmcnt(9)
    v_mfma_f32_32x32x16_bf16 v[112:127], v[52:55], v[48:51], v[112:127]
    ds_read_b128 v[88:91], v22 offset:2048
    ds_read_b64_tr_b16 v[92:93], v4 offset:28672
    ds_read_b64_tr_b16 v[94:95], v4 offset:29696
    s_waitcnt lgkmcnt(9)
    v_mfma_f32_32x32x16_bf16 v[112:127], v[60:63], v[56:59], v[112:127]
    ds_read_b128 v[96:99], v22 offset:3072
    ds_read_b64_tr_b16 v[100:101], v4 offset:30720
    ds_read_b64_tr_b16 v[102:103], v4 offset:31744
    s_waitcnt lgkmcnt(9)
    v_mfma_f32_32x32x16_bf16 v[112:127], v[76:79], v[72:75], v[112:127]
    s_waitcnt lgkmcnt(6)
    v_mfma_f32_32x32x16_bf16 v[112:127], v[84:87], v[80:83], v[112:127]
    s_waitcnt lgkmcnt(3)
    v_mfma_f32_32x32x16_bf16 v[112:127], v[92:95], v[88:91], v[112:127]
    s_waitcnt lgkmcnt(0)
    v_mfma_f32_32x32x16_bf16 v[112:127], v[100:103], v[96:99], v[112:127]
    s_nop 11
    v_cvt_pk_bf16_f32 v32, v112, v113
    v_cvt_pk_bf16_f32 v33, v114, v115
    v_cvt_pk_bf16_f32 v34, v116, v117
    v_cvt_pk_bf16_f32 v35, v118, v119
    v_cvt_pk_bf16_f32 v36, v120, v121
    v_cvt_pk_bf16_f32 v37, v122, v123
    v_cvt_pk_bf16_f32 v38, v124, v125
    v_cvt_pk_bf16_f32 v39, v126, v127
    s_cmp_eq_u32 s54, 0
    s_cbranch_scc1 L_st_8_s
    buffer_store_dwordx4 v[32:35], v2, s[12:15], s36 offen
    buffer_store_dwordx4 v[36:39], v2, s[12:15], s36 offen offset:1024
    s_branch L_st_8_j
L_st_8_s:
    buffer_store_dwordx4 v[32:35], v2, s[12:15], s36 offen sc1
    buffer_store_dwordx4 v[36:39], v2, s[12:15], s36 offen offset:1024 sc1
L_st_8_j:
    v_dot2_f32_bf16 v12, v32, s41, 0
    v_dot2_f32_bf16 v13, v32, v32, 0
    v_dot2_f32_bf16 v12, v33, s41, v12
    v_dot2_f32_bf16 v13, v33, v33, v13
    v_dot2_f32_bf16 v12, v34, s41, v12
    v_dot2_f32_bf16 v13, v34, v34, v13
    v_dot2_f32_bf16 v12, v35, s41, v12
    v_dot2_f32_bf16 v13, v35, v35, v13
    v_dot2_f32_bf16 v12, v36, s41, v12
    v_dot2_f32_bf16 v13, v36, v36, v13
    v_dot2_f32_bf16 v12, v37, s41, v12
    v_dot2_f32_bf16 v13, v37, v37, v13
    v_dot2_f32_bf16 v12, v38, s41, v12
    v_dot2_f32_bf16 v13, v38, v38, v13
    v_dot2_f32_bf16 v12, v39, s41, v12
    v_dot2_f32_bf16 v13, v39, v39, v13
    s_nop 2
    v_mov_b32 v14, v12
    v_mov_b32 v15, v13
    s_nop 0
    v_permlane32_swap_b32 v12, v14
    v_permlane32_swap_b32 v13, v15
    s_nop 0
    v_add_f32 v12, v12, v14
    v_add_f32 v13, v13, v15
    s_mov_b32 exec_hi, 0
    s_cmp_eq_u32 s54, 0
    s_cbranch_scc1 L_st_9_s
    buffer_store_dwordx2 v[12:13], v11, s[12:15], s37 offen
    s_branch L_st_9_j
L_st_9_s:
    buffer_store_dwordx2 v[12:13], v11, s[12:15], s37 offen sc1
L_st_9_j:
    s_mov_b64 exec, -1
    s_barrier
    v_mov_b32 v16, 0
    v_mov_b32 v17, s53
    s_mov_b64 exec, 1
    s_waitcnt vmcnt(0)
    s_cmp_eq_u32 s54, 0
    s_cbranch_scc1 L_st_10_s
    buffer_store_dword v17, v16, s[12:15], s55 offen
    s_branch L_st_10_j
L_st_10_s:
    buffer_store_dword v17, v16, s[12:15], s55 offen sc1
L_st_10_j:
    s_mov_b64 exec, -1
    s_and_b32 s30, s2, 7
    s_lshl_b32 s30, s30, 1
    s_bfe_u32 s31, s2, 0x10003
    s_add_u32 s25, s30, s31
    s_lshr_b32 s26, s2, 4
    s_cmp_ge_u32 s2, 240
    s_cbranch_scc1 L_p4_skip_c
    s_lshr_b32 s36, s29, 1
    s_and_b32 s37, s29, 1
    s_lshl_b32 s34, s25, 1
    s_add_u32 s34, s34, s36
    v_lshrrev_b32 v23, 5, v1
    v_bfe_u32 v20, v1, 2, 2
    v_lshl_add_u32 v20, v23, 2, v20
    v_mul_u32_u24 v20, 192, v20
    v_and_b32 v21, 3, v1
    v_lshl_add_u32 v20, v21, 3, v20
    s_mul_i32 s30, s37, 96
    v_add_u32 v20, s30, v20
    v_bfe_u32 v21, v1, 4, 1
    s_lshl_b32 s30, s37, 6
    s_sub_u32 s31, 3104, s30
    s_add_u32 s30, 3040, s30
    v_mad_u32_u24 v3, v21, s31, v20
    v_mad_u32_u24 v5, v21, s30, v20
    v_add_u32 v4, 0x00010000, v3
    v_add_u32 v6, 0x00010000, v5
    s_lshl_b32 s30, s36, 12
    s_add_u32 s30, s30, 122880
    v_add_u32 v7, s30, v2
    v_xor_b32 v20, v21, v1
    v_and_b32 v20, 1, v20
    v_cmp_eq_u32 vcc, 0, v20
    v_mov_b32 v20, 0x3f803f80
    s_nop 0
    v_cndmask_b32 v12, 0, v20, vcc
    v_cndmask_b32 v13, 0, v20, vcc
    v_cndmask_b32 v14, 0, v20, vcc
    v_cndmask_b32 v15, 0, v20, vcc
    s_lshl_b32 s30, s37, 1
    s_add_u32 s31, s30, s36
    s_mul_i32 s31, s31, 384
    s_add_u32 s31, s31, 24576
    v_and_b32 v20, 1, v1
    v_lshlrev_b32 v20, 6, v20
    v_and_b32 v21, 48, v1
    v_add3_u32 v8, v20, v21, s31
    s_mul_i32 s30, s30, 384
    s_add_u32 s30, s30, 24576
    v_mul_u32_u24 v20, 384, v23
    v_and_b32 v21, 31, v1
    v_lshl_add_u32 v20, v21, 2, v20
    v_add_u32 v9, s30, v20
    s_lshl_b32 s55, s34, 9
    s_lshl_b32 s35, s26, 1
    s_add_u32 s35, s35, s37
    s_lshl_b32 s30, s35, 2
    s_add_u32 s55, s55, s30
    s_add_u32 s55, s55, 11583488
    s_mul_i32 s34, s34, 253952
    s_mul_i32 s38, s35, 3
    s_lshl_b32 s35, s35, 10
    s_add_u32 s34, s34, s35
    s_add_u32 s34, s34, 32768
    s_add_u32 s35, s34, 126976
    s_mul_i32 s30, s36, 3072
    s_add_u32 s30, s30, 26112
    v_add_u32 v10, s30, v2
    v_lshl_add_u32 v11, v1, 3, s30
    v_mov_b32 v20, 0
    v_mov_b32 v21, 0
    v_mov_b32 v22, 0
    v_mov_b32 v23, 0
    v_mov_b32 v24, 0
    v_mov_b32 v25, 0
    v_mov_b32 v26, 0
    v_mov_b32 v27, 0
    v_mov_b32 v28, 0
    v_mov_b32 v29, 0
    v_mov_b32 v30, 0
    v_mov_b32 v31, 0
    s_lshl_b32 s40, s25, 8
    s_add_u32 s40, s40, 11542528
    s_cmp_lg_u32 s24, 0
    s_cbranch_scc1 L_poll_p4_go
    v_lshlrev_b32 v16, 2, v1
    s_mov_b32 s59, 0x40000
L_poll_p4:
    buffer_load_dword v17, v16, s[12:15], s40 offen offset:0 sc1
L_poll_p4_c:
    s_sub_u32 s59, s59, 1
    s_waitcnt vmcnt(0)
    v_cmp_ne_u32 vcc, s53, v17
    s_cmp_eq_u32 s59, 0
    s_cbranch_scc1 L_poll_p4_x
    s_cbranch_vccnz L_poll_p4
L_poll_p4_x:
    s_mov_b64 exec, -1
L_poll_p4_go:
    s_barrier
    s_barrier
    ds_read_b128 v[128:131], v7 offset:0
    ds_read_b64_tr_b16 v[144:145], v3 offset:32768
    ds_read_b64_tr_b16 v[146:147], v3 offset:34304
    ds_read_b128 v[132:135], v7 offset:2048
    ds_read_b64_tr_b16 v[148:149], v5 offset:32800
    ds_read_b64_tr_b16 v[150:151], v5 offset:34336
    ds_read_b64_tr_b16 v[152:153], v3 offset:32832
    ds_read_b64_tr_b16 v[154:155], v3 offset:34368
    s_cmp_eq_u32 s36, 1
    s_cbranch_scc1 L_p4_odd
    s_waitcnt lgkmcnt(4)
    v_mfma_f32_16x16x32_bf16 v[20:23], v[144:147], v[12:15], v[20:23]
    v_mfma_f32_32x32x16_bf16 v[32:47], v[144:147], v[128:131], 0
    ds_read_b128 v[136:139], v7 offset:1024
    ds_read_b64_tr_b16 v[156:157], v3 offset:38912
    v_mfma_f32_32x32x16_bf16 v[48:63], v[144:147], v[132:135], 0
    ds_read_b64_tr_b16 v[158:159], v3 offset:40448
    ds_read_b128 v[140:143], v7 offset:3072
    s_waitcnt lgkmcnt(6)
    v_mfma_f32_16x16x32_bf16 v[24:27], v[148:151], v[12:15], v[24:27]
    v_mfma_f32_32x32x16_bf16 v[64:79], v[148:151], v[128:131], 0
    ds_read_b64_tr_b16 v[160:161], v5 offset:38944
    ds_read_b64_tr_b16 v[162:163], v5 offset:40480
    v_mfma_f32_32x32x16_bf16 v[80:95], v[148:151], v[132:135], 0
    ds_read_b64_tr_b16 v[164:165], v3 offset:38976
    ds_read_b64_tr_b16 v[166:167], v3 offset:40512
    s_waitcnt lgkmcnt(8)
    v_mfma_f32_16x16x32_bf16 v[28:31], v[152:155], v[12:15], v[28:31]
    v_mfma_f32_32x32x16_bf16 v[96:111], v[152:155], v[128:131], 0
    v_mfma_f32_32x32x16_bf16 v[112:127], v[152:155], v[132:135], 0
    s_waitcnt lgkmcnt(0)
    s_barrier
    v_mfma_f32_32x32x16_bf16 v[32:47], v[156:159], v[136:139], v[32:47]
    ds_read_b128 v[128:131], v7 offset:8192
    ds_read_b64_tr_b16 v[144:145], v3 offset:45056
    v_mfma_f32_32x32x16_bf16 v[48:63], v[156:159], v[140:143], v[48:63]
    ds_read_b64_tr_b16 v[146:147], v3 offset:46592
    ds_read_b128 v[132:135], v7 offset:10240
    v_mfma_f32_32x32x16_bf16 v[64:79], v[160:163], v[136:139], v[64:79]
    ds_read_b64_tr_b16 v[148:149], v5 offset:45088
    ds_read_b64_tr_b16 v[150:151], v5 offset:46624
    v_mfma_f32_32x32x16_bf16 v[80:95], v[160:163], v[140:143], v[80:95]
    ds_read_b64_tr_b16 v[152:153], v3 offset:45120
    ds_read_b64_tr_b16 v[154:155], v3 offset:46656
    v_mfma_f32_32x32x16_bf16 v[96:111], v[164:167], v[136:139], v[96:111]
    v_mfma_f32_32x32x16_bf16 v[112:127], v[164:167], v[140:143], v[112:127]
    s_waitcnt lgkmcnt(4)
    v_mfma_f32_16x16x32_bf16 v[20:23], v[144:147], v[12:15], v[20:23]
    v_mfma_f32_32x32x16_bf16 v[32:47], v[144:147], v[128:131], v[32:47]
    ds_read_b128 v[136:139], v7 offset:9216
    ds_read_b64_tr_b16 v[156:157], v3 offset:51200
    v_mfma_f32_32x32x16_bf16 v[48:63], v[144:147], v[132:135], v[48:63]
    ds_read_b64_tr_b16 v[158:159], v3 offset:52736
    ds_read_b128 v[140:143], v7 offset:11264
    s_waitcnt lgkmcnt(6)
    v_mfma_f32_16x16x32_bf16 v[24:27], v[148:151], v[12:15], v[24:27]
    v_mfma_f32_32x32x16_bf16 v[64:79], v[148:151], v[128:131], v[64:79]
    ds_read_b64_tr_b16 v[160:161], v5 offset:51232
    ds_read_b64_tr_b16 v[162:163], v5 offset:52768
    v_mfma_f32_32x32x16_bf16 v[80:95], v[148:151], v[132:135], v[80:95]
    ds_read_b64_tr_b16 v[164:165], v3 offset:51264
    ds_read_b64_tr_b16 v[166:167], v3 offset:52800
    s_waitcnt lgkmcnt(8)
    v_mfma_f32_16x16x32_bf16 v[28:31], v[152:155], v[12:15], v[28:31]
    v_mfma_f32_32x32x16_bf16 v[96:111], v[152:155], v[128:131], v[96:111]
    v_mfma_f32_32x32x16_bf16 v[112:127], v[152:155], v[132:135], v[112:127]
    s_waitcnt lgkmcnt(0)
    s_barrier
    v_mfma_f32_32x32x16_bf16 v[32:47], v[156:159], v[136:139], v[32:47]
    ds_read_b128 v[128:131], v7 offset:16384
    ds_read_b64_tr_b16 v[144:145], v4 offset:32768
    v_mfma_f32_32x32x16_bf16 v[48:63], v[156:159], v[140:143], v[48:63]
    ds_read_b64_tr_b16 v[146:147], v4 offset:34304
    ds_read_b128 v[132:135], v7 offset:18432
    v_mfma_f32_32x32x16_bf16 v[64:79], v[160:163], v[136:139], v[64:79]
    ds_read_b64_tr_b16 v[148:149], v6 offset:32800
    ds_read_b64_tr_b16 v[150:151], v6 offset:34336
    v_mfma_f32_32x32x16_bf16 v[80:95], v[160:163], v[140:143], v[80:95]
    ds_read_b64_tr_b16 v[152:153], v4 offset:32832
    ds_read_b64_tr_b16 v[154:155], v4 offset:34368
    v_mfma_f32_32x32x16_bf16 v[96:111], v[164:167], v[136:139], v[96:111]
    v_mfma_f32_32x32x16_bf16 v[112:127], v[164:167], v[140:143], v[112:127]
    s_waitcnt lgkmcnt(4)
    v_mfma_f32_16x16x32_bf16 v[20:23], v[144:147], v[12:15], v[20:23]
    v_mfma_f32_32x32x16_bf16 v[32:47], v[144:147], v[128:131], v[32:47]
    ds_read_b128 v[136:139], v7 offset:17408
    ds_read_b64_tr_b16 v[156:157], v4 offset:38912
    v_mfma_f32_32x32x16_bf16 v[48:63], v[144:147], v[132:135], v[48:63]
    ds_read_b64_tr_b16 v[158:159], v4 offset:40448
    ds_read_b128 v[140:143], v7 offset:19456
    s_waitcnt lgkmcnt(6)
    v_mfma_f32_16x16x32_bf16 v[24:27], v[148:151], v[12:15], v[24:27]
    v_mfma_f32_32x32x16_bf16 v[64:79], v[148:151], v[128:131], v[64:79]
    ds_read_b64_tr_b16 v[160:161], v6 offset:38944
    ds_read_b64_tr_b16 v[162:163], v6 offset:40480
    v_mfma_f32_32x32x16_bf16 v[80:95], v[148:151], v[132:135], v[80:95]
    ds_read_b64_tr_b16 v[164:165], v4 offset:38976
    ds_read_b64_tr_b16 v[166:167], v4 offset:40512
    s_waitcnt lgkmcnt(8)
    v_mfma_f32_16x16x32_bf16 v[28:31], v[152:155], v[12:15], v[28:31]
    v_mfma_f32_32x32x16_bf16 v[96:111], v[152:155], v[128:131], v[96:111]
    v_mfma_f32_32x32x16_bf16 v[112:127], v[152:155], v[132:135], v[112:127]
    s_waitcnt lgkmcnt(0)
    s_barrier
    v_mfma_f32_32x32x16_bf16 v[32:47], v[156:159], v[136:139], v[32:47]
    ds_read_b128 v[128:131], v7 offset:24576
    ds_read_b64_tr_b16 v[144:145], v4 offset:45056
    v_mfma_f32_32x32x16_bf16 v[48:63], v[156:159], v[140:143], v[48:63]
    ds_read_b64_tr_b16 v[146:147], v4 offset:46592
    ds_read_b128 v[132:135], v7 offset:26624
    v_mfma_f32_32x32x16_bf16 v[64:79], v[160:163], v[136:139], v[64:79]
    ds_read_b64_tr_b16 v[148:149], v6 offset:45088
    ds_read_b64_tr_b16 v[150:151], v6 offset:46624
    v_mfma_f32_32x32x16_bf16 v[80:95], v[160:163], v[140:143], v[80:95]
    ds_read_b64_tr_b16 v[152:153], v4 offset:45120
    ds_read_b64_tr_b16 v[154:155], v4 offset:46656
    v_mfma_f32_32x32x16_bf16 v[96:111], v[164:167], v[136:139], v[96:111]
    v_mfma_f32_32x32x16_bf16 v[112:127], v[164:167], v[140:143], v[112:127]
    s_waitcnt lgkmcnt(4)
    v_mfma_f32_16x16x32_bf16 v[20:23], v[144:147], v[12:15], v[20:23]
    v_mfma_f32_32x32x16_bf16 v[32:47], v[144:147], v[128:131], v[32:47]
    ds_read_b128 v[136:139], v7 offset:25600
    ds_read_b64_tr_b16 v[156:157], v4 offset:51200
    v_mfma_f32_32x32x16_bf16 v[48:63], v[144:147], v[132:135], v[48:63]
    ds_read_b64_tr_b16 v[158:159], v4 offset:52736
    ds_read_b128 v[140:143], v7 offset:27648
    s_waitcnt lgkmcnt(6)
    v_mfma_f32_16x16x32_bf16 v[24:27], v[148:151], v[12:15], v[24:27]
    v_mfma_f32_32x32x16_bf16 v[64:79], v[148:151], v[128:131], v[64:79]
    ds_read_b64_tr_b16 v[160:161], v6 offset:51232
    ds_read_b64_tr_b16 v[162:163], v6 offset:52768
    v_mfma_f32_32x32x16_bf16 v[80:95], v[148:151], v[132:135], v[80:95]
    ds_read_b64_tr_b16 v[164:165], v4 offset:51264
    ds_read_b64_tr_b16 v[166:167], v4 offset:52800
    s_waitcnt lgkmcnt(8)
    v_mfma_f32_16x16x32_bf16 v[28:31], v[152:155], v[12:15], v[28:31]
    v_mfma_f32_32x32x16_bf16 v[96:111], v[152:155], v[128:131], v[96:111]
    v_mfma_f32_32x32x16_bf16 v[112:127], v[152:155], v[132:135], v[112:127]
    s_waitcnt lgkmcnt(0)
    s_barrier
    v_mfma_f32_32x32x16_bf16 v[32:47], v[156:159], v[136:139], v[32:47]
    ds_read_b128 v[128:131], v7 offset:32768
    ds_read_b64_tr_b16 v[144:145], v3 offset:0
    v_mfma_f32_32x32x16_bf16 v[48:63], v[156:159], v[140:143], v[48:63]
    ds_read_b64_tr_b16 v[146:147], v3 offset:1536
    ds_read_b128 v[132:135], v7 offset:34816
    v_mfma_f32_32x32x16_bf16 v[64:79], v[160:163], v[136:139], v[64:79]
    ds_read_b64_tr_b16 v[148:149], v5 offset:32
    ds_read_b64_tr_b16 v[150:151], v5 offset:1568
    v_mfma_f32_32x32x16_bf16 v[80:95], v[160:163], v[140:143], v[80:95]
    ds_read_b64_tr_b16 v[152:153], v3 offset:64
    ds_read_b64_tr_b16 v[154:155], v3 offset:1600
    v_mfma_f32_32x32x16_bf16 v[96:111], v[164:167], v[136:139], v[96:111]
    v_mfma_f32_32x32x16_bf16 v[112:127], v[164:167], v[140:143], v[112:127]
    s_waitcnt lgkmcnt(4)
    v_mfma_f32_16x16x32_bf16 v[20:23], v[144:147], v[12:15], v[20:23]
    v_mfma_f32_32x32x16_bf16 v[32:47], v[144:147], v[128:131], v[32:47]
    ds_read_b128 v[136:139], v7 offset:33792
    ds_read_b64_tr_b16 v[156:157], v3 offset:6144
    v_mfma_f32_32x32x16_bf16 v[48:63], v[144:147], v[132:135], v[48:63]
    ds_read_b64_tr_b16 v[158:159], v3 offset:7680
    ds_read_b128 v[140:143], v7 offset:35840
    s_waitcnt lgkmcnt(6)
    v_mfma_f32_16x16x32_bf16 v[24:27], v[148:151], v[12:15], v[24:27]
    v_mfma_f32_32x32x16_bf16 v[64:79], v[148:151], v[128:131], v[64:79]
    ds_read_b64_tr_b16 v[160:161], v5 offset:6176
    ds_read_b64_tr_b16 v[162:163], v5 offset:7712
    v_mfma_f32_32x32x16_bf16 v[80:95], v[148:151], v[132:135], v[80:95]
    ds_read_b64_tr_b16 v[164:165], v3 offset:6208
    ds_read_b64_tr_b16 v[166:167], v3 offset:7744
    s_waitcnt lgkmcnt(8)
    v_mfma_f32_16x16x32_bf16 v[28:31], v[152:155], v[12:15], v[28:31]
    v_mfma_f32_32x32x16_bf16 v[96:111], v[152:155], v[128:131], v[96:111]
    v_mfma_f32_32x32x16_bf16 v[112:127], v[152:155], v[132:135], v[112:127]
    s_waitcnt lgkmcnt(0)
    s_barrier
    v_mfma_f32_32x32x16_bf16 v[32:47], v[156:159], v[136:139], v[32:47]
    ds_read_b128 v[128:131], v7 offset:0
    ds_read_b64_tr_b16 v[144:145], v3 offset:12288
    v_mfma_f32_32x32x16_bf16 v[48:63], v[156:159], v[140:143], v[48:63]
    ds_read_b64_tr_b16 v[146:147], v3 offset:13824
    ds_read_b128 v[132:135], v7 offset:2048
    v_mfma_f32_32x32x16_bf16 v[64:79], v[160:163], v[136:139], v[64:79]
    ds_read_b64_tr_b16 v[148:149], v5 offset:12320
    ds_read_b64_tr_b16 v[150:151], v5 offset:13856
    v_mfma_f32_32x32x16_bf16 v[80:95], v[160:163], v[140:143], v[80:95]
    ds_read_b64_tr_b16 v[152:153], v3 offset:12352
    ds_read_b64_tr_b16 v[154:155], v3 offset:13888
    v_mfma_f32_32x32x16_bf16 v[96:111], v[164:167], v[136:139], v[96:111]
    v_mfma_f32_32x32x16_bf16 v[112:127], v[164:167], v[140:143], v[112:127]
    s_waitcnt lgkmcnt(4)
    v_mfma_f32_16x16x32_bf16 v[20:23], v[144:147], v[12:15], v[20:23]
    v_mfma_f32_32x32x16_bf16 v[32:47], v[144:147], v[128:131], v[32:47]
    ds_read_b128 v[136:139], v7 offset:1024
    ds_read_b64_tr_b16 v[156:157], v3 offset:18432
    v_mfma_f32_32x32x16_bf16 v[48:63], v[144:147], v[132:135], v[48:63]
    ds_read_b64_tr_b16 v[158:159], v3 offset:19968
    ds_read_b128 v[140:143], v7 offset:3072
    s_waitcnt lgkmcnt(6)
    v_mfma_f32_16x16x32_bf16 v[24:27], v[148:151], v[12:15], v[24:27]
    v_mfma_f32_32x32x16_bf16 v[64:79], v[148:151], v[128:131], v[64:79]
    ds_read_b64_tr_b16 v[160:161], v5 offset:18464
    ds_read_b64_tr_b16 v[162:163], v5 offset:20000
    v_mfma_f32_32x32x16_bf16 v[80:95], v[148:151], v[132:135], v[80:95]
    ds_read_b64_tr_b16 v[164:165], v3 offset:18496
    ds_read_b64_tr_b16 v[166:167], v3 offset:20032
    s_waitcnt lgkmcnt(8)
    v_mfma_f32_16x16x32_bf16 v[28:31], v[152:155], v[12:15], v[28:31]
    v_mfma_f32_32x32x16_bf16 v[96:111], v[152:155], v[128:131], v[96:111]
    v_mfma_f32_32x32x16_bf16 v[112:127], v[152:155], v[132:135], v[112:127]
    s_waitcnt lgkmcnt(0)
    s_barrier
    v_mfma_f32_32x32x16_bf16 v[32:47], v[156:159], v[136:139], v[32:47]
    ds_read_b128 v[128:131], v7 offset:8192
    ds_read_b64_tr_b16 v[144:145], v3 offset:57344
    v_mfma_f32_32x32x16_bf16 v[48:63], v[156:159], v[140:143], v[48:63]
    ds_read_b64_tr_b16 v[146:147], v3 offset:58880
    ds_read_b128 v[132:135], v7 offset:10240
    v_mfma_f32_32x32x16_bf16 v[64:79], v[160:163], v[136:139], v[64:79]
    ds_read_b64_tr_b16 v[148:149], v5 offset:57376
    ds_read_b64_tr_b16 v[150:151], v5 offset:58912
    v_mfma_f32_32x32x16_bf16 v[80:95], v[160:163], v[140:143], v[80:95]
    ds_read_b64_tr_b16 v[152:153], v3 offset:57408
    ds_read_b64_tr_b16 v[154:155], v3 offset:58944
    v_mfma_f32_32x32x16_bf16 v[96:111], v[164:167], v[136:139], v[96:111]
    v_mfma_f32_32x32x16_bf16 v[112:127], v[164:167], v[140:143], v[112:127]
    s_waitcnt lgkmcnt(4)
    v_mfma_f32_16x16x32_bf16 v[20:23], v[144:147], v[12:15], v[20:23]
    v_mfma_f32_32x32x16_bf16 v[32:47], v[144:147], v[128:131], v[32:47]
    ds_read_b128 v[136:139], v7 offset:9216
    ds_read_b64_tr_b16 v[156:157], v3 offset:63488
    v_mfma_f32_32x32x16_bf16 v[48:63], v[144:147], v[132:135], v[48:63]
    ds_read_b64_tr_b16 v[158:159], v3 offset:65024
    ds_read_b128 v[140:143], v7 offset:11264
    s_waitcnt lgkmcnt(6)
    v_mfma_f32_16x16x32_bf16 v[24:27], v[148:151], v[12:15], v[24:27]
    v_mfma_f32_32x32x16_bf16 v[64:79], v[148:151], v[128:131], v[64:79]
    ds_read_b64_tr_b16 v[160:161], v5 offset:63520
    ds_read_b64_tr_b16 v[162:163], v5 offset:65056
    v_mfma_f32_32x32x16_bf16 v[80:95], v[148:151], v[132:135], v[80:95]
    ds_read_b64_tr_b16 v[164:165], v3 offset:63552
    ds_read_b64_tr_b16 v[166:167], v3 offset:65088
    s_waitcnt lgkmcnt(8)
    v_mfma_f32_16x16x32_bf16 v[28:31], v[152:155], v[12:15], v[28:31]
    v_mfma_f32_32x32x16_bf16 v[96:111], v[152:155], v[128:131], v[96:111]
    v_mfma_f32_32x32x16_bf16 v[112:127], v[152:155], v[132:135], v[112:127]
    s_waitcnt lgkmcnt(0)
    s_barrier
    v_mfma_f32_32x32x16_bf16 v[32:47], v[156:159], v[136:139], v[32:47]
    ds_read_b128 v[128:131], v7 offset:16384
    ds_read_b64_tr_b16 v[144:145], v4 offset:4096
    v_mfma_f32_32x32x16_bf16 v[48:63], v[156:159], v[140:143], v[48:63]
    ds_read_b64_tr_b16 v[146:147], v4 offset:5632
    ds_read_b128 v[132:135], v7 offset:18432
    v_mfma_f32_32x32x16_bf16 v[64:79], v[160:163], v[136:139], v[64:79]
    ds_read_b64_tr_b16 v[148:149], v6 offset:4128
    ds_read_b64_tr_b16 v[150:151], v6 offset:5664
    v_mfma_f32_32x32x16_bf16 v[80:95], v[160:163], v[140:143], v[80:95]
    ds_read_b64_tr_b16 v[152:153], v4 offset:4160
    ds_read_b64_tr_b16 v[154:155], v4 offset:5696
    v_mfma_f32_32x32x16_bf16 v[96:111], v[164:167], v[136:139], v[96:111]
    v_mfma_f32_32x32x16_bf16 v[112:127], v[164:167], v[140:143], v[112:127]
    s_waitcnt lgkmcnt(4)
    v_mfma_f32_16x16x32_bf16 v[20:23], v[144:147], v[12:15], v[20:23]
    v_mfma_f32_32x32x16_bf16 v[32:47], v[144:147], v[128:131], v[32:47]
    ds_read_b128 v[136:139], v7 offset:17408
    ds_read_b64_tr_b16 v[156:157], v4 offset:10240
    v_mfma_f32_32x32x16_bf16 v[48:63], v[144:147], v[132:135], v[48:63]
    ds_read_b64_tr_b16 v[158:159], v4 offset:11776
    ds_read_b128 v[140:143], v7 offset:19456
    s_waitcnt lgkmcnt(6)
    v_mfma_f32_16x16x32_bf16 v[24:27], v[148:151], v[12:15], v[24:27]
    v_mfma_f32_32x32x16_bf16 v[64:79], v[148:151], v[128:131], v[64:79]
    ds_read_b64_tr_b16 v[160:161], v6 offset:10272
    ds_read_b64_tr_b16 v[162:163], v6 offset:11808
    v_mfma_f32_32x32x16_bf16 v[80:95], v[148:151], v[132:135], v[80:95]
    ds_read_b64_tr_b16 v[164:165], v4 offset:10304
    ds_read_b64_tr_b16 v[166:167], v4 offset:11840
    s_waitcnt lgkmcnt(8)
    v_mfma_f32_16x16x32_bf16 v[28:31], v[152:155], v[12:15], v[28:31]
    v_mfma_f32_32x32x16_bf16 v[96:111], v[152:155], v[128:131], v[96:111]
    v_mfma_f32_32x32x16_bf16 v[112:127], v[152:155], v[132:135], v[112:127]
    s_waitcnt lgkmcnt(0)
    s_barrier
    v_mfma_f32_32x32x16_bf16 v[32:47], v[156:159], v[136:139], v[32:47]
    ds_read_b128 v[128:131], v7 offset:24576
    ds_read_b64_tr_b16 v[144:145], v4 offset:16384
    v_mfma_f32_32x32x16_bf16 v[48:63], v[156:159], v[140:143], v[48:63]
    ds_read_b64_tr_b16 v[146:147], v4 offset:17920
    ds_read_b128 v[132:135], v7 offset:26624
    v_mfma_f32_32x32x16_bf16 v[64:79], v[160:163], v[136:139], v[64:79]
    ds_read_b64_tr_b16 v[148:149], v6 offset:16416
    ds_read_b64_tr_b16 v[150:151], v6 offset:17952
    v_mfma_f32_32x32x16_bf16 v[80:95], v[160:163], v[140:143], v[80:95]
    ds_read_b64_tr_b16 v[152:153], v4 offset:16448
    ds_read_b64_tr_b16 v[154:155], v4 offset:17984
    v_mfma_f32_32x32x16_bf16 v[96:111], v[164:167], v[136:139], v[96:111]
    v_mfma_f32_32x32x16_bf16 v[112:127], v[164:167], v[140:143], v[112:127]
    s_waitcnt lgkmcnt(4)
    v_mfma_f32_16x16x32_bf16 v[20:23], v[144:147], v[12:15], v[20:23]
    v_mfma_f32_32x32x16_bf16 v[32:47], v[144:147], v[128:131], v[32:47]
    ds_read_b128 v[136:139], v7 offset:25600
    ds_read_b64_tr_b16 v[156:157], v4 offset:22528
    v_mfma_f32_32x32x16_bf16 v[48:63], v[144:147], v[132:135], v[48:63]
    ds_read_b64_tr_b16 v[158:159], v4 offset:24064
    ds_read_b128 v[140:143], v7 offset:27648
    s_waitcnt lgkmcnt(6)
    v_mfma_f32_16x16x32_bf16 v[24:27], v[148:151], v[12:15], v[24:27]
    v_mfma_f32_32x32x16_bf16 v[64:79], v[148:151], v[128:131], v[64:79]
    ds_read_b64_tr_b16 v[160:161], v6 offset:22560
    ds_read_b64_tr_b16 v[162:163], v6 offset:24096
    v_mfma_f32_32x32x16_bf16 v[80:95], v[148:151], v[132:135], v[80:95]
    ds_read_b64_tr_b16 v[164:165], v4 offset:22592
    ds_read_b64_tr_b16 v[166:167], v4 offset:24128
    s_waitcnt lgkmcnt(8)
    v_mfma_f32_16x16x32_bf16 v[28:31], v[152:155], v[12:15], v[28:31]
    v_mfma_f32_32x32x16_bf16 v[96:111], v[152:155], v[128:131], v[96:111]
    v_mfma_f32_32x32x16_bf16 v[112:127], v[152:155], v[132:135], v[112:127]
    s_waitcnt lgkmcnt(0)
    s_barrier
    v_mfma_f32_32x32x16_bf16 v[32:47], v[156:159], v[136:139], v[32:47]
    ds_read_b128 v[128:131], v7 offset:32768
    ds_read_b64_tr_b16 v[144:145], v3 offset:32768
    v_mfma_f32_32x32x16_bf16 v[48:63], v[156:159], v[140:143], v[48:63]
    ds_read_b64_tr_b16 v[146:147], v3 offset:34304
    ds_read_b128 v[132:135], v7 offset:34816
    v_mfma_f32_32x32x16_bf16 v[64:79], v[160:163], v[136:139], v[64:79]
    ds_read_b64_tr_b16 v[148:149], v5 offset:32800
    ds_read_b64_tr_b16 v[150:151], v5 offset:34336
    v_mfma_f32_32x32x16_bf16 v[80:95], v[160:163], v[140:143], v[80:95]
    ds_read_b64_tr_b16 v[152:153], v3 offset:32832
    ds_read_b64_tr_b16 v[154:155], v3 offset:34368
    v_mfma_f32_32x32x16_bf16 v[96:111], v[164:167], v[136:139], v[96:111]
    v_mfma_f32_32x32x16_bf16 v[112:127], v[164:167], v[140:143], v[112:127]
    s_waitcnt lgkmcnt(4)
    v_mfma_f32_16x16x32_bf16 v[20:23], v[144:147], v[12:15], v[20:23]
    v_mfma_f32_32x32x16_bf16 v[32:47], v[144:147], v[128:131], v[32:47]
    ds_read_b128 v[136:139], v7 offset:33792
    ds_read_b64_tr_b16 v[156:157], v3 offset:38912
    v_mfma_f32_32x32x16_bf16 v[48:63], v[144:147], v[132:135], v[48:63]
    ds_read_b64_tr_b16 v[158:159], v3 offset:40448
    ds_read_b128 v[140:143], v7 offset:35840
    s_waitcnt lgkmcnt(6)
    v_mfma_f32_16x16x32_bf16 v[24:27], v[148:151], v[12:15], v[24:27]
    v_mfma_f32_32x32x16_bf16 v[64:79], v[148:151], v[128:131], v[64:79]
    ds_read_b64_tr_b16 v[160:161], v5 offset:38944
    ds_read_b64_tr_b16 v[162:163], v5 offset:40480
    v_mfma_f32_32x32x16_bf16 v[80:95], v[148:151], v[132:135], v[80:95]
    ds_read_b64_tr_b16 v[164:165], v3 offset:38976
    ds_read_b64_tr_b16 v[166:167], v3 offset:40512
    s_waitcnt lgkmcnt(8)
    v_mfma_f32_16x16x32_bf16 v[28:31], v[152:155], v[12:15], v[28:31]
    v_mfma_f32_32x32x16_bf16 v[96:111], v[152:155], v[128:131], v[96:111]
    v_mfma_f32_32x32x16_bf16 v[112:127], v[152:155], v[132:135], v[112:127]
    s_waitcnt lgkmcnt(0)
    s_barrier
    v_mfma_f32_32x32x16_bf16 v[32:47], v[156:159], v[136:139], v[32:47]
    ds_read_b128 v[128:131], v7 offset:0
    ds_read_b64_tr_b16 v[144:145], v3 offset:45056
    v_mfma_f32_32x32x16_bf16 v[48:63], v[156:159], v[140:143], v[48:63]
    ds_read_b64_tr_b16 v[146:147], v3 offset:46592
    ds_read_b128 v[132:135], v7 offset:2048
    v_mfma_f32_32x32x16_bf16 v[64:79], v[160:163], v[136:139], v[64:79]
    ds_read_b64_tr_b16 v[148:149], v5 offset:45088
    ds_read_b64_tr_b16 v[150:151], v5 offset:46624
    v_mfma_f32_32x32x16_bf16 v[80:95], v[160:163], v[140:143], v[80:95]
    ds_read_b64_tr_b16 v[152:153], v3 offset:45120
    ds_read_b64_tr_b16 v[154:155], v3 offset:46656
    v_mfma_f32_32x32x16_bf16 v[96:111], v[164:167], v[136:139], v[96:111]
    v_mfma_f32_32x32x16_bf16 v[112:127], v[164:167], v[140:143], v[112:127]
    s_waitcnt lgkmcnt(4)
    v_mfma_f32_16x16x32_bf16 v[20:23], v[144:147], v[12:15], v[20:23]
    v_mfma_f32_32x32x16_bf16 v[32:47], v[144:147], v[128:131], v[32:47]
    ds_read_b128 v[136:139], v7 offset:1024
    ds_read_b64_tr_b16 v[156:157], v3 offset:51200
    v_mfma_f32_32x32x16_bf16 v[48:63], v[144:147], v[132:135], v[48:63]
    ds_read_b64_tr_b16 v[158:159], v3 offset:52736
    ds_read_b128 v[140:143], v7 offset:3072
    s_waitcnt lgkmcnt(6)
    v_mfma_f32_16x16x32_bf16 v[24:27], v[148:151], v[12:15], v[24:27]
    v_mfma_f32_32x32x16_bf16 v[64:79], v[148:151], v[128:131], v[64:79]
    ds_read_b64_tr_b16 v[160:161], v5 offset:51232
    ds_read_b64_tr_b16 v[162:163], v5 offset:52768
    v_mfma_f32_32x32x16_bf16 v[80:95], v[148:151], v[132:135], v[80:95]
    ds_read_b64_tr_b16 v[164:165], v3 offset:51264
    ds_read_b64_tr_b16 v[166:167], v3 offset:52800
    s_waitcnt lgkmcnt(8)
    v_mfma_f32_16x16x32_bf16 v[28:31], v[152:155], v[12:15], v[28:31]
    v_mfma_f32_32x32x16_bf16 v[96:111], v[152:155], v[128:131], v[96:111]
    v_mfma_f32_32x32x16_bf16 v[112:127], v[152:155], v[132:135], v[112:127]
    s_waitcnt lgkmcnt(0)
    s_barrier
    v_mfma_f32_32x32x16_bf16 v[32:47], v[156:159], v[136:139], v[32:47]
    ds_read_b128 v[128:131], v7 offset:8192
    ds_read_b64_tr_b16 v[144:145], v4 offset:32768
    v_mfma_f32_32x32x16_bf16 v[48:63], v[156:159], v[140:143], v[48:63]
    ds_read_b64_tr_b16 v[146:147], v4 offset:34304
    ds_read_b128 v[132:135], v7 offset:10240
    v_mfma_f32_32x32x16_bf16 v[64:79], v[160:163], v[136:139], v[64:79]
    ds_read_b64_tr_b16 v[148:149], v6 offset:32800
    ds_read_b64_tr_b16 v[150:151], v6 offset:34336
    v_mfma_f32_32x32x16_bf16 v[80:95], v[160:163], v[140:143], v[80:95]
    ds_read_b64_tr_b16 v[152:153], v4 offset:32832
    ds_read_b64_tr_b16 v[154:155], v4 offset:34368
    v_mfma_f32_32x32x16_bf16 v[96:111], v[164:167], v[136:139], v[96:111]
    v_mfma_f32_32x32x16_bf16 v[112:127], v[164:167], v[140:143], v[112:127]
    s_waitcnt lgkmcnt(4)
    v_mfma_f32_16x16x32_bf16 v[20:23], v[144:147], v[12:15], v[20:23]
    v_mfma_f32_32x32x16_bf16 v[32:47], v[144:147], v[128:131], v[32:47]
    ds_read_b128 v[136:139], v7 offset:9216
    ds_read_b64_tr_b16 v[156:157], v4 offset:38912
    v_mfma_f32_32x32x16_bf16 v[48:63], v[144:147], v[132:135], v[48:63]
    ds_read_b64_tr_b16 v[158:159], v4 offset:40448
    ds_read_b128 v[140:143], v7 offset:11264
    s_waitcnt lgkmcnt(6)
    v_mfma_f32_16x16x32_bf16 v[24:27], v[148:151], v[12:15], v[24:27]
    v_mfma_f32_32x32x16_bf16 v[64:79], v[148:151], v[128:131], v[64:79]
    ds_read_b64_tr_b16 v[160:161], v6 offset:38944
    ds_read_b64_tr_b16 v[162:163], v6 offset:40480
    v_mfma_f32_32x32x16_bf16 v[80:95], v[148:151], v[132:135], v[80:95]
    ds_read_b64_tr_b16 v[164:165], v4 offset:38976
    ds_read_b64_tr_b16 v[166:167], v4 offset:40512
    s_waitcnt lgkmcnt(8)
    v_mfma_f32_16x16x32_bf16 v[28:31], v[152:155], v[12:15], v[28:31]
    v_mfma_f32_32x32x16_bf16 v[96:111], v[152:155], v[128:131], v[96:111]
    v_mfma_f32_32x32x16_bf16 v[112:127], v[152:155], v[132:135], v[112:127]
    s_waitcnt lgkmcnt(0)
    s_barrier
    v_mfma_f32_32x32x16_bf16 v[32:47], v[156:159], v[136:139], v[32:47]
    ds_read_b128 v[128:131], v7 offset:16384
    ds_read_b64_tr_b16 v[144:145], v4 offset:45056
    v_mfma_f32_32x32x16_bf16 v[48:63], v[156:159], v[140:143], v[48:63]
    ds_read_b64_tr_b16 v[146:147], v4 offset:46592
    ds_read_b128 v[132:135], v7 offset:18432
    v_mfma_f32_32x32x16_bf16 v[64:79], v[160:163], v[136:139], v[64:79]
    ds_read_b64_tr_b16 v[148:149], v6 offset:45088
    ds_read_b64_tr_b16 v[150:151], v6 offset:46624
    v_mfma_f32_32x32x16_bf16 v[80:95], v[160:163], v[140:143], v[80:95]
    ds_read_b64_tr_b16 v[152:153], v4 offset:45120
    ds_read_b64_tr_b16 v[154:155], v4 offset:46656
    v_mfma_f32_32x32x16_bf16 v[96:111], v[164:167], v[136:139], v[96:111]
    v_mfma_f32_32x32x16_bf16 v[112:127], v[164:167], v[140:143], v[112:127]
    s_waitcnt lgkmcnt(4)
    v_mfma_f32_16x16x32_bf16 v[20:23], v[144:147], v[12:15], v[20:23]
    v_mfma_f32_32x32x16_bf16 v[32:47], v[144:147], v[128:131], v[32:47]
    ds_read_b128 v[136:139], v7 offset:17408
    ds_read_b64_tr_b16 v[156:157], v4 offset:51200
    v_mfma_f32_32x32x16_bf16 v[48:63], v[144:147], v[132:135], v[48:63]
    ds_read_b64_tr_b16 v[158:159], v4 offset:52736
    ds_read_b128 v[140:143], v7 offset:19456
    s_waitcnt lgkmcnt(6)
    v_mfma_f32_16x16x32_bf16 v[24:27], v[148:151], v[12:15], v[24:27]
    v_mfma_f32_32x32x16_bf16 v[64:79], v[148:151], v[128:131], v[64:79]
    ds_read_b64_tr_b16 v[160:161], v6 offset:51232
    ds_read_b64_tr_b16 v[162:163], v6 offset:52768
    v_mfma_f32_32x32x16_bf16 v[80:95], v[148:151], v[132:135], v[80:95]
    ds_read_b64_tr_b16 v[164:165], v4 offset:51264
    ds_read_b64_tr_b16 v[166:167], v4 offset:52800
    s_waitcnt lgkmcnt(8)
    v_mfma_f32_16x16x32_bf16 v[28:31], v[152:155], v[12:15], v[28:31]
    v_mfma_f32_32x32x16_bf16 v[96:111], v[152:155], v[128:131], v[96:111]
    v_mfma_f32_32x32x16_bf16 v[112:127], v[152:155], v[132:135], v[112:127]
    s_waitcnt lgkmcnt(0)
    s_barrier
    v_mfma_f32_32x32x16_bf16 v[32:47], v[156:159], v[136:139], v[32:47]
    ds_read_b128 v[128:131], v7 offset:24576
    ds_read_b64_tr_b16 v[144:145], v3 offset:0
    v_mfma_f32_32x32x16_bf16 v[48:63], v[156:159], v[140:143], v[48:63]
    ds_read_b64_tr_b16 v[146:147], v3 offset:1536
    ds_read_b128 v[132:135], v7 offset:26624
    v_mfma_f32_32x32x16_bf16 v[64:79], v[160:163], v[136:139], v[64:79]
    ds_read_b64_tr_b16 v[148:149], v5 offset:32
    ds_read_b64_tr_b16 v[150:151], v5 offset:1568
    v_mfma_f32_32x32x16_bf16 v[80:95], v[160:163], v[140:143], v[80:95]
    ds_read_b64_tr_b16 v[152:153], v3 offset:64
    ds_read_b64_tr_b16 v[154:155], v3 offset:1600
    v_mfma_f32_32x32x16_bf16 v[96:111], v[164:167], v[136:139], v[96:111]
    v_mfma_f32_32x32x16_bf16 v[112:127], v[164:167], v[140:143], v[112:127]
    s_waitcnt lgkmcnt(4)
    v_mfma_f32_16x16x32_bf16 v[20:23], v[144:147], v[12:15], v[20:23]
    v_mfma_f32_32x32x16_bf16 v[32:47], v[144:147], v[128:131], v[32:47]
    ds_read_b128 v[136:139], v7 offset:25600
    ds_read_b64_tr_b16 v[156:157], v3 offset:6144
    v_mfma_f32_32x32x16_bf16 v[48:63], v[144:147], v[132:135], v[48:63]
    ds_read_b64_tr_b16 v[158:159], v3 offset:7680
    ds_read_b128 v[140:143], v7 offset:27648
    s_waitcnt lgkmcnt(6)
    v_mfma_f32_16x16x32_bf16 v[24:27], v[148:151], v[12:15], v[24:27]
    v_mfma_f32_32x32x16_bf16 v[64:79], v[148:151], v[128:131], v[64:79]
    ds_read_b64_tr_b16 v[160:161], v5 offset:6176
    ds_read_b64_tr_b16 v[162:163], v5 offset:7712
    v_mfma_f32_32x32x16_bf16 v[80:95], v[148:151], v[132:135], v[80:95]
    ds_read_b64_tr_b16 v[164:165], v3 offset:6208
    ds_read_b64_tr_b16 v[166:167], v3 offset:7744
    s_waitcnt lgkmcnt(8)
    v_mfma_f32_16x16x32_bf16 v[28:31], v[152:155], v[12:15], v[28:31]
    v_mfma_f32_32x32x16_bf16 v[96:111], v[152:155], v[128:131], v[96:111]
    v_mfma_f32_32x32x16_bf16 v[112:127], v[152:155], v[132:135], v[112:127]
    s_waitcnt lgkmcnt(0)
    s_barrier
    v_mfma_f32_32x32x16_bf16 v[32:47], v[156:159], v[136:139], v[32:47]
    ds_read_b128 v[128:131], v7 offset:32768
    ds_read_b64_tr_b16 v[144:145], v3 offset:12288
    v_mfma_f32_32x32x16_bf16 v[48:63], v[156:159], v[140:143], v[48:63]
    ds_read_b64_tr_b16 v[146:147], v3 offset:13824
    ds_read_b128 v[132:135], v7 offset:34816
    v_mfma_f32_32x32x16_bf16 v[64:79], v[160:163], v[136:139], v[64:79]
    ds_read_b64_tr_b16 v[148:149], v5 offset:12320
    ds_read_b64_tr_b16 v[150:151], v5 offset:13856
    v_mfma_f32_32x32x16_bf16 v[80:95], v[160:163], v[140:143], v[80:95]
    ds_read_b64_tr_b16 v[152:153], v3 offset:12352
    ds_read_b64_tr_b16 v[154:155], v3 offset:13888
    v_mfma_f32_32x32x16_bf16 v[96:111], v[164:167], v[136:139], v[96:111]
    v_mfma_f32_32x32x16_bf16 v[112:127], v[164:167], v[140:143], v[112:127]
    s_waitcnt lgkmcnt(4)
    v_mfma_f32_16x16x32_bf16 v[20:23], v[144:147], v[12:15], v[20:23]
    v_mfma_f32_32x32x16_bf16 v[32:47], v[144:147], v[128:131], v[32:47]
    ds_read_b128 v[136:139], v7 offset:33792
    ds_read_b64_tr_b16 v[156:157], v3 offset:18432
    v_mfma_f32_32x32x16_bf16 v[48:63], v[144:147], v[132:135], v[48:63]
    ds_read_b64_tr_b16 v[158:159], v3 offset:19968
    ds_read_b128 v[140:143], v7 offset:35840
    s_waitcnt lgkmcnt(6)
    v_mfma_f32_16x16x32_bf16 v[24:27], v[148:151], v[12:15], v[24:27]
    v_mfma_f32_32x32x16_bf16 v[64:79], v[148:151], v[128:131], v[64:79]
    ds_read_b64_tr_b16 v[160:161], v5 offset:18464
    ds_read_b64_tr_b16 v[162:163], v5 offset:20000
    v_mfma_f32_32x32x16_bf16 v[80:95], v[148:151], v[132:135], v[80:95]
    ds_read_b64_tr_b16 v[164:165], v3 offset:18496
    ds_read_b64_tr_b16 v[166:167], v3 offset:20032
    s_waitcnt lgkmcnt(8)
    v_mfma_f32_16x16x32_bf16 v[28:31], v[152:155], v[12:15], v[28:31]
    v_mfma_f32_32x32x16_bf16 v[96:111], v[152:155], v[128:131], v[96:111]
    v_mfma_f32_32x32x16_bf16 v[112:127], v[152:155], v[132:135], v[112:127]
    s_waitcnt lgkmcnt(0)
    s_barrier
    v_mfma_f32_32x32x16_bf16 v[32:47], v[156:159], v[136:139], v[32:47]
    ds_read_b128 v[128:131], v7 offset:0
    ds_read_b64_tr_b16 v[144:145], v3 offset:57344
    v_mfma_f32_32x32x16_bf16 v[48:63], v[156:159], v[140:143], v[48:63]
    ds_read_b64_tr_b16 v[146:147], v3 offset:58880
    ds_read_b128 v[132:135], v7 offset:2048
    v_mfma_f32_32x32x16_bf16 v[64:79], v[160:163], v[136:139], v[64:79]
    ds_read_b64_tr_b16 v[148:149], v5 offset:57376
    ds_read_b64_tr_b16 v[150:151], v5 offset:58912
    v_mfma_f32_32x32x16_bf16 v[80:95], v[160:163], v[140:143], v[80:95]
    ds_read_b64_tr_b16 v[152:153], v3 offset:57408
    ds_read_b64_tr_b16 v[154:155], v3 offset:58944
    v_mfma_f32_32x32x16_bf16 v[96:111], v[164:167], v[136:139], v[96:111]
    v_mfma_f32_32x32x16_bf16 v[112:127], v[164:167], v[140:143], v[112:127]
    s_waitcnt lgkmcnt(4)
    v_mfma_f32_16x16x32_bf16 v[20:23], v[144:147], v[12:15], v[20:23]
    v_mfma_f32_32x32x16_bf16 v[32:47], v[144:147], v[128:131], v[32:47]
    ds_read_b128 v[136:139], v7 offset:1024
    ds_read_b64_tr_b16 v[156:157], v3 offset:63488
    v_mfma_f32_32x32x16_bf16 v[48:63], v[144:147], v[132:135], v[48:63]
    ds_read_b64_tr_b16 v[158:159], v3 offset:65024
    ds_read_b128 v[140:143], v7 offset:3072
    s_waitcnt lgkmcnt(6)
    v_mfma_f32_16x16x32_bf16 v[24:27], v[148:151], v[12:15], v[24:27]
    v_mfma_f32_32x32x16_bf16 v[64:79], v[148:151], v[128:131], v[64:79]
    ds_read_b64_tr_b16 v[160:161], v5 offset:63520
    ds_read_b64_tr_b16 v[162:163], v5 offset:65056
    v_mfma_f32_32x32x16_bf16 v[80:95], v[148:151], v[132:135], v[80:95]
    ds_read_b64_tr_b16 v[164:165], v3 offset:63552
    ds_read_b64_tr_b16 v[166:167], v3 offset:65088
    s_waitcnt lgkmcnt(8)
    v_mfma_f32_16x16x32_bf16 v[28:31], v[152:155], v[12:15], v[28:31]
    v_mfma_f32_32x32x16_bf16 v[96:111], v[152:155], v[128:131], v[96:111]
    v_mfma_f32_32x32x16_bf16 v[112:127], v[152:155], v[132:135], v[112:127]
    s_waitcnt lgkmcnt(0)
L_p4_join:
    v_mfma_f32_32x32x16_bf16 v[32:47], v[156:159], v[136:139], v[32:47]
    v_mov_b32 v146, 0
    v_mov_b32 v147, 0
    v_mov_b32 v150, 0
    v_mov_b32 v151, 0
    v_mov_b32 v154, 0
    v_mov_b32 v155, 0
    v_mfma_f32_32x32x16_bf16 v[48:63], v[156:159], v[140:143], v[48:63]
    s_mov_b32 exec_lo, 0x00030003
    s_mov_b32 exec_hi, 0x00030003
    ds_write_b128 v8, v[20:23] offset:0
    ds_write_b128 v8, v[24:27] offset:128
    ds_write_b128 v8, v[28:31] offset:256
    s_mov_b64 exec, -1
    ds_read_b128 v[128:131], v10 offset:0
    ds_read_b64 v[12:13], v11 offset:1024
    ds_read_b128 v[132:135], v10 offset:1536
    ds_read_b64 v[14:15], v11 offset:2560
    v_mfma_f32_32x32x16_bf16 v[64:79], v[160:163], v[136:139], v[64:79]
    v_mfma_f32_32x32x16_bf16 v[80:95], v[160:163], v[140:143], v[80:95]
    s_waitcnt lgkmcnt(0)
    s_barrier
    ds_read_b32 v17, v9 offset:0
    ds_read_b32 v18, v9 offset:128
    ds_read_b32 v19, v9 offset:256
    v_mfma_f32_32x32x16_bf16 v[96:111], v[164:167], v[136:139], v[96:111]
    v_mfma_f32_32x32x16_bf16 v[112:127], v[164:167], v[140:143], v[112:127]
    s_waitcnt lgkmcnt(2)
    v_cvt_pk_bf16_f32 v145, v17, 0
    v_lshlrev_b32 v16, 16, v145
    v_sub_f32 v16, v17, v16
    v_cvt_pk_bf16_f32 v144, v17, v16
    s_waitcnt lgkmcnt(1)
    v_cvt_pk_bf16_f32 v149, v18, 0
    v_lshlrev_b32 v16, 16, v149
    v_sub_f32 v16, v18, v16
    v_cvt_pk_bf16_f32 v148, v18, v16
    s_waitcnt lgkmcnt(0)
    v_cvt_pk_bf16_f32 v153, v19, 0
    v_lshlrev_b32 v16, 16, v153
    v_sub_f32 v16, v19, v16
    v_cvt_pk_bf16_f32 v152, v19, v16
    v_mfma_f32_32x32x16_bf16 v[32:47], v[144:147], v[128:131], v[32:47]
    v_mfma_f32_32x32x16_bf16 v[48:63], v[144:147], v[132:135], v[48:63]
    v_mfma_f32_32x32x16_bf16 v[64:79], v[148:151], v[128:131], v[64:79]
    v_mfma_f32_32x32x16_bf16 v[80:95], v[148:151], v[132:135], v[80:95]
    v_mfma_f32_32x32x16_bf16 v[96:111], v[152:155], v[128:131], v[96:111]
    v_mfma_f32_32x32x16_bf16 v[112:127], v[152:155], v[132:135], v[112:127]
    v_lshlrev_b32 v16, 7, v1
    v_mov_b32 v17, s53
    s_nop 2
    s_cmp_ge_u32 s38, 86
    s_cbranch_scc1 L_p4_pub
    v_pk_mul_f32 v[32:33], v[32:33], v[12:13] op_sel_hi:[1,0]
    v_pk_mul_f32 v[34:35], v[34:35], v[12:13] op_sel_hi:[1,0]
    v_pk_mul_f32 v[36:37], v[36:37], v[12:13] op_sel_hi:[1,0]
    v_pk_mul_f32 v[38:39], v[38:39], v[12:13] op_sel_hi:[1,0]
    v_pk_mul_f32 v[48:49], v[48:49], v[14:15] op_sel_hi:[1,0]
    v_pk_mul_f32 v[50:51], v[50:51], v[14:15] op_sel_hi:[1,0]
    v_pk_mul_f32 v[52:53], v[52:53], v[14:15] op_sel_hi:[1,0]
    v_pk_mul_f32 v[54:55], v[54:55], v[14:15] op_sel_hi:[1,0]
    v_exp_f32 v32, v32
    v_exp_f32 v33, v33
    v_exp_f32 v34, v34
    v_exp_f32 v35, v35
    v_exp_f32 v36, v36
    v_exp_f32 v37, v37
    v_exp_f32 v38, v38
    v_exp_f32 v39, v39
    v_exp_f32 v48, v48
    v_exp_f32 v49, v49
    v_exp_f32 v50, v50
    v_exp_f32 v51, v51
    v_exp_f32 v52, v52
    v_exp_f32 v53, v53
    v_exp_f32 v54, v54
    v_exp_f32 v55, v55
    v_pk_fma_f32 v[32:33], v[32:33], v[12:13], v[12:13] op_sel:[0,1,1] op_sel_hi:[1,1,1]
    v_pk_fma_f32 v[34:35], v[34:35], v[12:13], v[12:13] op_sel:[0,1,1] op_sel_hi:[1,1,1]
    v_pk_fma_f32 v[36:37], v[36:37], v[12:13], v[12:13] op_sel:[0,1,1] op_sel_hi:[1,1,1]
    v_pk_fma_f32 v[38:39], v[38:39], v[12:13], v[12:13] op_sel:[0,1,1] op_sel_hi:[1,1,1]
    v_pk_fma_f32 v[48:49], v[48:49], v[14:15], v[14:15] op_sel:[0,1,1] op_sel_hi:[1,1,1]
    v_pk_fma_f32 v[50:51], v[50:51], v[14:15], v[14:15] op_sel:[0,1,1] op_sel_hi:[1,1,1]
    v_pk_fma_f32 v[52:53], v[52:53], v[14:15], v[14:15] op_sel:[0,1,1] op_sel_hi:[1,1,1]
    v_pk_fma_f32 v[54:55], v[54:55], v[14:15], v[14:15] op_sel:[0,1,1] op_sel_hi:[1,1,1]
    v_rcp_f32 v32, v32
    v_rcp_f32 v33, v33
    v_rcp_f32 v34, v34
    v_rcp_f32 v35, v35
    v_rcp_f32 v36, v36
    v_rcp_f32 v37, v37
    v_rcp_f32 v38, v38
    v_rcp_f32 v39, v39
    v_rcp_f32 v48, v48
    v_rcp_f32 v49, v49
    v_rcp_f32 v50, v50
    v_rcp_f32 v51, v51
    v_rcp_f32 v52, v52
    v_rcp_f32 v53, v53
    v_rcp_f32 v54, v54
    v_rcp_f32 v55, v55
    v_pk_mul_f32 v[32:33], v[32:33], v[40:41]
    v_pk_mul_f32 v[34:35], v[34:35], v[42:43]
    v_pk_mul_f32 v[36:37], v[36:37], v[44:45]
    v_pk_mul_f32 v[38:39], v[38:39], v[46:47]
    v_pk_mul_f32 v[48:49], v[48:49], v[56:57]
    v_pk_mul_f32 v[50:51], v[50:51], v[58:59]
    v_pk_mul_f32 v[52:53], v[52:53], v[60:61]
    v_pk_mul_f32 v[54:55], v[54:55], v[62:63]
    v_cvt_pk_bf16_f32 v40, v32, v33
    v_cvt_pk_bf16_f32 v41, v34, v35
    v_cvt_pk_bf16_f32 v42, v36, v37
    v_cvt_pk_bf16_f32 v43, v38, v39
    v_cvt_pk_bf16_f32 v44, v48, v49
    v_cvt_pk_bf16_f32 v45, v50, v51
    v_cvt_pk_bf16_f32 v46, v52, v53
    v_cvt_pk_bf16_f32 v47, v54, v55
    s_cmp_eq_u32 s54, 0
    s_cbranch_scc1 L_st_11_s
    buffer_store_dwordx4 v[40:43], v2, s[12:15], s34 offen
    buffer_store_dwordx4 v[44:47], v2, s[12:15], s35 offen
    s_branch L_st_11_j
L_st_11_s:
    buffer_store_dwordx4 v[40:43], v2, s[12:15], s34 offen sc1
    buffer_store_dwordx4 v[44:47], v2, s[12:15], s35 offen sc1
L_st_11_j:
    s_add_u32 s34, s34, 29696
    s_add_u32 s35, s35, 29696
    s_cmp_ge_u32 s38, 85
    s_cbranch_scc1 L_p4_pub
    v_pk_mul_f32 v[64:65], v[64:65], v[12:13] op_sel_hi:[1,0]
    v_pk_mul_f32 v[66:67], v[66:67], v[12:13] op_sel_hi:[1,0]
    v_pk_mul_f32 v[68:69], v[68:69], v[12:13] op_sel_hi:[1,0]
    v_pk_mul_f32 v[70:71], v[70:71], v[12:13] op_sel_hi:[1,0]
    v_pk_mul_f32 v[80:81], v[80:81], v[14:15] op_sel_hi:[1,0]
    v_pk_mul_f32 v[82:83], v[82:83], v[14:15] op_sel_hi:[1,0]
    v_pk_mul_f32 v[84:85], v[84:85], v[14:15] op_sel_hi:[1,0]
    v_pk_mul_f32 v[86:87], v[86:87], v[14:15] op_sel_hi:[1,0]
    v_exp_f32 v64, v64
    v_exp_f32 v65, v65
    v_exp_f32 v66, v66
    v_exp_f32 v67, v67
    v_exp_f32 v68, v68
    v_exp_f32 v69, v69
    v_exp_f32 v70, v70
    v_exp_f32 v71, v71
    v_exp_f32 v80, v80
    v_exp_f32 v81, v81
    v_exp_f32 v82, v82
    v_exp_f32 v83, v83
    v_exp_f32 v84, v84
    v_exp_f32 v85, v85
    v_exp_f32 v86, v86
    v_exp_f32 v87, v87
    v_pk_fma_f32 v[64:65], v[64:65], v[12:13], v[12:13] op_sel:[0,1,1] op_sel_hi:[1,1,1]
    v_pk_fma_f32 v[66:67], v[66:67], v[12:13], v[12:13] op_sel:[0,1,1] op_sel_hi:[1,1,1]
    v_pk_fma_f32 v[68:69], v[68:69], v[12:13], v[12:13] op_sel:[0,1,1] op_sel_hi:[1,1,1]
    v_pk_fma_f32 v[70:71], v[70:71], v[12:13], v[12:13] op_sel:[0,1,1] op_sel_hi:[1,1,1]
    v_pk_fma_f32 v[80:81], v[80:81], v[14:15], v[14:15] op_sel:[0,1,1] op_sel_hi:[1,1,1]
    v_pk_fma_f32 v[82:83], v[82:83], v[14:15], v[14:15] op_sel:[0,1,1] op_sel_hi:[1,1,1]
    v_pk_fma_f32 v[84:85], v[84:85], v[14:15], v[14:15] op_sel:[0,1,1] op_sel_hi:[1,1,1]
    v_pk_fma_f32 v[86:87], v[86:87], v[14:15], v[14:15] op_sel:[0,1,1] op_sel_hi:[1,1,1]
    v_rcp_f32 v64, v64
    v_rcp_f32 v65, v65
    v_rcp_f32 v66, v66
    v_rcp_f32 v67, v67
    v_rcp_f32 v68, v68
    v_rcp_f32 v69, v69
    v_rcp_f32 v70, v70
    v_rcp_f32 v71, v71
    v_rcp_f32 v80, v80
    v_rcp_f32 v81, v81
    v_rcp_f32 v82, v82
    v_rcp_f32 v83, v83
    v_rcp_f32 v84, v84
    v_rcp_f32 v85, v85
    v_rcp_f32 v86, v86
    v_rcp_f32 v87, v87
    v_pk_mul_f32 v[64:65], v[64:65], v[72:73]
    v_pk_mul_f32 v[66:67], v[66:67], v[74:75]
    v_pk_mul_f32 v[68:69], v[68:69], v[76:77]
    v_pk_mul_f32 v[70:71], v[70:71], v[78:79]
    v_pk_mul_f32 v[80:81], v[80:81], v[88:89]
    v_pk_mul_f32 v[82:83], v[82:83], v[90:91]
    v_pk_mul_f32 v[84:85], v[84:85], v[92:93]
    v_pk_mul_f32 v[86:87], v[86:87], v[94:95]
    v_cvt_pk_bf16_f32 v72, v64, v65
    v_cvt_pk_bf16_f32 v73, v66, v67
    v_cvt_pk_bf16_f32 v74, v68, v69
    v_cvt_pk_bf16_f32 v75, v70, v71
    v_cvt_pk_bf16_f32 v76, v80, v81
    v_cvt_pk_bf16_f32 v77, v82, v83
    v_cvt_pk_bf16_f32 v78, v84, v85
    v_cvt_pk_bf16_f32 v79, v86, v87
    s_cmp_eq_u32 s54, 0
    s_cbranch_scc1 L_st_12_s
    buffer_store_dwordx4 v[72:75], v2, s[12:15], s34 offen
    buffer_store_dwordx4 v[76:79], v2, s[12:15], s35 offen
    s_branch L_st_12_j
L_st_12_s:
    buffer_store_dwordx4 v[72:75], v2, s[12:15], s34 offen sc1
    buffer_store_dwordx4 v[76:79], v2, s[12:15], s35 offen sc1
L_st_12_j:
    s_add_u32 s34, s34, 29696
    s_add_u32 s35, s35, 29696
    s_mov_b64 exec, 1
    s_waitcnt vmcnt(2)
    s_cmp_eq_u32 s54, 0
    s_cbranch_scc1 L_st_13_s
    buffer_store_dword v17, v16, s[12:15], s55 offen offset:0
    s_branch L_st_13_j
L_st_13_s:
    buffer_store_dword v17, v16, s[12:15], s55 offen offset:0 sc1
L_st_13_j:
    s_mov_b64 exec, -1
    s_cmp_ge_u32 s38, 84
    s_cbranch_scc1 L_p4_pub
    v_pk_mul_f32 v[96:97], v[96:97], v[12:13] op_sel_hi:[1,0]
    v_pk_mul_f32 v[98:99], v[98:99], v[12:13] op_sel_hi:[1,0]
    v_pk_mul_f32 v[100:101], v[100:101], v[12:13] op_sel_hi:[1,0]
    v_pk_mul_f32 v[102:103], v[102:103], v[12:13] op_sel_hi:[1,0]
    v_pk_mul_f32 v[112:113], v[112:113], v[14:15] op_sel_hi:[1,0]
    v_pk_mul_f32 v[114:115], v[114:115], v[14:15] op_sel_hi:[1,0]
    v_pk_mul_f32 v[116:117], v[116:117], v[14:15] op_sel_hi:[1,0]
    v_pk_mul_f32 v[118:119], v[118:119], v[14:15] op_sel_hi:[1,0]
    v_exp_f32 v96, v96
    v_exp_f32 v97, v97
    v_exp_f32 v98, v98
    v_exp_f32 v99, v99
    v_exp_f32 v100, v100
    v_exp_f32 v101, v101
    v_exp_f32 v102, v102
    v_exp_f32 v103, v103
    v_exp_f32 v112, v112
    v_exp_f32 v113, v113
    v_exp_f32 v114, v114
    v_exp_f32 v115, v115
    v_exp_f32 v116, v116
    v_exp_f32 v117, v117
    v_exp_f32 v118, v118
    v_exp_f32 v119, v119
    v_pk_fma_f32 v[96:97], v[96:97], v[12:13], v[12:13] op_sel:[0,1,1] op_sel_hi:[1,1,1]
    v_pk_fma_f32 v[98:99], v[98:99], v[12:13], v[12:13] op_sel:[0,1,1] op_sel_hi:[1,1,1]
    v_pk_fma_f32 v[100:101], v[100:101], v[12:13], v[12:13] op_sel:[0,1,1] op_sel_hi:[1,1,1]
    v_pk_fma_f32 v[102:103], v[102:103], v[12:13], v[12:13] op_sel:[0,1,1] op_sel_hi:[1,1,1]
    v_pk_fma_f32 v[112:113], v[112:113], v[14:15], v[14:15] op_sel:[0,1,1] op_sel_hi:[1,1,1]
    v_pk_fma_f32 v[114:115], v[114:115], v[14:15], v[14:15] op_sel:[0,1,1] op_sel_hi:[1,1,1]
    v_pk_fma_f32 v[116:117], v[116:117], v[14:15], v[14:15] op_sel:[0,1,1] op_sel_hi:[1,1,1]
    v_pk_fma_f32 v[118:119], v[118:119], v[14:15], v[14:15] op_sel:[0,1,1] op_sel_hi:[1,1,1]
    v_rcp_f32 v96, v96
    v_rcp_f32 v97, v97
    v_rcp_f32 v98, v98
    v_rcp_f32 v99, v99
    v_rcp_f32 v100, v100
    v_rcp_f32 v101, v101
    v_rcp_f32 v102, v102
    v_rcp_f32 v103, v103
    v_rcp_f32 v112, v112
    v_rcp_f32 v113, v113
    v_rcp_f32 v114, v114
    v_rcp_f32 v115, v115
    v_rcp_f32 v116, v116
    v_rcp_f32 v117, v117
    v_rcp_f32 v118, v118
    v_rcp_f32 v119, v119
    v_pk_mul_f32 v[96:97], v[96:97], v[104:105]
    v_pk_mul_f32 v[98:99], v[98:99], v[106:107]
    v_pk_mul_f32 v[100:101], v[100:101], v[108:109]
    v_pk_mul_f32 v[102:103], v[102:103], v[110:111]
    v_pk_mul_f32 v[112:113], v[112:113], v[120:121]
    v_pk_mul_f32 v[114:115], v[114:115], v[122:123]
    v_pk_mul_f32 v[116:117], v[116:117], v[124:125]
    v_pk_mul_f32 v[118:119], v[118:119], v[126:127]
    v_cvt_pk_bf16_f32 v104, v96, v97
    v_cvt_pk_bf16_f32 v105, v98, v99
    v_cvt_pk_bf16_f32 v106, v100, v101
    v_cvt_pk_bf16_f32 v107, v102, v103
    v_cvt_pk_bf16_f32 v108, v112, v113
    v_cvt_pk_bf16_f32 v109, v114, v115
    v_cvt_pk_bf16_f32 v110, v116, v117
    v_cvt_pk_bf16_f32 v111, v118, v119
    s_cmp_eq_u32 s54, 0
    s_cbranch_scc1 L_st_14_s
    buffer_store_dwordx4 v[104:107], v2, s[12:15], s34 offen
    buffer_store_dwordx4 v[108:111], v2, s[12:15], s35 offen
    s_branch L_st_14_j
L_st_14_s:
    buffer_store_dwordx4 v[104:107], v2, s[12:15], s34 offen sc1
    buffer_store_dwordx4 v[108:111], v2, s[12:15], s35 offen sc1
L_st_14_j:
    s_add_u32 s34, s34, 29696
    s_add_u32 s35, s35, 29696
    s_mov_b64 exec, 1
    s_waitcnt vmcnt(3)
    s_cmp_eq_u32 s54, 0
    s_cbranch_scc1 L_st_15_s
    buffer_store_dword v17, v16, s[12:15], s55 offen offset:128
    s_branch L_st_15_j
L_st_15_s:
    buffer_store_dword v17, v16, s[12:15], s55 offen offset:128 sc1
L_st_15_j:
    s_mov_b64 exec, -1
L_p4_pub:
    s_nop 7
    s_mov_b64 exec, 7
    s_waitcnt vmcnt(0)
    s_cmp_eq_u32 s54, 0
    s_cbranch_scc1 L_st_16_s
    buffer_store_dword v17, v16, s[12:15], s55 offen
    s_branch L_st_16_j
L_st_16_s:
    buffer_store_dword v17, v16, s[12:15], s55 offen sc1
L_st_16_j:
    s_mov_b64 exec, -1
L_p4_skip_c:
    s_and_b32 s30, s2, 7
    s_lshl_b32 s27, s30, 2
    s_lshr_b32 s34, s2, 6
    s_add_u32 s27, s27, s34
    s_bfe_u32 s28, s2, 0x30003
    s_and_b32 s25, s24, 1
    s_bfe_u32 s26, s24, 0x10001
    v_and_b32 v12, 31, v1
    v_lshrrev_b32 v13, 5, v1
    v_bfe_u32 v14, v1, 2, 2
    v_lshl_add_u32 v15, v13, 2, v14
    v_lshlrev_b32 v15, 7, v15
    v_bfe_u32 v16, v1, 4, 1
    v_lshl_add_u32 v15, v16, 5, v15
    v_and_b32 v16, 3, v1
    v_lshl_add_u32 v15, v16, 3, v15
    v_lshrrev_b32 v14, 1, v14
    v_xor_b32 v14, s26, v14
    v_lshl_add_u32 v3, v14, 6, v15
    v_add_u32 v4, 0x00010000, v3
    s_lshl_b32 s30, s25, 12
    v_add_u32 v5, s30, v2
    v_add_u32 v6, 0x00010000, v5
    v_add_u32 v22, 0x00020000, v5
    s_lshl_b32 s31, s26, 11
    s_add_u32 s30, s30, s31
    s_add_u32 s30, s30, 24576
    v_add_u32 v7, s30, v2
    v_add_u32 v8, 1024, v7
    v_mov_b32 v17, 0x3f80
    v_bfe_u32 v14, v1, 3, 1
    v_and_b32 v15, 3, v1
    v_lshl_add_u32 v14, v14, 2, v15
    v_bfe_u32 v15, v1, 2, 1
    v_xor_b32 v15, v15, v13
    v_bfe_u32 v16, v1, 4, 1
    v_xor_b32 v16, 0, v16
    v_or_b32 v15, v15, v16
    v_lshl_add_u32 v14, v15, 4, v14
    v_and_b32 v15, 1, v14
    v_lshlrev_b32 v15, 4, v15
    v_lshlrev_b32 v15, v15, v17
    v_lshrrev_b32 v14, 1, v14
    v_cmp_eq_u32 vcc, 0, v14
    s_nop 1
    v_cndmask_b32 v24, 0, v15, vcc
    v_cmp_eq_u32 vcc, 1, v14
    s_nop 1
    v_cndmask_b32 v25, 0, v15, vcc
    v_cmp_eq_u32 vcc, 2, v14
    s_nop 1
    v_cndmask_b32 v26, 0, v15, vcc
    v_cmp_eq_u32 vcc, 3, v14
    s_nop 1
    v_cndmask_b32 v27, 0, v15, vcc
    v_bfe_u32 v14, v1, 3, 1
    v_and_b32 v15, 3, v1
    v_lshl_add_u32 v14, v14, 2, v15
    v_bfe_u32 v15, v1, 2, 1
    v_xor_b32 v15, v15, v13
    v_bfe_u32 v16, v1, 4, 1
    v_xor_b32 v16, 1, v16
    v_or_b32 v15, v15, v16
    v_lshl_add_u32 v14, v15, 4, v14
    v_and_b32 v15, 1, v14
    v_lshlrev_b32 v15, 4, v15
    v_lshlrev_b32 v15, v15, v17
    v_lshrrev_b32 v14, 1, v14
    v_cmp_eq_u32 vcc, 0, v14
    s_nop 1
    v_cndmask_b32 v28, 0, v15, vcc
    v_cmp_eq_u32 vcc, 1, v14
    s_nop 1
    v_cndmask_b32 v29, 0, v15, vcc
    v_cmp_eq_u32 vcc, 2, v14
    s_nop 1
    v_cndmask_b32 v30, 0, v15, vcc
    v_cmp_eq_u32 vcc, 3, v14
    s_nop 1
    v_cndmask_b32 v31, 0, v15, vcc
    s_lshl_b32 s33, s27, 1
    s_add_u32 s33, s33, s25
    s_lshl_b32 s34, s28, 1
    s_add_u32 s34, s34, s26
    s_mul_i32 s30, s29, 2560
    s_add_u32 s30, s30, 0
    v_mul_u32_u24 v14, 80, v12
    v_lshl_add_u32 v14, v13, 3, v14
    v_add_u32 v9, s30, v14
    v_lshrrev_b32 v14, 2, v1
    v_and_b32 v15, 3, v1
    v_lshlrev_b32 v15, 4, v15
    v_mad_u32_u24 v16, v14, 64, v15
    v_lshl_add_u32 v16, v14, 4, v16
    v_add_u32 v10, s30, v16
    v_lshl_add_u32 v11, v14, 10, v15
    s_lshl_b32 s36, s33, 15
    s_lshl_b32 s37, s34, 6
    s_add_u32 s36, s36, s37
    s_add_u32 s37, s36, 16384
    s_mov_b32 s20, s78
    s_mov_b32 s21, s79
    s_mov_b32 s22, 0x00200000
    s_mov_b32 s23, 0x00020000
    s_lshl_b32 s40, s27, 9
    s_add_u32 s40, s40, 11583488
    s_cmp_lg_u32 s24, 0
    s_cbranch_scc1 L_pi_p5i0
    v_lshlrev_b32 v18, 2, v1
    buffer_load_dword v19, v18, s[12:15], s40 offen offset:128 sc1
L_pi_p5i0:
    s_barrier
    ds_read_b128 v[32:35], v6 offset:49152
    ds_read_b64_tr_b16 v[36:37], v3 offset:0
    ds_read_b64_tr_b16 v[38:39], v3 offset:1024
    ds_read_b128 v[40:43], v6 offset:50176
    ds_read_b64_tr_b16 v[44:45], v3 offset:2048
    ds_read_b64_tr_b16 v[46:47], v3 offset:3072
    ds_read_b128 v[48:51], v6 offset:51200
    ds_read_b64_tr_b16 v[52:53], v3 offset:4096
    ds_read_b64_tr_b16 v[54:55], v3 offset:5120
    ds_read_b128 v[56:59], v6 offset:52224
    ds_read_b64_tr_b16 v[60:61], v3 offset:6144
    ds_read_b64_tr_b16 v[62:63], v3 offset:7168
    s_barrier
    s_waitcnt lgkmcnt(9)
    v_mfma_f32_32x32x16_bf16 v[112:127], v[36:39], v[32:35], 0
    ds_read_b128 v[72:75], v6 offset:57344
    ds_read_b64_tr_b16 v[76:77], v3 offset:8192
    ds_read_b64_tr_b16 v[78:79], v3 offset:9216
    s_waitcnt lgkmcnt(9)
    v_mfma_f32_32x32x16_bf16 v[112:127], v[44:47], v[40:43], v[112:127]
    ds_read_b128 v[80:83], v6 offset:58368
    ds_read_b64_tr_b16 v[84:85], v3 offset:10240
    ds_read_b64_tr_b16 v[86:87], v3 offset:11264
    s_waitcnt lgkmcnt(9)
    v_mfma_f32_32x32x16_bf16 v[112:127], v[52:55], v[48:51], v[112:127]
    ds_read_b128 v[88:91], v6 offset:59392
    ds_read_b64_tr_b16 v[92:93], v3 offset:12288
    ds_read_b64_tr_b16 v[94:95], v3 offset:13312
    s_waitcnt lgkmcnt(9)
    v_mfma_f32_32x32x16_bf16 v[112:127], v[60:63], v[56:59], v[112:127]
    ds_read_b128 v[96:99], v6 offset:60416
    ds_read_b64_tr_b16 v[100:101], v3 offset:14336
    ds_read_b64_tr_b16 v[102:103], v3 offset:15360
    s_cmp_lg_u32 s24, 0
    s_cbranch_scc1 L_poll_p5c1_go
    s_mov_b32 s59, 0x40000
    s_mov_b64 exec, 0x3fffffff
    s_branch L_poll_p5c1_c
L_poll_p5c1:
    buffer_load_dword v19, v18, s[12:15], s40 offen offset:128 sc1
L_poll_p5c1_c:
    s_sub_u32 s59, s59, 1
    s_waitcnt vmcnt(0)
    v_cmp_ne_u32 vcc, s53, v19
    s_cmp_eq_u32 s59, 0
    s_cbranch_scc1 L_poll_p5c1_x
    s_cbranch_vccnz L_poll_p5c1
L_poll_p5c1_x:
    s_mov_b64 exec, -1
L_poll_p5c1_go:
    s_barrier
    s_waitcnt lgkmcnt(9)
    v_mfma_f32_32x32x16_bf16 v[112:127], v[76:79], v[72:75], v[112:127]
    ds_read_b128 v[32:35], v22 offset:0
    ds_read_b64_tr_b16 v[36:37], v3 offset:16384
    ds_read_b64_tr_b16 v[38:39], v3 offset:17408
    s_waitcnt lgkmcnt(9)
    v_mfma_f32_32x32x16_bf16 v[112:127], v[84:87], v[80:83], v[112:127]
    ds_read_b128 v[40:43], v22 offset:1024
    ds_read_b64_tr_b16 v[44:45], v3 offset:18432
    ds_read_b64_tr_b16 v[46:47], v3 offset:19456
    s_waitcnt lgkmcnt(9)
    v_mfma_f32_32x32x16_bf16 v[112:127], v[92:95], v[88:91], v[112:127]
    ds_read_b128 v[48:51], v22 offset:2048
    ds_read_b64_tr_b16 v[52:53], v3 offset:20480
    ds_read_b64_tr_b16 v[54:55], v3 offset:21504
    s_waitcnt lgkmcnt(9)
    v_mfma_f32_32x32x16_bf16 v[112:127], v[100:103], v[96:99], v[112:127]
    ds_read_b128 v[56:59], v22 offset:3072
    ds_read_b64_tr_b16 v[60:61], v3 offset:22528
    ds_read_b64_tr_b16 v[62:63], v3 offset:23552
    s_barrier
    s_waitcnt lgkmcnt(9)
    v_mfma_f32_32x32x16_bf16 v[112:127], v[36:39], v[32:35], v[112:127]
    ds_read_b128 v[72:75], v22 offset:8192
    ds_read_b64_tr_b16 v[76:77], v3 offset:32768
    ds_read_b64_tr_b16 v[78:79], v3 offset:33792
    s_waitcnt lgkmcnt(9)
    v_mfma_f32_32x32x16_bf16 v[112:127], v[44:47], v[40:43], v[112:127]
    ds_read_b128 v[80:83], v22 offset:9216
    ds_read_b64_tr_b16 v[84:85], v3 offset:34816
    ds_read_b64_tr_b16 v[86:87], v3 offset:35840
    s_waitcnt lgkmcnt(9)
    v_mfma_f32_32x32x16_bf16 v[112:127], v[52:55], v[48:51], v[112:127]
    ds_read_b128 v[88:91], v22 offset:10240
    ds_read_b64_tr_b16 v[92:93], v3 offset:36864
    ds_read_b64_tr_b16 v[94:95], v3 offset:37888
    s_waitcnt lgkmcnt(9)
    v_mfma_f32_32x32x16_bf16 v[112:127], v[60:63], v[56:59], v[112:127]
    ds_read_b128 v[96:99], v22 offset:11264
    ds_read_b64_tr_b16 v[100:101], v3 offset:38912
    ds_read_b64_tr_b16 v[102:103], v3 offset:39936
    s_barrier
    s_waitcnt lgkmcnt(9)
    v_mfma_f32_32x32x16_bf16 v[112:127], v[76:79], v[72:75], v[112:127]
    ds_read_b128 v[32:35], v22 offset:16384
    ds_read_b64_tr_b16 v[36:37], v3 offset:40960
    ds_read_b64_tr_b16 v[38:39], v3 offset:41984
    s_waitcnt lgkmcnt(9)
    v_mfma_f32_32x32x16_bf16 v[112:127], v[84:87], v[80:83], v[112:127]
    ds_read_b128 v[40:43], v22 offset:17408
    ds_read_b64_tr_b16 v[44:45], v3 offset:43008
    ds_read_b64_tr_b16 v[46:47], v3 offset:44032
    s_waitcnt lgkmcnt(9)
    v_mfma_f32_32x32x16_bf16 v[112:127], v[92:95], v[88:91], v[112:127]
    ds_read_b128 v[48:51], v22 offset:18432
    ds_read_b64_tr_b16 v[52:53], v3 offset:45056
    ds_read_b64_tr_b16 v[54:55], v3 offset:46080
    s_waitcnt lgkmcnt(9)
    v_mfma_f32_32x32x16_bf16 v[112:127], v[100:103], v[96:99], v[112:127]
    ds_read_b128 v[56:59], v22 offset:19456
    ds_read_b64_tr_b16 v[60:61], v3 offset:47104
    ds_read_b64_tr_b16 v[62:63], v3 offset:48128
    ds_read_b128 v[64:67], v7
    ds_read_b128 v[68:71], v8
    s_barrier
    s_waitcnt lgkmcnt(11)
    v_mfma_f32_32x32x16_bf16 v[112:127], v[36:39], v[32:35], v[112:127]
    ds_read_b128 v[72:75], v22 offset:24576
    ds_read_b64_tr_b16 v[76:77], v3 offset:49152
    ds_read_b64_tr_b16 v[78:79], v3 offset:50176
    s_waitcnt lgkmcnt(11)
    v_mfma_f32_32x32x16_bf16 v[112:127], v[44:47], v[40:43], v[112:127]
    ds_read_b128 v[80:83], v22 offset:25600
    ds_read_b64_tr_b16 v[84:85], v3 offset:51200
    ds_read_b64_tr_b16 v[86:87], v3 offset:52224
    s_waitcnt lgkmcnt(11)
    v_mfma_f32_32x32x16_bf16 v[112:127], v[52:55], v[48:51], v[112:127]
    ds_read_b128 v[88:91], v22 offset:26624
    ds_read_b64_tr_b16 v[92:93], v3 offset:53248
    ds_read_b64_tr_b16 v[94:95], v3 offset:54272
    s_waitcnt lgkmcnt(11)
    v_mfma_f32_32x32x16_bf16 v[112:127], v[60:63], v[56:59], v[112:127]
    ds_read_b128 v[96:99], v22 offset:27648
    ds_read_b64_tr_b16 v[100:101], v3 offset:55296
    ds_read_b64_tr_b16 v[102:103], v3 offset:56320
    s_waitcnt lgkmcnt(13)
    v_mfma_f32_32x32x16_bf16 v[112:127], v[24:27], v[64:67], v[112:127]
    s_waitcnt lgkmcnt(12)
    v_mfma_f32_32x32x16_bf16 v[112:127], v[28:31], v[68:71], v[112:127]
    s_cmp_lg_u32 s24, 0
    s_cbranch_scc1 L_pi_p5i6
    v_lshlrev_b32 v18, 2, v1
    buffer_load_dword v19, v18, s[12:15], s40 offen offset:256 sc1
L_pi_p5i6:
    s_barrier
    s_waitcnt lgkmcnt(9)
    v_mfma_f32_32x32x16_bf16 v[112:127], v[76:79], v[72:75], v[112:127]
    ds_read_b128 v[32:35], v6 offset:49152
    ds_read_b64_tr_b16 v[36:37], v3 offset:57344
    ds_read_b64_tr_b16 v[38:39], v3 offset:58368
    s_waitcnt lgkmcnt(9)
    v_mfma_f32_32x32x16_bf16 v[112:127], v[84:87], v[80:83], v[112:127]
    ds_read_b128 v[40:43], v6 offset:50176
    ds_read_b64_tr_b16 v[44:45], v3 offset:59392
    ds_read_b64_tr_b16 v[46:47], v3 offset:60416
    s_waitcnt lgkmcnt(9)
    v_mfma_f32_32x32x16_bf16 v[112:127], v[92:95], v[88:91], v[112:127]
    ds_read_b128 v[48:51], v6 offset:51200
    ds_read_b64_tr_b16 v[52:53], v3 offset:61440
    ds_read_b64_tr_b16 v[54:55], v3 offset:62464
    s_waitcnt lgkmcnt(9)
    v_mfma_f32_32x32x16_bf16 v[112:127], v[100:103], v[96:99], v[112:127]
    ds_read_b128 v[56:59], v6 offset:52224
    ds_read_b64_tr_b16 v[60:61], v3 offset:63488
    ds_read_b64_tr_b16 v[62:63], v3 offset:64512
    s_barrier
    s_waitcnt lgkmcnt(9)
    v_mfma_f32_32x32x16_bf16 v[112:127], v[36:39], v[32:35], v[112:127]
    ds_read_b128 v[72:75], v6 offset:57344
    ds_read_b64_tr_b16 v[76:77], v4 offset:0
    ds_read_b64_tr_b16 v[78:79], v4 offset:1024
    s_waitcnt lgkmcnt(9)
    v_mfma_f32_32x32x16_bf16 v[112:127], v[44:47], v[40:43], v[112:127]
    ds_read_b128 v[80:83], v6 offset:58368
    ds_read_b64_tr_b16 v[84:85], v4 offset:2048
    ds_read_b64_tr_b16 v[86:87], v4 offset:3072
    s_waitcnt lgkmcnt(9)
    v_mfma_f32_32x32x16_bf16 v[112:127], v[52:55], v[48:51], v[112:127]
    ds_read_b128 v[88:91], v6 offset:59392
    ds_read_b64_tr_b16 v[92:93], v4 offset:4096
    ds_read_b64_tr_b16 v[94:95], v4 offset:5120
    s_waitcnt lgkmcnt(9)
    v_mfma_f32_32x32x16_bf16 v[112:127], v[60:63], v[56:59], v[112:127]
    ds_read_b128 v[96:99], v6 offset:60416
    ds_read_b64_tr_b16 v[100:101], v4 offset:6144
    ds_read_b64_tr_b16 v[102:103], v4 offset:7168
    s_barrier
    s_waitcnt lgkmcnt(9)
    v_mfma_f32_32x32x16_bf16 v[112:127], v[76:79], v[72:75], v[112:127]
    ds_read_b128 v[32:35], v22 offset:0
    ds_read_b64_tr_b16 v[36:37], v4 offset:8192
    ds_read_b64_tr_b16 v[38:39], v4 offset:9216
    s_waitcnt lgkmcnt(9)
    v_mfma_f32_32x32x16_bf16 v[112:127], v[84:87], v[80:83], v[112:127]
    ds_read_b128 v[40:43], v22 offset:1024
    ds_read_b64_tr_b16 v[44:45], v4 offset:10240
    ds_read_b64_tr_b16 v[46:47], v4 offset:11264
    s_waitcnt lgkmcnt(9)
    v_mfma_f32_32x32x16_bf16 v[112:127], v[92:95], v[88:91], v[112:127]
    ds_read_b128 v[48:51], v22 offset:2048
    ds_read_b64_tr_b16 v[52:53], v4 offset:12288
    ds_read_b64_tr_b16 v[54:55], v4 offset:13312
    s_waitcnt lgkmcnt(9)
    v_mfma_f32_32x32x16_bf16 v[112:127], v[100:103], v[96:99], v[112:127]
    ds_read_b128 v[56:59], v22 offset:3072
    ds_read_b64_tr_b16 v[60:61], v4 offset:14336
    ds_read_b64_tr_b16 v[62:63], v4 offset:15360
    s_cmp_lg_u32 s24, 0
    s_cbranch_scc1 L_poll_p5c8_go
    s_mov_b32 s59, 0x40000
    s_mov_b64 exec, 0x3fffffff
    s_branch L_poll_p5c8_c
L_poll_p5c8:
    buffer_load_dword v19, v18, s[12:15], s40 offen offset:256 sc1
L_poll_p5c8_c:
    s_sub_u32 s59, s59, 1
    s_waitcnt vmcnt(0)
    v_cmp_ne_u32 vcc, s53, v19
    s_cmp_eq_u32 s59, 0
    s_cbranch_scc1 L_poll_p5c8_x
    s_cbranch_vccnz L_poll_p5c8
L_poll_p5c8_x:
    s_mov_b64 exec, -1
L_poll_p5c8_go:
    s_barrier
    s_waitcnt lgkmcnt(9)
    v_mfma_f32_32x32x16_bf16 v[112:127], v[36:39], v[32:35], v[112:127]
    ds_read_b128 v[72:75], v22 offset:8192
    ds_read_b64_tr_b16 v[76:77], v4 offset:16384
    ds_read_b64_tr_b16 v[78:79], v4 offset:17408
    s_waitcnt lgkmcnt(9)
    v_mfma_f32_32x32x16_bf16 v[112:127], v[44:47], v[40:43], v[112:127]
    ds_read_b128 v[80:83], v22 offset:9216
    ds_read_b64_tr_b16 v[84:85], v4 offset:18432
    ds_read_b64_tr_b16 v[86:87], v4 offset:19456
    s_waitcnt lgkmcnt(9)
    v_mfma_f32_32x32x16_bf16 v[112:127], v[52:55], v[48:51], v[112:127]
    ds_read_b128 v[88:91], v22 offset:10240
    ds_read_b64_tr_b16 v[92:93], v4 offset:20480
    ds_read_b64_tr_b16 v[94:95], v4 offset:21504
    s_waitcnt lgkmcnt(9)
    v_mfma_f32_32x32x16_bf16 v[112:127], v[60:63], v[56:59], v[112:127]
    ds_read_b128 v[96:99], v22 offset:11264
    ds_read_b64_tr_b16 v[100:101], v4 offset:22528
    ds_read_b64_tr_b16 v[102:103], v4 offset:23552
    s_barrier
    s_waitcnt lgkmcnt(9)
    v_mfma_f32_32x32x16_bf16 v[112:127], v[76:79], v[72:75], v[112:127]
    ds_read_b128 v[32:35], v22 offset:16384
    ds_read_b64_tr_b16 v[36:37], v4 offset:24576
    ds_read_b64_tr_b16 v[38:39], v4 offset:25600
    s_waitcnt lgkmcnt(9)
    v_mfma_f32_32x32x16_bf16 v[112:127], v[84:87], v[80:83], v[112:127]
    ds_read_b128 v[40:43], v22 offset:17408
    ds_read_b64_tr_b16 v[44:45], v4 offset:26624
    ds_read_b64_tr_b16 v[46:47], v4 offset:27648
    s_waitcnt lgkmcnt(9)
    v_mfma_f32_32x32x16_bf16 v[112:127], v[92:95], v[88:91], v[112:127]
    ds_read_b128 v[48:51], v22 offset:18432
    ds_read_b64_tr_b16 v[52:53], v4 offset:28672
    ds_read_b64_tr_b16 v[54:55], v4 offset:29696
    s_waitcnt lgkmcnt(9)
    v_mfma_f32_32x32x16_bf16 v[112:127], v[100:103], v[96:99], v[112:127]
    ds_read_b128 v[56:59], v22 offset:19456
    ds_read_b64_tr_b16 v[60:61], v4 offset:30720
    ds_read_b64_tr_b16 v[62:63], v4 offset:31744
    s_barrier
    s_waitcnt lgkmcnt(9)
    v_mfma_f32_32x32x16_bf16 v[112:127], v[36:39], v[32:35], v[112:127]
    ds_read_b128 v[72:75], v22 offset:24576
    ds_read_b64_tr_b16 v[76:77], v4 offset:32768
    ds_read_b64_tr_b16 v[78:79], v4 offset:33792
    s_waitcnt lgkmcnt(9)
    v_mfma_f32_32x32x16_bf16 v[112:127], v[44:47], v[40:43], v[112:127]
    ds_read_b128 v[80:83], v22 offset:25600
    ds_read_b64_tr_b16 v[84:85], v4 offset:34816
    ds_read_b64_tr_b16 v[86:87], v4 offset:35840
    s_waitcnt lgkmcnt(9)
    v_mfma_f32_32x32x16_bf16 v[112:127], v[52:55], v[48:51], v[112:127]
    ds_read_b128 v[88:91], v22 offset:26624
    ds_read_b64_tr_b16 v[92:93], v4 offset:36864
    ds_read_b64_tr_b16 v[94:95], v4 offset:37888
    s_waitcnt lgkmcnt(9)
    v_mfma_f32_32x32x16_bf16 v[112:127], v[60:63], v[56:59], v[112:127]
    ds_read_b128 v[96:99], v22 offset:27648
    ds_read_b64_tr_b16 v[100:101], v4 offset:38912
    ds_read_b64_tr_b16 v[102:103], v4 offset:39936
    s_barrier
    s_waitcnt lgkmcnt(9)
    v_mfma_f32_32x32x16_bf16 v[112:127], v[76:79], v[72:75], v[112:127]
    ds_read_b128 v[32:35], v6 offset:49152
    ds_read_b64_tr_b16 v[36:37], v4 offset:40960
    ds_read_b64_tr_b16 v[38:39], v4 offset:41984
    s_waitcnt lgkmcnt(9)
    v_mfma_f32_32x32x16_bf16 v[112:127], v[84:87], v[80:83], v[112:127]
    ds_read_b128 v[40:43], v6 offset:50176
    ds_read_b64_tr_b16 v[44:45], v4 offset:43008
    ds_read_b64_tr_b16 v[46:47], v4 offset:44032
    s_waitcnt lgkmcnt(9)
    v_mfma_f32_32x32x16_bf16 v[112:127], v[92:95], v[88:91], v[112:127]
    ds_read_b128 v[48:51], v6 offset:51200
    ds_read_b64_tr_b16 v[52:53], v4 offset:45056
    ds_read_b64_tr_b16 v[54:55], v4 offset:46080
    s_waitcnt lgkmcnt(9)
    v_mfma_f32_32x32x16_bf16 v[112:127], v[100:103], v[96:99], v[112:127]
    ds_read_b128 v[56:59], v6 offset:52224
    ds_read_b64_tr_b16 v[60:61], v4 offset:47104
    ds_read_b64_tr_b16 v[62:63], v4 offset:48128
    s_barrier
    s_waitcnt lgkmcnt(9)
    v_mfma_f32_32x32x16_bf16 v[112:127], v[36:39], v[32:35], v[112:127]
    ds_read_b128 v[72:75], v6 offset:57344
    ds_read_b64_tr_b16 v[76:77], v3 offset:0
    ds_read_b64_tr_b16 v[78:79], v3 offset:1024
    s_waitcnt lgkmcnt(9)
    v_mfma_f32_32x32x16_bf16 v[112:127], v[44:47], v[40:43], v[112:127]
    ds_read_b128 v[80:83], v6 offset:58368
    ds_read_b64_tr_b16 v[84:85], v3 offset:2048
    ds_read_b64_tr_b16 v[86:87], v3 offset:3072
    s_waitcnt lgkmcnt(9)
    v_mfma_f32_32x32x16_bf16 v[112:127], v[52:55], v[48:51], v[112:127]
    ds_read_b128 v[88:91], v6 offset:59392
    ds_read_b64_tr_b16 v[92:93], v3 offset:4096
    ds_read_b64_tr_b16 v[94:95], v3 offset:5120
    s_waitcnt lgkmcnt(9)
    v_mfma_f32_32x32x16_bf16 v[112:127], v[60:63], v[56:59], v[112:127]
    ds_read_b128 v[96:99], v6 offset:60416
    ds_read_b64_tr_b16 v[100:101], v3 offset:6144
    ds_read_b64_tr_b16 v[102:103], v3 offset:7168
    s_barrier
    s_waitcnt lgkmcnt(9)
    v_mfma_f32_32x32x16_bf16 v[112:127], v[76:79], v[72:75], v[112:127]
    ds_read_b128 v[32:35], v22 offset:0
    ds_read_b64_tr_b16 v[36:37], v3 offset:8192
    ds_read_b64_tr_b16 v[38:39], v3 offset:9216
    s_waitcnt lgkmcnt(9)
    v_mfma_f32_32x32x16_bf16 v[112:127], v[84:87], v[80:83], v[112:127]
    ds_read_b128 v[40:43], v22 offset:1024
    ds_read_b64_tr_b16 v[44:45], v3 offset:10240
    ds_read_b64_tr_b16 v[46:47], v3 offset:11264
    s_waitcnt lgkmcnt(9)
    v_mfma_f32_32x32x16_bf16 v[112:127], v[92:95], v[88:91], v[112:127]
    ds_read_b128 v[48:51], v22 offset:2048
    ds_read_b64_tr_b16 v[52:53], v3 offset:12288
    ds_read_b64_tr_b16 v[54:55], v3 offset:13312
    s_waitcnt lgkmcnt(9)
    v_mfma_f32_32x32x16_bf16 v[112:127], v[100:103], v[96:99], v[112:127]
    ds_read_b128 v[56:59], v22 offset:3072
    ds_read_b64_tr_b16 v[60:61], v3 offset:14336
    ds_read_b64_tr_b16 v[62:63], v3 offset:15360
    s_barrier
    s_waitcnt lgkmcnt(9)
    v_mfma_f32_32x32x16_bf16 v[112:127], v[36:39], v[32:35], v[112:127]
    ds_read_b128 v[72:75], v22 offset:8192
    ds_read_b64_tr_b16 v[76:77], v3 offset:16384
    ds_read_b64_tr_b16 v[78:79], v3 offset:17408
    s_waitcnt lgkmcnt(9)
    v_mfma_f32_32x32x16_bf16 v[112:127], v[44:47], v[40:43], v[112:127]
    ds_read_b128 v[80:83], v22 offset:9216
    ds_read_b64_tr_b16 v[84:85], v3 offset:18432
    ds_read_b64_tr_b16 v[86:87], v3 offset:19456
    s_waitcnt lgkmcnt(9)
    v_mfma_f32_32x32x16_bf16 v[112:127], v[52:55], v[48:51], v[112:127]
    ds_read_b128 v[88:91], v22 offset:10240
    ds_read_b64_tr_b16 v[92:93], v3 offset:20480
    ds_read_b64_tr_b16 v[94:95], v3 offset:21504
    s_waitcnt lgkmcnt(9)
    v_mfma_f32_32x32x16_bf16 v[112:127], v[60:63], v[56:59], v[112:127]
    ds_read_b128 v[96:99], v22 offset:11264
    ds_read_b64_tr_b16 v[100:101], v3 offset:22528
    ds_read_b64_tr_b16 v[102:103], v3 offset:23552
    s_barrier
    s_waitcnt lgkmcnt(9)
    v_mfma_f32_32x32x16_bf16 v[112:127], v[76:79], v[72:75], v[112:127]
    ds_read_b128 v[32:35], v22 offset:16384
    ds_read_b64_tr_b16 v[36:37], v3 offset:32768
    ds_read_b64_tr_b16 v[38:39], v3 offset:33792
    s_waitcnt lgkmcnt(9)
    v_mfma_f32_32x32x16_bf16 v[112:127], v[84:87], v[80:83], v[112:127]
    ds_read_b128 v[40:43], v22 offset:17408
    ds_read_b64_tr_b16 v[44:45], v3 offset:34816
    ds_read_b64_tr_b16 v[46:47], v3 offset:35840
    s_waitcnt lgkmcnt(9)
    v_mfma_f32_32x32x16_bf16 v[112:127], v[92:95], v[88:91], v[112:127]
    ds_read_b128 v[48:51], v22 offset:18432
    ds_read_b64_tr_b16 v[52:53], v3 offset:36864
    ds_read_b64_tr_b16 v[54:55], v3 offset:37888
    s_waitcnt lgkmcnt(9)
    v_mfma_f32_32x32x16_bf16 v[112:127], v[100:103], v[96:99], v[112:127]
    ds_read_b128 v[56:59], v22 offset:19456
    ds_read_b64_tr_b16 v[60:61], v3 offset:38912
    ds_read_b64_tr_b16 v[62:63], v3 offset:39936
    s_barrier
    s_waitcnt lgkmcnt(9)
    v_mfma_f32_32x32x16_bf16 v[112:127], v[36:39], v[32:35], v[112:127]
    ds_read_b128 v[72:75], v22 offset:24576
    ds_read_b64_tr_b16 v[76:77], v3 offset:40960
    ds_read_b64_tr_b16 v[78:79], v3 offset:41984
    s_waitcnt lgkmcnt(9)
    v_mfma_f32_32x32x16_bf16 v[112:127], v[44:47], v[40:43], v[112:127]
    ds_read_b128 v[80:83], v22 offset:25600
    ds_read_b64_tr_b16 v[84:85], v3 offset:43008
    ds_read_b64_tr_b16 v[86:87], v3 offset:44032
    s_waitcnt lgkmcnt(9)
    v_mfma_f32_32x32x16_bf16 v[112:127], v[52:55], v[48:51], v[112:127]
    ds_read_b128 v[88:91], v22 offset:26624
    ds_read_b64_tr_b16 v[92:93], v3 offset:45056
    ds_read_b64_tr_b16 v[94:95], v3 offset:46080
    s_waitcnt lgkmcnt(9)
    v_mfma_f32_32x32x16_bf16 v[112:127], v[60:63], v[56:59], v[112:127]
    ds_read_b128 v[96:99], v22 offset:27648
    ds_read_b64_tr_b16 v[100:101], v3 offset:47104
    ds_read_b64_tr_b16 v[102:103], v3 offset:48128
    s_barrier
    s_waitcnt lgkmcnt(9)
    v_mfma_f32_32x32x16_bf16 v[112:127], v[76:79], v[72:75], v[112:127]
    ds_read_b128 v[32:35], v6 offset:49152
    ds_read_b64_tr_b16 v[36:37], v3 offset:49152
    ds_read_b64_tr_b16 v[38:39], v3 offset:50176
    s_waitcnt lgkmcnt(9)
    v_mfma_f32_32x32x16_bf16 v[112:127], v[84:87], v[80:83], v[112:127]
    ds_read_b128 v[40:43], v6 offset:50176
    ds_read_b64_tr_b16 v[44:45], v3 offset:51200
    ds_read_b64_tr_b16 v[46:47], v3 offset:52224
    s_waitcnt lgkmcnt(9)
    v_mfma_f32_32x32x16_bf16 v[112:127], v[92:95], v[88:91], v[112:127]
    ds_read_b128 v[48:51], v6 offset:51200
    ds_read_b64_tr_b16 v[52:53], v3 offset:53248
    ds_read_b64_tr_b16 v[54:55], v3 offset:54272
    s_waitcnt lgkmcnt(9)
    v_mfma_f32_32x32x16_bf16 v[112:127], v[100:103], v[96:99], v[112:127]
    ds_read_b128 v[56:59], v6 offset:52224
    ds_read_b64_tr_b16 v[60:61], v3 offset:55296
    ds_read_b64_tr_b16 v[62:63], v3 offset:56320
    s_barrier
    s_waitcnt lgkmcnt(9)
    v_mfma_f32_32x32x16_bf16 v[112:127], v[36:39], v[32:35], v[112:127]
    ds_read_b128 v[72:75], v6 offset:57344
    ds_read_b64_tr_b16 v[76:77], v3 offset:57344
    ds_read_b64_tr_b16 v[78:79], v3 offset:58368
    s_waitcnt lgkmcnt(9)
    v_mfma_f32_32x32x16_bf16 v[112:127], v[44:47], v[40:43], v[112:127]
    ds_read_b128 v[80:83], v6 offset:58368
    ds_read_b64_tr_b16 v[84:85], v3 offset:59392
    ds_read_b64_tr_b16 v[86:87], v3 offset:60416
    s_waitcnt lgkmcnt(9)
    v_mfma_f32_32x32x16_bf16 v[112:127], v[52:55], v[48:51], v[112:127]
    ds_read_b128 v[88:91], v6 offset:59392
    ds_read_b64_tr_b16 v[92:93], v3 offset:61440
    ds_read_b64_tr_b16 v[94:95], v3 offset:62464
    s_waitcnt lgkmcnt(9)
    v_mfma_f32_32x32x16_bf16 v[112:127], v[60:63], v[56:59], v[112:127]
    ds_read_b128 v[96:99], v6 offset:60416
    ds_read_b64_tr_b16 v[100:101], v3 offset:63488
    ds_read_b64_tr_b16 v[102:103], v3 offset:64512
    s_barrier
    s_waitcnt lgkmcnt(9)
    v_mfma_f32_32x32x16_bf16 v[112:127], v[76:79], v[72:75], v[112:127]
    ds_read_b128 v[32:35], v22 offset:0
    ds_read_b64_tr_b16 v[36:37], v4 offset:0
    ds_read_b64_tr_b16 v[38:39], v4 offset:1024
    s_waitcnt lgkmcnt(9)
    v_mfma_f32_32x32x16_bf16 v[112:127], v[84:87], v[80:83], v[112:127]
    ds_read_b128 v[40:43], v22 offset:1024
    ds_read_b64_tr_b16 v[44:45], v4 offset:2048
    ds_read_b64_tr_b16 v[46:47], v4 offset:3072
    s_waitcnt lgkmcnt(9)
    v_mfma_f32_32x32x16_bf16 v[112:127], v[92:95], v[88:91], v[112:127]
    ds_read_b128 v[48:51], v22 offset:2048
    ds_read_b64_tr_b16 v[52:53], v4 offset:4096
    ds_read_b64_tr_b16 v[54:55], v4 offset:5120
    s_waitcnt lgkmcnt(9)
    v_mfma_f32_32x32x16_bf16 v[112:127], v[100:103], v[96:99], v[112:127]
    ds_read_b128 v[56:59], v22 offset:3072
    ds_read_b64_tr_b16 v[60:61], v4 offset:6144
    ds_read_b64_tr_b16 v[62:63], v4 offset:7168
    s_barrier
    s_waitcnt lgkmcnt(9)
    v_mfma_f32_32x32x16_bf16 v[112:127], v[36:39], v[32:35], v[112:127]
    ds_read_b128 v[72:75], v22 offset:8192
    ds_read_b64_tr_b16 v[76:77], v4 offset:8192
    ds_read_b64_tr_b16 v[78:79], v4 offset:9216
    s_waitcnt lgkmcnt(9)
    v_mfma_f32_32x32x16_bf16 v[112:127], v[44:47], v[40:43], v[112:127]
    ds_read_b128 v[80:83], v22 offset:9216
    ds_read_b64_tr_b16 v[84:85], v4 offset:10240
    ds_read_b64_tr_b16 v[86:87], v4 offset:11264
    s_waitcnt lgkmcnt(9)
    v_mfma_f32_32x32x16_bf16 v[112:127], v[52:55], v[48:51], v[112:127]
    s_waitcnt lgkmcnt(6)
    v_mfma_f32_32x32x16_bf16 v[112:127], v[60:63], v[56:59], v[112:127]
    s_waitcnt lgkmcnt(3)
    v_mfma_f32_32x32x16_bf16 v[112:127], v[76:79], v[72:75], v[112:127]
    s_waitcnt lgkmcnt(0)
    v_mfma_f32_32x32x16_bf16 v[112:127], v[84:87], v[80:83], v[112:127]
    s_nop 11
    v_cvt_pk_bf16_f32 v32, v112, v113
    v_cvt_pk_bf16_f32 v33, v114, v115
    v_cvt_pk_bf16_f32 v34, v116, v117
    v_cvt_pk_bf16_f32 v35, v118, v119
    v_cvt_pk_bf16_f32 v36, v120, v121
    v_cvt_pk_bf16_f32 v37, v122, v123
    v_cvt_pk_bf16_f32 v38, v124, v125
    v_cvt_pk_bf16_f32 v39, v126, v127
    ds_write_b64 v9, v[32:33] offset:0
    ds_write_b64 v9, v[34:35] offset:16
    ds_write_b64 v9, v[36:37] offset:32
    ds_write_b64 v9, v[38:39] offset:48
    s_waitcnt lgkmcnt(0)
    ds_read_b128 v[40:43], v10
    ds_read_b128 v[44:47], v10 offset:1280
    s_waitcnt lgkmcnt(1)
    buffer_store_dwordx4 v[40:43], v11, s[20:23], s36 offen
    s_waitcnt lgkmcnt(0)
    buffer_store_dwordx4 v[44:47], v11, s[20:23], s37 offen
    s_cmp_lg_u32 s2, 0
    s_cbranch_scc1 L_nogen
    s_cmp_lg_u32 s24, 0
    s_cbranch_scc1 L_nogen
    v_mov_b32 v12, 11563008
    v_mov_b32 v13, s53
    s_mov_b64 exec, 1
    buffer_store_dword v13, v12, s[12:15], 0 offen sc1
L_nogen:
L_done:
    s_endpgm
L_p4_odd:
    s_waitcnt lgkmcnt(4)
    v_mfma_f32_32x32x16_bf16 v[32:47], v[144:147], v[128:131], 0
    ds_read_b128 v[136:139], v7 offset:1024
    ds_read_b64_tr_b16 v[156:157], v3 offset:38912
    v_mfma_f32_32x32x16_bf16 v[48:63], v[144:147], v[132:135], 0
    ds_read_b64_tr_b16 v[158:159], v3 offset:40448
    ds_read_b128 v[140:143], v7 offset:3072
    s_waitcnt lgkmcnt(6)
    v_mfma_f32_32x32x16_bf16 v[64:79], v[148:151], v[128:131], 0
    ds_read_b64_tr_b16 v[160:161], v5 offset:38944
    ds_read_b64_tr_b16 v[162:163], v5 offset:40480
    v_mfma_f32_32x32x16_bf16 v[80:95], v[148:151], v[132:135], 0
    ds_read_b64_tr_b16 v[164:165], v3 offset:38976
    ds_read_b64_tr_b16 v[166:167], v3 offset:40512
    s_waitcnt lgkmcnt(8)
    v_mfma_f32_32x32x16_bf16 v[96:111], v[152:155], v[128:131], 0
    v_mfma_f32_32x32x16_bf16 v[112:127], v[152:155], v[132:135], 0
    s_waitcnt lgkmcnt(0)
    s_barrier
    v_mfma_f32_16x16x32_bf16 v[20:23], v[156:159], v[12:15], v[20:23]
    v_mfma_f32_32x32x16_bf16 v[32:47], v[156:159], v[136:139], v[32:47]
    ds_read_b128 v[128:131], v7 offset:8192
    ds_read_b64_tr_b16 v[144:145], v3 offset:45056
    v_mfma_f32_32x32x16_bf16 v[48:63], v[156:159], v[140:143], v[48:63]
    ds_read_b64_tr_b16 v[146:147], v3 offset:46592
    ds_read_b128 v[132:135], v7 offset:10240
    v_mfma_f32_16x16x32_bf16 v[24:27], v[160:163], v[12:15], v[24:27]
    v_mfma_f32_32x32x16_bf16 v[64:79], v[160:163], v[136:139], v[64:79]
    ds_read_b64_tr_b16 v[148:149], v5 offset:45088
    ds_read_b64_tr_b16 v[150:151], v5 offset:46624
    v_mfma_f32_32x32x16_bf16 v[80:95], v[160:163], v[140:143], v[80:95]
    ds_read_b64_tr_b16 v[152:153], v3 offset:45120
    ds_read_b64_tr_b16 v[154:155], v3 offset:46656
    v_mfma_f32_16x16x32_bf16 v[28:31], v[164:167], v[12:15], v[28:31]
    v_mfma_f32_32x32x16_bf16 v[96:111], v[164:167], v[136:139], v[96:111]
    v_mfma_f32_32x32x16_bf16 v[112:127], v[164:167], v[140:143], v[112:127]
    s_waitcnt lgkmcnt(4)
    v_mfma_f32_32x32x16_bf16 v[32:47], v[144:147], v[128:131], v[32:47]
    ds_read_b128 v[136:139], v7 offset:9216
    ds_read_b64_tr_b16 v[156:157], v3 offset:51200
    v_mfma_f32_32x32x16_bf16 v[48:63], v[144:147], v[132:135], v[48:63]
    ds_read_b64_tr_b16 v[158:159], v3 offset:52736
    ds_read_b128 v[140:143], v7 offset:11264
    s_waitcnt lgkmcnt(6)
    v_mfma_f32_32x32x16_bf16 v[64:79], v[148:151], v[128:131], v[64:79]
    ds_read_b64_tr_b16 v[160:161], v5 offset:51232
    ds_read_b64_tr_b16 v[162:163], v5 offset:52768
    v_mfma_f32_32x32x16_bf16 v[80:95], v[148:151], v[132:135], v[80:95]
    ds_read_b64_tr_b16 v[164:165], v3 offset:51264
    ds_read_b64_tr_b16 v[166:167], v3 offset:52800
    s_waitcnt lgkmcnt(8)
    v_mfma_f32_32x32x16_bf16 v[96:111], v[152:155], v[128:131], v[96:111]
    v_mfma_f32_32x32x16_bf16 v[112:127], v[152:155], v[132:135], v[112:127]
    s_waitcnt lgkmcnt(0)
    s_barrier
    v_mfma_f32_16x16x32_bf16 v[20:23], v[156:159], v[12:15], v[20:23]
    v_mfma_f32_32x32x16_bf16 v[32:47], v[156:159], v[136:139], v[32:47]
    ds_read_b128 v[128:131], v7 offset:16384
    ds_read_b64_tr_b16 v[144:145], v4 offset:32768
    v_mfma_f32_32x32x16_bf16 v[48:63], v[156:159], v[140:143], v[48:63]
    ds_read_b64_tr_b16 v[146:147], v4 offset:34304
    ds_read_b128 v[132:135], v7 offset:18432
    v_mfma_f32_16x16x32_bf16 v[24:27], v[160:163], v[12:15], v[24:27]
    v_mfma_f32_32x32x16_bf16 v[64:79], v[160:163], v[136:139], v[64:79]
    ds_read_b64_tr_b16 v[148:149], v6 offset:32800
    ds_read_b64_tr_b16 v[150:151], v6 offset:34336
    v_mfma_f32_32x32x16_bf16 v[80:95], v[160:163], v[140:143], v[80:95]
    ds_read_b64_tr_b16 v[152:153], v4 offset:32832
    ds_read_b64_tr_b16 v[154:155], v4 offset:34368
    v_mfma_f32_16x16x32_bf16 v[28:31], v[164:167], v[12:15], v[28:31]
    v_mfma_f32_32x32x16_bf16 v[96:111], v[164:167], v[136:139], v[96:111]
    v_mfma_f32_32x32x16_bf16 v[112:127], v[164:167], v[140:143], v[112:127]
    s_waitcnt lgkmcnt(4)
    v_mfma_f32_32x32x16_bf16 v[32:47], v[144:147], v[128:131], v[32:47]
    ds_read_b128 v[136:139], v7 offset:17408
    ds_read_b64_tr_b16 v[156:157], v4 offset:38912
    v_mfma_f32_32x32x16_bf16 v[48:63], v[144:147], v[132:135], v[48:63]
    ds_read_b64_tr_b16 v[158:159], v4 offset:40448
    ds_read_b128 v[140:143], v7 offset:19456
    s_waitcnt lgkmcnt(6)
    v_mfma_f32_32x32x16_bf16 v[64:79], v[148:151], v[128:131], v[64:79]
    ds_read_b64_tr_b16 v[160:161], v6 offset:38944
    ds_read_b64_tr_b16 v[162:163], v6 offset:40480
    v_mfma_f32_32x32x16_bf16 v[80:95], v[148:151], v[132:135], v[80:95]
    ds_read_b64_tr_b16 v[164:165], v4 offset:38976
    ds_read_b64_tr_b16 v[166:167], v4 offset:40512
    s_waitcnt lgkmcnt(8)
    v_mfma_f32_32x32x16_bf16 v[96:111], v[152:155], v[128:131], v[96:111]
    v_mfma_f32_32x32x16_bf16 v[112:127], v[152:155], v[132:135], v[112:127]
    s_waitcnt lgkmcnt(0)
    s_barrier
    v_mfma_f32_16x16x32_bf16 v[20:23], v[156:159], v[12:15], v[20:23]
    v_mfma_f32_32x32x16_bf16 v[32:47], v[156:159], v[136:139], v[32:47]
    ds_read_b128 v[128:131], v7 offset:24576
    ds_read_b64_tr_b16 v[144:145], v4 offset:45056
    v_mfma_f32_32x32x16_bf16 v[48:63], v[156:159], v[140:143], v[48:63]
    ds_read_b64_tr_b16 v[146:147], v4 offset:46592
    ds_read_b128 v[132:135], v7 offset:26624
    v_mfma_f32_16x16x32_bf16 v[24:27], v[160:163], v[12:15], v[24:27]
    v_mfma_f32_32x32x16_bf16 v[64:79], v[160:163], v[136:139], v[64:79]
    ds_read_b64_tr_b16 v[148:149], v6 offset:45088
    ds_read_b64_tr_b16 v[150:151], v6 offset:46624
    v_mfma_f32_32x32x16_bf16 v[80:95], v[160:163], v[140:143], v[80:95]
    ds_read_b64_tr_b16 v[152:153], v4 offset:45120
    ds_read_b64_tr_b16 v[154:155], v4 offset:46656
    v_mfma_f32_16x16x32_bf16 v[28:31], v[164:167], v[12:15], v[28:31]
    v_mfma_f32_32x32x16_bf16 v[96:111], v[164:167], v[136:139], v[96:111]
    v_mfma_f32_32x32x16_bf16 v[112:127], v[164:167], v[140:143], v[112:127]
    s_waitcnt lgkmcnt(4)
    v_mfma_f32_32x32x16_bf16 v[32:47], v[144:147], v[128:131], v[32:47]
    ds_read_b128 v[136:139], v7 offset:25600
    ds_read_b64_tr_b16 v[156:157], v4 offset:51200
    v_mfma_f32_32x32x16_bf16 v[48:63], v[144:147], v[132:135], v[48:63]
    ds_read_b64_tr_b16 v[158:159], v4 offset:52736
    ds_read_b128 v[140:143], v7 offset:27648
    s_waitcnt lgkmcnt(6)
    v_mfma_f32_32x32x16_bf16 v[64:79], v[148:151], v[128:131], v[64:79]
    ds_read_b64_tr_b16 v[160:161], v6 offset:51232
    ds_read_b64_tr_b16 v[162:163], v6 offset:52768
    v_mfma_f32_32x32x16_bf16 v[80:95], v[148:151], v[132:135], v[80:95]
    ds_read_b64_tr_b16 v[164:165], v4 offset:51264
    ds_read_b64_tr_b16 v[166:167], v4 offset:52800
    s_waitcnt lgkmcnt(8)
    v_mfma_f32_32x32x16_bf16 v[96:111], v[152:155], v[128:131], v[96:111]
    v_mfma_f32_32x32x16_bf16 v[112:127], v[152:155], v[132:135], v[112:127]
    s_waitcnt lgkmcnt(0)
    s_barrier
    v_mfma_f32_16x16x32_bf16 v[20:23], v[156:159], v[12:15], v[20:23]
    v_mfma_f32_32x32x16_bf16 v[32:47], v[156:159], v[136:139], v[32:47]
    ds_read_b128 v[128:131], v7 offset:32768
    ds_read_b64_tr_b16 v[144:145], v3 offset:0
    v_mfma_f32_32x32x16_bf16 v[48:63], v[156:159], v[140:143], v[48:63]
    ds_read_b64_tr_b16 v[146:147], v3 offset:1536
    ds_read_b128 v[132:135], v7 offset:34816
    v_mfma_f32_16x16x32_bf16 v[24:27], v[160:163], v[12:15], v[24:27]
    v_mfma_f32_32x32x16_bf16 v[64:79], v[160:163], v[136:139], v[64:79]
    ds_read_b64_tr_b16 v[148:149], v5 offset:32
    ds_read_b64_tr_b16 v[150:151], v5 offset:1568
    v_mfma_f32_32x32x16_bf16 v[80:95], v[160:163], v[140:143], v[80:95]
    ds_read_b64_tr_b16 v[152:153], v3 offset:64
    ds_read_b64_tr_b16 v[154:155], v3 offset:1600
    v_mfma_f32_16x16x32_bf16 v[28:31], v[164:167], v[12:15], v[28:31]
    v_mfma_f32_32x32x16_bf16 v[96:111], v[164:167], v[136:139], v[96:111]
    v_mfma_f32_32x32x16_bf16 v[112:127], v[164:167], v[140:143], v[112:127]
    s_waitcnt lgkmcnt(4)
    v_mfma_f32_32x32x16_bf16 v[32:47], v[144:147], v[128:131], v[32:47]
    ds_read_b128 v[136:139], v7 offset:33792
    ds_read_b64_tr_b16 v[156:157], v3 offset:6144
    v_mfma_f32_32x32x16_bf16 v[48:63], v[144:147], v[132:135], v[48:63]
    ds_read_b64_tr_b16 v[158:159], v3 offset:7680
    ds_read_b128 v[140:143], v7 offset:35840
    s_waitcnt lgkmcnt(6)
    v_mfma_f32_32x32x16_bf16 v[64:79], v[148:151], v[128:131], v[64:79]
    ds_read_b64_tr_b16 v[160:161], v5 offset:6176
    ds_read_b64_tr_b16 v[162:163], v5 offset:7712
    v_mfma_f32_32x32x16_bf16 v[80:95], v[148:151], v[132:135], v[80:95]
    ds_read_b64_tr_b16 v[164:165], v3 offset:6208
    ds_read_b64_tr_b16 v[166:167], v3 offset:7744
    s_waitcnt lgkmcnt(8)
    v_mfma_f32_32x32x16_bf16 v[96:111], v[152:155], v[128:131], v[96:111]
    v_mfma_f32_32x32x16_bf16 v[112:127], v[152:155], v[132:135], v[112:127]
    s_waitcnt lgkmcnt(0)
    s_barrier
    v_mfma_f32_16x16x32_bf16 v[20:23], v[156:159], v[12:15], v[20:23]
    v_mfma_f32_32x32x16_bf16 v[32:47], v[156:159], v[136:139], v[32:47]
    ds_read_b128 v[128:131], v7 offset:0
    ds_read_b64_tr_b16 v[144:145], v3 offset:12288
    v_mfma_f32_32x32x16_bf16 v[48:63], v[156:159], v[140:143], v[48:63]
    ds_read_b64_tr_b16 v[146:147], v3 offset:13824
    ds_read_b128 v[132:135], v7 offset:2048
    v_mfma_f32_16x16x32_bf16 v[24:27], v[160:163], v[12:15], v[24:27]
    v_mfma_f32_32x32x16_bf16 v[64:79], v[160:163], v[136:139], v[64:79]
    ds_read_b64_tr_b16 v[148:149], v5 offset:12320
    ds_read_b64_tr_b16 v[150:151], v5 offset:13856
    v_mfma_f32_32x32x16_bf16 v[80:95], v[160:163], v[140:143], v[80:95]
    ds_read_b64_tr_b16 v[152:153], v3 offset:12352
    ds_read_b64_tr_b16 v[154:155], v3 offset:13888
    v_mfma_f32_16x16x32_bf16 v[28:31], v[164:167], v[12:15], v[28:31]
    v_mfma_f32_32x32x16_bf16 v[96:111], v[164:167], v[136:139], v[96:111]
    v_mfma_f32_32x32x16_bf16 v[112:127], v[164:167], v[140:143], v[112:127]
    s_waitcnt lgkmcnt(4)
    v_mfma_f32_32x32x16_bf16 v[32:47], v[144:147], v[128:131], v[32:47]
    ds_read_b128 v[136:139], v7 offset:1024
    ds_read_b64_tr_b16 v[156:157], v3 offset:18432
    v_mfma_f32_32x32x16_bf16 v[48:63], v[144:147], v[132:135], v[48:63]
    ds_read_b64_tr_b16 v[158:159], v3 offset:19968
    ds_read_b128 v[140:143], v7 offset:3072
    s_waitcnt lgkmcnt(6)
    v_mfma_f32_32x32x16_bf16 v[64:79], v[148:151], v[128:131], v[64:79]
    ds_read_b64_tr_b16 v[160:161], v5 offset:18464
    ds_read_b64_tr_b16 v[162:163], v5 offset:20000
    v_mfma_f32_32x32x16_bf16 v[80:95], v[148:151], v[132:135], v[80:95]
    ds_read_b64_tr_b16 v[164:165], v3 offset:18496
    ds_read_b64_tr_b16 v[166:167], v3 offset:20032
    s_waitcnt lgkmcnt(8)
    v_mfma_f32_32x32x16_bf16 v[96:111], v[152:155], v[128:131], v[96:111]
    v_mfma_f32_32x32x16_bf16 v[112:127], v[152:155], v[132:135], v[112:127]
    s_waitcnt lgkmcnt(0)
    s_barrier
    v_mfma_f32_16x16x32_bf16 v[20:23], v[156:159], v[12:15], v[20:23]
    v_mfma_f32_32x32x16_bf16 v[32:47], v[156:159], v[136:139], v[32:47]
    ds_read_b128 v[128:131], v7 offset:8192
    ds_read_b64_tr_b16 v[144:145], v3 offset:57344
    v_mfma_f32_32x32x16_bf16 v[48:63], v[156:159], v[140:143], v[48:63]
    ds_read_b64_tr_b16 v[146:147], v3 offset:58880
    ds_read_b128 v[132:135], v7 offset:10240
    v_mfma_f32_16x16x32_bf16 v[24:27], v[160:163], v[12:15], v[24:27]
    v_mfma_f32_32x32x16_bf16 v[64:79], v[160:163], v[136:139], v[64:79]
    ds_read_b64_tr_b16 v[148:149], v5 offset:57376
    ds_read_b64_tr_b16 v[150:151], v5 offset:58912
    v_mfma_f32_32x32x16_bf16 v[80:95], v[160:163], v[140:143], v[80:95]
    ds_read_b64_tr_b16 v[152:153], v3 offset:57408
    ds_read_b64_tr_b16 v[154:155], v3 offset:58944
    v_mfma_f32_16x16x32_bf16 v[28:31], v[164:167], v[12:15], v[28:31]
    v_mfma_f32_32x32x16_bf16 v[96:111], v[164:167], v[136:139], v[96:111]
    v_mfma_f32_32x32x16_bf16 v[112:127], v[164:167], v[140:143], v[112:127]
    s_waitcnt lgkmcnt(4)
    v_mfma_f32_32x32x16_bf16 v[32:47], v[144:147], v[128:131], v[32:47]
    ds_read_b128 v[136:139], v7 offset:9216
    ds_read_b64_tr_b16 v[156:157], v3 offset:63488
    v_mfma_f32_32x32x16_bf16 v[48:63], v[144:147], v[132:135], v[48:63]
    ds_read_b64_tr_b16 v[158:159], v3 offset:65024
    ds_read_b128 v[140:143], v7 offset:11264
    s_waitcnt lgkmcnt(6)
    v_mfma_f32_32x32x16_bf16 v[64:79], v[148:151], v[128:131], v[64:79]
    ds_read_b64_tr_b16 v[160:161], v5 offset:63520
    ds_read_b64_tr_b16 v[162:163], v5 offset:65056
    v_mfma_f32_32x32x16_bf16 v[80:95], v[148:151], v[132:135], v[80:95]
    ds_read_b64_tr_b16 v[164:165], v3 offset:63552
    ds_read_b64_tr_b16 v[166:167], v3 offset:65088
    s_waitcnt lgkmcnt(8)
    v_mfma_f32_32x32x16_bf16 v[96:111], v[152:155], v[128:131], v[96:111]
    v_mfma_f32_32x32x16_bf16 v[112:127], v[152:155], v[132:135], v[112:127]
    s_waitcnt lgkmcnt(0)
    s_barrier
    v_mfma_f32_16x16x32_bf16 v[20:23], v[156:159], v[12:15], v[20:23]
    v_mfma_f32_32x32x16_bf16 v[32:47], v[156:159], v[136:139], v[32:47]
    ds_read_b128 v[128:131], v7 offset:16384
    ds_read_b64_tr_b16 v[144:145], v4 offset:4096
    v_mfma_f32_32x32x16_bf16 v[48:63], v[156:159], v[140:143], v[48:63]
    ds_read_b64_tr_b16 v[146:147], v4 offset:5632
    ds_read_b128 v[132:135], v7 offset:18432
    v_mfma_f32_16x16x32_bf16 v[24:27], v[160:163], v[12:15], v[24:27]
    v_mfma_f32_32x32x16_bf16 v[64:79], v[160:163], v[136:139], v[64:79]
    ds_read_b64_tr_b16 v[148:149], v6 offset:4128
    ds_read_b64_tr_b16 v[150:151], v6 offset:5664
    v_mfma_f32_32x32x16_bf16 v[80:95], v[160:163], v[140:143], v[80:95]
    ds_read_b64_tr_b16 v[152:153], v4 offset:4160
    ds_read_b64_tr_b16 v[154:155], v4 offset:5696
    v_mfma_f32_16x16x32_bf16 v[28:31], v[164:167], v[12:15], v[28:31]
    v_mfma_f32_32x32x16_bf16 v[96:111], v[164:167], v[136:139], v[96:111]
    v_mfma_f32_32x32x16_bf16 v[112:127], v[164:167], v[140:143], v[112:127]
    s_waitcnt lgkmcnt(4)
    v_mfma_f32_32x32x16_bf16 v[32:47], v[144:147], v[128:131], v[32:47]
    ds_read_b128 v[136:139], v7 offset:17408
    ds_read_b64_tr_b16 v[156:157], v4 offset:10240
    v_mfma_f32_32x32x16_bf16 v[48:63], v[144:147], v[132:135], v[48:63]
    ds_read_b64_tr_b16 v[158:159], v4 offset:11776
    ds_read_b128 v[140:143], v7 offset:19456
    s_waitcnt lgkmcnt(6)
    v_mfma_f32_32x32x16_bf16 v[64:79], v[148:151], v[128:131], v[64:79]
    ds_read_b64_tr_b16 v[160:161], v6 offset:10272
    ds_read_b64_tr_b16 v[162:163], v6 offset:11808
    v_mfma_f32_32x32x16_bf16 v[80:95], v[148:151], v[132:135], v[80:95]
    ds_read_b64_tr_b16 v[164:165], v4 offset:10304
    ds_read_b64_tr_b16 v[166:167], v4 offset:11840
    s_waitcnt lgkmcnt(8)
    v_mfma_f32_32x32x16_bf16 v[96:111], v[152:155], v[128:131], v[96:111]
    v_mfma_f32_32x32x16_bf16 v[112:127], v[152:155], v[132:135], v[112:127]
    s_waitcnt lgkmcnt(0)
    s_barrier
    v_mfma_f32_16x16x32_bf16 v[20:23], v[156:159], v[12:15], v[20:23]
    v_mfma_f32_32x32x16_bf16 v[32:47], v[156:159], v[136:139], v[32:47]
    ds_read_b128 v[128:131], v7 offset:24576
    ds_read_b64_tr_b16 v[144:145], v4 offset:16384
    v_mfma_f32_32x32x16_bf16 v[48:63], v[156:159], v[140:143], v[48:63]
    ds_read_b64_tr_b16 v[146:147], v4 offset:17920
    ds_read_b128 v[132:135], v7 offset:26624
    v_mfma_f32_16x16x32_bf16 v[24:27], v[160:163], v[12:15], v[24:27]
    v_mfma_f32_32x32x16_bf16 v[64:79], v[160:163], v[136:139], v[64:79]
    ds_read_b64_tr_b16 v[148:149], v6 offset:16416
    ds_read_b64_tr_b16 v[150:151], v6 offset:17952
    v_mfma_f32_32x32x16_bf16 v[80:95], v[160:163], v[140:143], v[80:95]
    ds_read_b64_tr_b16 v[152:153], v4 offset:16448
    ds_read_b64_tr_b16 v[154:155], v4 offset:17984
    v_mfma_f32_16x16x32_bf16 v[28:31], v[164:167], v[12:15], v[28:31]
    v_mfma_f32_32x32x16_bf16 v[96:111], v[164:167], v[136:139], v[96:111]
    v_mfma_f32_32x32x16_bf16 v[112:127], v[164:167], v[140:143], v[112:127]
    s_waitcnt lgkmcnt(4)
    v_mfma_f32_32x32x16_bf16 v[32:47], v[144:147], v[128:131], v[32:47]
    ds_read_b128 v[136:139], v7 offset:25600
    ds_read_b64_tr_b16 v[156:157], v4 offset:22528
    v_mfma_f32_32x32x16_bf16 v[48:63], v[144:147], v[132:135], v[48:63]
    ds_read_b64_tr_b16 v[158:159], v4 offset:24064
    ds_read_b128 v[140:143], v7 offset:27648
    s_waitcnt lgkmcnt(6)
    v_mfma_f32_32x32x16_bf16 v[64:79], v[148:151], v[128:131], v[64:79]
    ds_read_b64_tr_b16 v[160:161], v6 offset:22560
    ds_read_b64_tr_b16 v[162:163], v6 offset:24096
    v_mfma_f32_32x32x16_bf16 v[80:95], v[148:151], v[132:135], v[80:95]
    ds_read_b64_tr_b16 v[164:165], v4 offset:22592
    ds_read_b64_tr_b16 v[166:167], v4 offset:24128
    s_waitcnt lgkmcnt(8)
    v_mfma_f32_32x32x16_bf16 v[96:111], v[152:155], v[128:131], v[96:111]
    v_mfma_f32_32x32x16_bf16 v[112:127], v[152:155], v[132:135], v[112:127]
    s_waitcnt lgkmcnt(0)
    s_barrier
    v_mfma_f32_16x16x32_bf16 v[20:23], v[156:159], v[12:15], v[20:23]
    v_mfma_f32_32x32x16_bf16 v[32:47], v[156:159], v[136:139], v[32:47]
    ds_read_b128 v[128:131], v7 offset:32768
    ds_read_b64_tr_b16 v[144:145], v3 offset:32768
    v_mfma_f32_32x32x16_bf16 v[48:63], v[156:159], v[140:143], v[48:63]
    ds_read_b64_tr_b16 v[146:147], v3 offset:34304
    ds_read_b128 v[132:135], v7 offset:34816
    v_mfma_f32_16x16x32_bf16 v[24:27], v[160:163], v[12:15], v[24:27]
    v_mfma_f32_32x32x16_bf16 v[64:79], v[160:163], v[136:139], v[64:79]
    ds_read_b64_tr_b16 v[148:149], v5 offset:32800
    ds_read_b64_tr_b16 v[150:151], v5 offset:34336
    v_mfma_f32_32x32x16_bf16 v[80:95], v[160:163], v[140:143], v[80:95]
    ds_read_b64_tr_b16 v[152:153], v3 offset:32832
    ds_read_b64_tr_b16 v[154:155], v3 offset:34368
    v_mfma_f32_16x16x32_bf16 v[28:31], v[164:167], v[12:15], v[28:31]
    v_mfma_f32_32x32x16_bf16 v[96:111], v[164:167], v[136:139], v[96:111]
    v_mfma_f32_32x32x16_bf16 v[112:127], v[164:167], v[140:143], v[112:127]
    s_waitcnt lgkmcnt(4)
    v_mfma_f32_32x32x16_bf16 v[32:47], v[144:147], v[128:131], v[32:47]
    ds_read_b128 v[136:139], v7 offset:33792
    ds_read_b64_tr_b16 v[156:157], v3 offset:38912
    v_mfma_f32_32x32x16_bf16 v[48:63], v[144:147], v[132:135], v[48:63]
    ds_read_b64_tr_b16 v[158:159], v3 offset:40448
    ds_read_b128 v[140:143], v7 offset:35840
    s_waitcnt lgkmcnt(6)
    v_mfma_f32_32x32x16_bf16 v[64:79], v[148:151], v[128:131], v[64:79]
    ds_read_b64_tr_b16 v[160:161], v5 offset:38944
    ds_read_b64_tr_b16 v[162:163], v5 offset:40480
    v_mfma_f32_32x32x16_bf16 v[80:95], v[148:151], v[132:135], v[80:95]
    ds_read_b64_tr_b16 v[164:165], v3 offset:38976
    ds_read_b64_tr_b16 v[166:167], v3 offset:40512
    s_waitcnt lgkmcnt(8)
    v_mfma_f32_32x32x16_bf16 v[96:111], v[152:155], v[128:131], v[96:111]
    v_mfma_f32_32x32x16_bf16 v[112:127], v[152:155], v[132:135], v[112:127]
    s_waitcnt lgkmcnt(0)
    s_barrier
    v_mfma_f32_16x16x32_bf16 v[20:23], v[156:159], v[12:15], v[20:23]
    v_mfma_f32_32x32x16_bf16 v[32:47], v[156:159], v[136:139], v[32:47]
    ds_read_b128 v[128:131], v7 offset:0
    ds_read_b64_tr_b16 v[144:145], v3 offset:45056
    v_mfma_f32_32x32x16_bf16 v[48:63], v[156:159], v[140:143], v[48:63]
    ds_read_b64_tr_b16 v[146:147], v3 offset:46592
    ds_read_b128 v[132:135], v7 offset:2048
    v_mfma_f32_16x16x32_bf16 v[24:27], v[160:163], v[12:15], v[24:27]
    v_mfma_f32_32x32x16_bf16 v[64:79], v[160:163], v[136:139], v[64:79]
    ds_read_b64_tr_b16 v[148:149], v5 offset:45088
    ds_read_b64_tr_b16 v[150:151], v5 offset:46624
    v_mfma_f32_32x32x16_bf16 v[80:95], v[160:163], v[140:143], v[80:95]
    ds_read_b64_tr_b16 v[152:153], v3 offset:45120
    ds_read_b64_tr_b16 v[154:155], v3 offset:46656
    v_mfma_f32_16x16x32_bf16 v[28:31], v[164:167], v[12:15], v[28:31]
    v_mfma_f32_32x32x16_bf16 v[96:111], v[164:167], v[136:139], v[96:111]
    v_mfma_f32_32x32x16_bf16 v[112:127], v[164:167], v[140:143], v[112:127]
    s_waitcnt lgkmcnt(4)
    v_mfma_f32_32x32x16_bf16 v[32:47], v[144:147], v[128:131], v[32:47]
    ds_read_b128 v[136:139], v7 offset:1024
    ds_read_b64_tr_b16 v[156:157], v3 offset:51200
    v_mfma_f32_32x32x16_bf16 v[48:63], v[144:147], v[132:135], v[48:63]
    ds_read_b64_tr_b16 v[158:159], v3 offset:52736
    ds_read_b128 v[140:143], v7 offset:3072
    s_waitcnt lgkmcnt(6)
    v_mfma_f32_32x32x16_bf16 v[64:79], v[148:151], v[128:131], v[64:79]
    ds_read_b64_tr_b16 v[160:161], v5 offset:51232
    ds_read_b64_tr_b16 v[162:163], v5 offset:52768
    v_mfma_f32_32x32x16_bf16 v[80:95], v[148:151], v[132:135], v[80:95]
    ds_read_b64_tr_b16 v[164:165], v3 offset:51264
    ds_read_b64_tr_b16 v[166:167], v3 offset:52800
    s_waitcnt lgkmcnt(8)
    v_mfma_f32_32x32x16_bf16 v[96:111], v[152:155], v[128:131], v[96:111]
    v_mfma_f32_32x32x16_bf16 v[112:127], v[152:155], v[132:135], v[112:127]
    s_waitcnt lgkmcnt(0)
    s_barrier
    v_mfma_f32_16x16x32_bf16 v[20:23], v[156:159], v[12:15], v[20:23]
    v_mfma_f32_32x32x16_bf16 v[32:47], v[156:159], v[136:139], v[32:47]
    ds_read_b128 v[128:131], v7 offset:8192
    ds_read_b64_tr_b16 v[144:145], v4 offset:32768
    v_mfma_f32_32x32x16_bf16 v[48:63], v[156:159], v[140:143], v[48:63]
    ds_read_b64_tr_b16 v[146:147], v4 offset:34304
    ds_read_b128 v[132:135], v7 offset:10240
    v_mfma_f32_16x16x32_bf16 v[24:27], v[160:163], v[12:15], v[24:27]
    v_mfma_f32_32x32x16_bf16 v[64:79], v[160:163], v[136:139], v[64:79]
    ds_read_b64_tr_b16 v[148:149], v6 offset:32800
    ds_read_b64_tr_b16 v[150:151], v6 offset:34336
    v_mfma_f32_32x32x16_bf16 v[80:95], v[160:163], v[140:143], v[80:95]
    ds_read_b64_tr_b16 v[152:153], v4 offset:32832
    ds_read_b64_tr_b16 v[154:155], v4 offset:34368
    v_mfma_f32_16x16x32_bf16 v[28:31], v[164:167], v[12:15], v[28:31]
    v_mfma_f32_32x32x16_bf16 v[96:111], v[164:167], v[136:139], v[96:111]
    v_mfma_f32_32x32x16_bf16 v[112:127], v[164:167], v[140:143], v[112:127]
    s_waitcnt lgkmcnt(4)
    v_mfma_f32_32x32x16_bf16 v[32:47], v[144:147], v[128:131], v[32:47]
    ds_read_b128 v[136:139], v7 offset:9216
    ds_read_b64_tr_b16 v[156:157], v4 offset:38912
    v_mfma_f32_32x32x16_bf16 v[48:63], v[144:147], v[132:135], v[48:63]
    ds_read_b64_tr_b16 v[158:159], v4 offset:40448
    ds_read_b128 v[140:143], v7 offset:11264
    s_waitcnt lgkmcnt(6)
    v_mfma_f32_32x32x16_bf16 v[64:79], v[148:151], v[128:131], v[64:79]
    ds_read_b64_tr_b16 v[160:161], v6 offset:38944
    ds_read_b64_tr_b16 v[162:163], v6 offset:40480
    v_mfma_f32_32x32x16_bf16 v[80:95], v[148:151], v[132:135], v[80:95]
    ds_read_b64_tr_b16 v[164:165], v4 offset:38976
    ds_read_b64_tr_b16 v[166:167], v4 offset:40512
    s_waitcnt lgkmcnt(8)
    v_mfma_f32_32x32x16_bf16 v[96:111], v[152:155], v[128:131], v[96:111]
    v_mfma_f32_32x32x16_bf16 v[112:127], v[152:155], v[132:135], v[112:127]
    s_waitcnt lgkmcnt(0)
    s_barrier
    v_mfma_f32_16x16x32_bf16 v[20:23], v[156:159], v[12:15], v[20:23]
    v_mfma_f32_32x32x16_bf16 v[32:47], v[156:159], v[136:139], v[32:47]
    ds_read_b128 v[128:131], v7 offset:16384
    ds_read_b64_tr_b16 v[144:145], v4 offset:45056
    v_mfma_f32_32x32x16_bf16 v[48:63], v[156:159], v[140:143], v[48:63]
    ds_read_b64_tr_b16 v[146:147], v4 offset:46592
    ds_read_b128 v[132:135], v7 offset:18432
    v_mfma_f32_16x16x32_bf16 v[24:27], v[160:163], v[12:15], v[24:27]
    v_mfma_f32_32x32x16_bf16 v[64:79], v[160:163], v[136:139], v[64:79]
    ds_read_b64_tr_b16 v[148:149], v6 offset:45088
    ds_read_b64_tr_b16 v[150:151], v6 offset:46624
    v_mfma_f32_32x32x16_bf16 v[80:95], v[160:163], v[140:143], v[80:95]
    ds_read_b64_tr_b16 v[152:153], v4 offset:45120
    ds_read_b64_tr_b16 v[154:155], v4 offset:46656
    v_mfma_f32_16x16x32_bf16 v[28:31], v[164:167], v[12:15], v[28:31]
    v_mfma_f32_32x32x16_bf16 v[96:111], v[164:167], v[136:139], v[96:111]
    v_mfma_f32_32x32x16_bf16 v[112:127], v[164:167], v[140:143], v[112:127]
    s_waitcnt lgkmcnt(4)
    v_mfma_f32_32x32x16_bf16 v[32:47], v[144:147], v[128:131], v[32:47]
    ds_read_b128 v[136:139], v7 offset:17408
    ds_read_b64_tr_b16 v[156:157], v4 offset:51200
    v_mfma_f32_32x32x16_bf16 v[48:63], v[144:147], v[132:135], v[48:63]
    ds_read_b64_tr_b16 v[158:159], v4 offset:52736
    ds_read_b128 v[140:143], v7 offset:19456
    s_waitcnt lgkmcnt(6)
    v_mfma_f32_32x32x16_bf16 v[64:79], v[148:151], v[128:131], v[64:79]
    ds_read_b64_tr_b16 v[160:161], v6 offset:51232
    ds_read_b64_tr_b16 v[162:163], v6 offset:52768
    v_mfma_f32_32x32x16_bf16 v[80:95], v[148:151], v[132:135], v[80:95]
    ds_read_b64_tr_b16 v[164:165], v4 offset:51264
    ds_read_b64_tr_b16 v[166:167], v4 offset:52800
    s_waitcnt lgkmcnt(8)
    v_mfma_f32_32x32x16_bf16 v[96:111], v[152:155], v[128:131], v[96:111]
    v_mfma_f32_32x32x16_bf16 v[112:127], v[152:155], v[132:135], v[112:127]
    s_waitcnt lgkmcnt(0)
    s_barrier
    v_mfma_f32_16x16x32_bf16 v[20:23], v[156:159], v[12:15], v[20:23]
    v_mfma_f32_32x32x16_bf16 v[32:47], v[156:159], v[136:139], v[32:47]
    ds_read_b128 v[128:131], v7 offset:24576
    ds_read_b64_tr_b16 v[144:145], v3 offset:0
    v_mfma_f32_32x32x16_bf16 v[48:63], v[156:159], v[140:143], v[48:63]
    ds_read_b64_tr_b16 v[146:147], v3 offset:1536
    ds_read_b128 v[132:135], v7 offset:26624
    v_mfma_f32_16x16x32_bf16 v[24:27], v[160:163], v[12:15], v[24:27]
    v_mfma_f32_32x32x16_bf16 v[64:79], v[160:163], v[136:139], v[64:79]
    ds_read_b64_tr_b16 v[148:149], v5 offset:32
    ds_read_b64_tr_b16 v[150:151], v5 offset:1568
    v_mfma_f32_32x32x16_bf16 v[80:95], v[160:163], v[140:143], v[80:95]
    ds_read_b64_tr_b16 v[152:153], v3 offset:64
    ds_read_b64_tr_b16 v[154:155], v3 offset:1600
    v_mfma_f32_16x16x32_bf16 v[28:31], v[164:167], v[12:15], v[28:31]
    v_mfma_f32_32x32x16_bf16 v[96:111], v[164:167], v[136:139], v[96:111]
    v_mfma_f32_32x32x16_bf16 v[112:127], v[164:167], v[140:143], v[112:127]
    s_waitcnt lgkmcnt(4)
    v_mfma_f32_32x32x16_bf16 v[32:47], v[144:147], v[128:131], v[32:47]
    ds_read_b128 v[136:139], v7 offset:25600
    ds_read_b64_tr_b16 v[156:157], v3 offset:6144
    v_mfma_f32_32x32x16_bf16 v[48:63], v[144:147], v[132:135], v[48:63]
    ds_read_b64_tr_b16 v[158:159], v3 offset:7680
    ds_read_b128 v[140:143], v7 offset:27648
    s_waitcnt lgkmcnt(6)
    v_mfma_f32_32x32x16_bf16 v[64:79], v[148:151], v[128:131], v[64:79]
    ds_read_b64_tr_b16 v[160:161], v5 offset:6176
    ds_read_b64_tr_b16 v[162:163], v5 offset:7712
    v_mfma_f32_32x32x16_bf16 v[80:95], v[148:151], v[132:135], v[80:95]
    ds_read_b64_tr_b16 v[164:165], v3 offset:6208
    ds_read_b64_tr_b16 v[166:167], v3 offset:7744
    s_waitcnt lgkmcnt(8)
    v_mfma_f32_32x32x16_bf16 v[96:111], v[152:155], v[128:131], v[96:111]
    v_mfma_f32_32x32x16_bf16 v[112:127], v[152:155], v[132:135], v[112:127]
    s_waitcnt lgkmcnt(0)
    s_barrier
    v_mfma_f32_16x16x32_bf16 v[20:23], v[156:159], v[12:15], v[20:23]
    v_mfma_f32_32x32x16_bf16 v[32:47], v[156:159], v[136:139], v[32:47]
    ds_read_b128 v[128:131], v7 offset:32768
    ds_read_b64_tr_b16 v[144:145], v3 offset:12288
    v_mfma_f32_32x32x16_bf16 v[48:63], v[156:159], v[140:143], v[48:63]
    ds_read_b64_tr_b16 v[146:147], v3 offset:13824
    ds_read_b128 v[132:135], v7 offset:34816
    v_mfma_f32_16x16x32_bf16 v[24:27], v[160:163], v[12:15], v[24:27]
    v_mfma_f32_32x32x16_bf16 v[64:79], v[160:163], v[136:139], v[64:79]
    ds_read_b64_tr_b16 v[148:149], v5 offset:12320
    ds_read_b64_tr_b16 v[150:151], v5 offset:13856
    v_mfma_f32_32x32x16_bf16 v[80:95], v[160:163], v[140:143], v[80:95]
    ds_read_b64_tr_b16 v[152:153], v3 offset:12352
    ds_read_b64_tr_b16 v[154:155], v3 offset:13888
    v_mfma_f32_16x16x32_bf16 v[28:31], v[164:167], v[12:15], v[28:31]
    v_mfma_f32_32x32x16_bf16 v[96:111], v[164:167], v[136:139], v[96:111]
    v_mfma_f32_32x32x16_bf16 v[112:127], v[164:167], v[140:143], v[112:127]
    s_waitcnt lgkmcnt(4)
    v_mfma_f32_32x32x16_bf16 v[32:47], v[144:147], v[128:131], v[32:47]
    ds_read_b128 v[136:139], v7 offset:33792
    ds_read_b64_tr_b16 v[156:157], v3 offset:18432
    v_mfma_f32_32x32x16_bf16 v[48:63], v[144:147], v[132:135], v[48:63]
    ds_read_b64_tr_b16 v[158:159], v3 offset:19968
    ds_read_b128 v[140:143], v7 offset:35840
    s_waitcnt lgkmcnt(6)
    v_mfma_f32_32x32x16_bf16 v[64:79], v[148:151], v[128:131], v[64:79]
    ds_read_b64_tr_b16 v[160:161], v5 offset:18464
    ds_read_b64_tr_b16 v[162:163], v5 offset:20000
    v_mfma_f32_32x32x16_bf16 v[80:95], v[148:151], v[132:135], v[80:95]
    ds_read_b64_tr_b16 v[164:165], v3 offset:18496
    ds_read_b64_tr_b16 v[166:167], v3 offset:20032
    s_waitcnt lgkmcnt(8)
    v_mfma_f32_32x32x16_bf16 v[96:111], v[152:155], v[128:131], v[96:111]
    v_mfma_f32_32x32x16_bf16 v[112:127], v[152:155], v[132:135], v[112:127]
    s_waitcnt lgkmcnt(0)
    s_barrier
    v_mfma_f32_16x16x32_bf16 v[20:23], v[156:159], v[12:15], v[20:23]
    v_mfma_f32_32x32x16_bf16 v[32:47], v[156:159], v[136:139], v[32:47]
    ds_read_b128 v[128:131], v7 offset:0
    ds_read_b64_tr_b16 v[144:145], v3 offset:57344
    v_mfma_f32_32x32x16_bf16 v[48:63], v[156:159], v[140:143], v[48:63]
    ds_read_b64_tr_b16 v[146:147], v3 offset:58880
    ds_read_b128 v[132:135], v7 offset:2048
    v_mfma_f32_16x16x32_bf16 v[24:27], v[160:163], v[12:15], v[24:27]
    v_mfma_f32_32x32x16_bf16 v[64:79], v[160:163], v[136:139], v[64:79]
    ds_read_b64_tr_b16 v[148:149], v5 offset:57376
    ds_read_b64_tr_b16 v[150:151], v5 offset:58912
    v_mfma_f32_32x32x16_bf16 v[80:95], v[160:163], v[140:143], v[80:95]
    ds_read_b64_tr_b16 v[152:153], v3 offset:57408
    ds_read_b64_tr_b16 v[154:155], v3 offset:58944
    v_mfma_f32_16x16x32_bf16 v[28:31], v[164:167], v[12:15], v[28:31]
    v_mfma_f32_32x32x16_bf16 v[96:111], v[164:167], v[136:139], v[96:111]
    v_mfma_f32_32x32x16_bf16 v[112:127], v[164:167], v[140:143], v[112:127]
    s_waitcnt lgkmcnt(4)
    v_mfma_f32_32x32x16_bf16 v[32:47], v[144:147], v[128:131], v[32:47]
    ds_read_b128 v[136:139], v7 offset:1024
    ds_read_b64_tr_b16 v[156:157], v3 offset:63488
    v_mfma_f32_32x32x16_bf16 v[48:63], v[144:147], v[132:135], v[48:63]
    ds_read_b64_tr_b16 v[158:159], v3 offset:65024
    ds_read_b128 v[140:143], v7 offset:3072
    s_waitcnt lgkmcnt(6)
    v_mfma_f32_32x32x16_bf16 v[64:79], v[148:151], v[128:131], v[64:79]
    ds_read_b64_tr_b16 v[160:161], v5 offset:63520
    ds_read_b64_tr_b16 v[162:163], v5 offset:65056
    v_mfma_f32_32x32x16_bf16 v[80:95], v[148:151], v[132:135], v[80:95]
    ds_read_b64_tr_b16 v[164:165], v3 offset:63552
    ds_read_b64_tr_b16 v[166:167], v3 offset:65088
    s_waitcnt lgkmcnt(8)
    v_mfma_f32_32x32x16_bf16 v[96:111], v[152:155], v[128:131], v[96:111]
    v_mfma_f32_32x32x16_bf16 v[112:127], v[152:155], v[132:135], v[112:127]
    s_waitcnt lgkmcnt(0)
    v_mfma_f32_16x16x32_bf16 v[20:23], v[156:159], v[12:15], v[20:23]
    v_mfma_f32_16x16x32_bf16 v[24:27], v[160:163], v[12:15], v[24:27]
    v_mfma_f32_16x16x32_bf16 v[28:31], v[164:167], v[12:15], v[28:31]
    s_branch L_p4_join
L_p2_fallback:
    s_lshl_b32 s37, s27, 16
    v_subrev_u32 v155, s37, v4
    s_mul_i32 s36, s25, 135424
    s_add_u32 s36, s36, 12582912
    v_mov_b32 v156, 0xff800000
    s_mov_b32 s56, 0
    s_mov_b32 s37, s36
L_p2_fb_max:
    buffer_load_dwordx4 v[16:19], v2, s[12:15], s37 offen sc1
    s_waitcnt vmcnt(0)
    v_mfma_f32_32x32x16_bf16 v[64:79], v[16:19], v[8:11], 0
    s_nop 15
    v_max3_f32 v156, v156, v64, v65
    v_max3_f32 v156, v156, v66, v67
    v_max3_f32 v156, v156, v68, v69
    v_max3_f32 v156, v156, v70, v71
    v_max3_f32 v156, v156, v72, v73
    v_max3_f32 v156, v156, v74, v75
    v_max3_f32 v156, v156, v76, v77
    v_max3_f32 v156, v156, v78, v79
    s_add_u32 s37, s37, 2048
    s_add_u32 s56, s56, 1
    s_cmp_lt_u32 s56, 64
    s_cbranch_scc1 L_p2_fb_max
    v_mov_b32 v144, v156
    s_nop 1
    v_permlane32_swap_b32 v156, v144
    s_nop 1
    v_max_f32 v156, v156, v144
    v_sub_f32 v128, 0, v156
    v_mov_b32 v96, 0
    v_sub_f32 v129, 0, v156
    v_mov_b32 v97, 0
    v_sub_f32 v130, 0, v156
    v_mov_b32 v98, 0
    v_sub_f32 v131, 0, v156
    v_mov_b32 v99, 0
    v_sub_f32 v132, 0, v156
    v_mov_b32 v100, 0
    v_sub_f32 v133, 0, v156
    v_mov_b32 v101, 0
    v_sub_f32 v134, 0, v156
    v_mov_b32 v102, 0
    v_sub_f32 v135, 0, v156
    v_mov_b32 v103, 0
    v_sub_f32 v136, 0, v156
    v_mov_b32 v104, 0
    v_sub_f32 v137, 0, v156
    v_mov_b32 v105, 0
    v_sub_f32 v138, 0, v156
    v_mov_b32 v106, 0
    v_sub_f32 v139, 0, v156
    v_mov_b32 v107, 0
    v_sub_f32 v140, 0, v156
    v_mov_b32 v108, 0
    v_sub_f32 v141, 0, v156
    v_mov_b32 v109, 0
    v_sub_f32 v142, 0, v156
    v_mov_b32 v110, 0
    v_sub_f32 v143, 0, v156
    v_mov_b32 v111, 0
    s_mov_b32 s56, 0
    s_mov_b32 s37, s36
L_p2_fb_pv:
    buffer_load_dwordx4 v[16:19], v2, s[12:15], s37 offen sc1
    s_mov_b64 exec, s[34:35]
    buffer_load_dwordx4 v[32:35], v155, s[12:15], s37 offen offset:1024 sc1
    buffer_load_dwordx4 v[36:39], v155, s[12:15], s37 offen offset:1536 sc1
    s_mov_b64 exec, -1
    s_waitcnt vmcnt(0)
    v_mfma_f32_32x32x16_bf16 v[64:79], v[16:19], v[8:11], v[128:143]
    s_nop 15
    v_exp_f32 v64, v64
    v_exp_f32 v65, v65
    v_exp_f32 v66, v66
    v_exp_f32 v67, v67
    v_exp_f32 v68, v68
    v_exp_f32 v69, v69
    v_exp_f32 v70, v70
    v_exp_f32 v71, v71
    v_exp_f32 v72, v72
    v_exp_f32 v73, v73
    v_exp_f32 v74, v74
    v_exp_f32 v75, v75
    v_exp_f32 v76, v76
    v_exp_f32 v77, v77
    v_exp_f32 v78, v78
    v_exp_f32 v79, v79
    s_nop 1
    v_smfmac_f32_32x32x32_bf16 v[96:111], v[32:35], v[64:71], v5
    v_smfmac_f32_32x32x32_bf16 v[96:111], v[36:39], v[72:79], v5
    s_nop 15
    s_add_u32 s37, s37, 2048
    s_add_u32 s56, s56, 1
    s_cmp_lt_u32 s56, 64
    s_cbranch_scc1 L_p2_fb_pv
    s_branch L_p2_finish
L_rdy6_spin:
    s_sleep 2
    ds_read_b32 v152, v150
    s_sub_u32 s59, s59, 1
    s_waitcnt lgkmcnt(0)
    s_cmp_lg_u32 s59, 0
    s_cbranch_scc1 L_rdy6
    s_mov_b32 s59, 1
    v_mov_b32 v152, 7
    s_nop 0
    s_branch L_rdy6
L_rdy12_spin:
    s_sleep 2
    ds_read_b32 v152, v150
    s_sub_u32 s59, s59, 1
    s_waitcnt lgkmcnt(0)
    s_cmp_lg_u32 s59, 0
    s_cbranch_scc1 L_rdy12
    s_mov_b32 s59, 1
    v_mov_b32 v152, 7
    s_nop 0
    s_branch L_rdy12
L_rdy20_spin:
    s_sleep 2
    ds_read_b32 v152, v150
    s_sub_u32 s59, s59, 1
    s_waitcnt lgkmcnt(0)
    s_cmp_lg_u32 s59, 0
    s_cbranch_scc1 L_rdy20
    s_mov_b32 s59, 1
    v_mov_b32 v152, 7
    s_nop 0
    s_branch L_rdy20
L_rdy28_spin:
    s_sleep 2
    ds_read_b32 v152, v150
    s_sub_u32 s59, s59, 1
    s_waitcnt lgkmcnt(0)
    s_cmp_lg_u32 s59, 0
    s_cbranch_scc1 L_rdy28
    s_mov_b32 s59, 1
    v_mov_b32 v152, 7
    s_nop 0
    s_branch L_rdy28
L_rdy36_spin:
    s_sleep 2
    ds_read_b32 v152, v150
    s_sub_u32 s59, s59, 1
    s_waitcnt lgkmcnt(0)
    s_cmp_lg_u32 s59, 0
    s_cbranch_scc1 L_rdy36
    s_mov_b32 s59, 1
    v_mov_b32 v152, 7
    s_nop 0
    s_branch L_rdy36
L_rdy44_spin:
    s_sleep 2
    ds_read_b32 v152, v150
    s_sub_u32 s59, s59, 1
    s_waitcnt lgkmcnt(0)
    s_cmp_lg_u32 s59, 0
    s_cbranch_scc1 L_rdy44
    s_mov_b32 s59, 1
    v_mov_b32 v152, 7
    s_nop 0
    s_branch L_rdy44
L_rdy52_spin:
    s_sleep 2
    ds_read_b32 v152, v150
    s_sub_u32 s59, s59, 1
    s_waitcnt lgkmcnt(0)
    s_cmp_lg_u32 s59, 0
    s_cbranch_scc1 L_rdy52
    s_mov_b32 s59, 1
    v_mov_b32 v152, 7
    s_nop 0
    s_branch L_rdy52
L_code_end:
.section .rodata,"a"
.p2align 6
.amdhsa_kernel sequential_preLN__mha_block__glu_gated_glu__prompt_kernel
  .amdhsa_next_free_vgpr 168
  .amdhsa_next_free_sgpr 102
  .amdhsa_accum_offset 168
  .amdhsa_group_segment_fixed_size 0
  .amdhsa_kernarg_size 80
  .amdhsa_user_sgpr_count 2
  .amdhsa_user_sgpr_kernarg_segment_ptr 1
  .amdhsa_system_sgpr_workgroup_id_x 1
.end_amdhsa_kernel
```
